```python
import torch

def _softmax(x, axis=-1):
    return torch.softmax(x, dim=axis)
def _gelu(x):
    return torch.nn.functional.gelu(x, approximate="tanh")
def _silu(x):
    return torch.nn.functional.silu(x)
def _sigmoid(x):
    return torch.sigmoid(x)
def _layernorm(x, axis=-1, eps=1e-5):
    m = x.mean(dim=axis, keepdim=True)
    v = x.var(dim=axis, keepdim=True, unbiased=False)
    return (x - m) / torch.sqrt(v + eps)
def _scatter_add(tgt, idx, src, axis=0):
    return tgt.clone().index_add_(axis, idx, src)
def _segment_sum(src, seg, n):
    out = torch.zeros((n,) + src.shape[1:], dtype=src.dtype)
    return out.index_add_(0, seg, src)
def _pad(x, pw):
    flat = tuple(v for pair in reversed(pw) for v in pair)
    return torch.nn.functional.pad(x, flat)

kernel_name = 'sequential_preLN__mha_block__dense_activation_silu__prompt'

def setup_inputs():

    _w = (lambda a: (lambda t: t.to(torch.bfloat16) if t.is_floating_point() else t)(torch.as_tensor(a)))
    def _A_setup():
        B, S, D, H = 1, 2048, 512, 32
        return {
            "x": _w((lambda *s: torch.randn(*s, dtype=torch.bfloat16) * 0.05)(B, S, D)),
            "wqkv": _w((lambda *s: torch.randn(*s, dtype=torch.bfloat16) * 0.05)(D, 3 * D)),
            "wo": _w((lambda *s: torch.randn(*s, dtype=torch.bfloat16) * 0.05)(D, D)),
        }
    _A_in = _A_setup()

    def _B_setup():
        B, S, D, F = 1, 2048, 512, 1376
        return {
            "x": _w((lambda *s: torch.randn(*s, dtype=torch.bfloat16) * 0.05)(B, S, D)),
            "w1": _w((lambda *s: torch.randn(*s, dtype=torch.bfloat16) * 0.8)(D, F) * (D ** -0.5)),
            "w2": _w((lambda *s: torch.randn(*s, dtype=torch.bfloat16) * 0.2)(F, D) * (F ** -0.5)),
        }
    _B_in = _B_setup()

    return {
        "A_x": _A_in["x"],
        "A_wqkv": _A_in["wqkv"],
        "A_wo": _A_in["wo"],
        "B_x": _B_in["x"],
        "B_w1": _B_in["w1"],
        "B_w2": _B_in["w2"],
    }

def reference(A_x, A_wqkv, A_wo, B_x, B_w1, B_w2):
    def _A_ref(x, wqkv, wo):
        B, S, D = x.shape
        H = 32
        Dh = D // H
        qkv = (lambda x, *d: x.permute(*d))((x @ wqkv).reshape(B, S, 3, H, Dh), 2, 0, 3, 1, 4)
        q, k, v = qkv[0], qkv[1], qkv[2]
        scores = torch.einsum("bhqd,bhkd->bhqk", q, k) * (Dh ** -0.5)
        p = _softmax(scores, axis=-1)
        o = torch.einsum("bhqk,bhkd->bhqd", p, v)
        return (lambda x, *d: x.permute(*d))(o, 0, 2, 1, 3).reshape(B, S, D) @ wo

    def _B_ref(x, w1, w2):
        h = torch.einsum("bsd,df->bsf", x, w1)
        h = _silu(h)
        out = torch.einsum("bsf,fd->bsd", h, w2)
        return out

    x = A_x
    h = x + _A_ref(_layernorm(x, axis=-1), A_wqkv, A_wo)
    h2 = h + _B_ref(_layernorm(h, axis=-1), B_w1, B_w2)
    return h2
```

```asm
; @launch grid=(256,1,1) block=(256,1,1) lds=163840
.amdgcn_target "amdgcn-amd-amdhsa--gfx950"
.text
.globl sequential_preLN__mha_block__dense_activation_silu__prompt_kernel
.p2align 8
.type sequential_preLN__mha_block__dense_activation_silu__prompt_kernel,@function
sequential_preLN__mha_block__dense_activation_silu__prompt_kernel:
    s_cmp_ge_u32 s2, 256
    s_cbranch_scc1 k2_END
    s_load_dwordx2 s[4:5], s[0:1], 0
    s_load_dwordx2 s[40:41], s[0:1], 8
    s_load_dwordx2 s[22:23], s[0:1], 16
    s_load_dwordx4 s[24:27], s[0:1], 32
    s_load_dwordx4 s[8:11], s[0:1], 48
    s_load_dwordx2 s[6:7], s[0:1], 64
    v_lshrrev_b32 v2, 6, v0
    v_and_b32 v1, 63, v0
    v_readfirstlane_b32 s3, v2
    s_and_b32 s33, s2, 7
    s_lshr_b32 s34, s2, 3
    s_lshr_b32 s18, s34, 1
    s_and_b32 s19, s34, 1
    s_lshl_b32 s35, s33, 1
    s_add_u32 s19, s19, s35
    s_mul_i32 s35, s18, 2
    s_lshr_b32 s35, s35, 1
    s_xor_b32 s30, s33, s35
    s_and_b32 s30, s30, 7
    v_and_b32 v0, 31, v0
    s_lshl_b32 s34, s33, 10
    s_add_u32 s34, s34, 16252928
    v_lshl_add_u32 v0, v0, 2, s34
    s_lshl_b32 s69, s3, 8
    s_add_u32 s69, s69, s2
    s_lshl_b32 s18, s18, 2
    s_add_u32 s18, s18, s3
    v_lshrrev_b32 v16, 3, v1
    v_and_b32 v17, 7, v1
    v_lshrrev_b32 v18, 4, v1
    v_xor_b32 v17, v17, v18
    v_lshlrev_b32 v17, 4, v17
    v_lshl_add_u32 v112, v16, 10, v17
    v_xor_b32 v113, 64, v112
    v_add_u32 v113, 7168, v113
    v_add_u32 v114, 14336, v112
    v_add_u32 v115, 14336, v113
    s_lshl_b32 s21, s3, 4
    v_add_u32 v16, s21, v16
    v_mul_u32_u24 v16, 3072, v16
    v_and_b32 v17, 7, v1
    v_and_b32 v18, 1, v18
    v_lshlrev_b32 v18, 2, v18
    v_xor_b32 v17, v17, v18
    v_lshlrev_b32 v17, 4, v17
    s_and_b32 s12, s19, 1
    s_lshr_b32 s13, s19, 1
    s_lshl_b32 s35, s12, 3
    s_add_u32 s35, s35, s13
    s_lshl_b32 s35, s35, 7
    v_add3_u32 v116, v16, v17, s35
    v_add_u32 v117, 23552, v116
    v_lshrrev_b32 v21, 2, v1
    v_add_u32 v21, s21, v21
    v_mul_u32_u24 v21, 3072, v21
    v_and_b32 v22, 3, v1
    v_lshlrev_b32 v22, 4, v22
    s_lshl_b32 s35, s19, 6
    s_add_u32 s35, s35, 2048
    v_add3_u32 v118, v21, v22, s35
    s_lshl_b32 s31, s3, 12
    s_add_u32 s31, s31, 98304
    s_lshl_b32 s32, s3, 11
    s_lshl_b32 s35, s18, 15
    s_mov_b32 s38, 32768
    s_mov_b32 s39, 0x20000
    s_mov_b32 s42, 1572864
    s_mov_b32 s43, 0x20000
    s_cmp_lt_u32 s69, 8
    s_waitcnt lgkmcnt(0)
    s_cbranch_scc0 K1_CLB
    v_mov_b32 v16, 0
    v_mov_b32 v17, 0
    v_mov_b32 v18, 0
    v_mov_b32 v19, 0
    v_lshl_add_u32 v20, v1, 4, s34
    global_store_dwordx4 v20, v[16:19], s[6:7] sc0 sc1
K1_CLB:
    s_add_u32 s36, s4, s35
    s_addc_u32 s37, s5, 0
    s_xor_b32 s35, s30, 0
    s_add_u32 m0, s31, 0
    s_lshl_b32 s28, s35, 7
    buffer_load_dwordx4 v112, s[36:39], s28 offen offset:0 lds
    buffer_load_dwordx4 v113, s[36:39], s28 offen offset:1024 lds
    buffer_load_dwordx4 v114, s[36:39], s28 offen offset:2048 lds
    buffer_load_dwordx4 v115, s[36:39], s28 offen offset:3072 lds
    s_add_u32 m0, s32, 0
    s_mul_i32 s29, s35, 196608
    buffer_load_dwordx4 v116, s[40:43], s29 offen offset:0 lds
    buffer_load_dwordx4 v117, s[40:43], s29 offen offset:1024 lds
    v_and_b32 v16, 31, v1
    v_lshrrev_b32 v17, 5, v1
    v_bfe_u32 v18, v1, 1, 3
    v_xor_b32 v18, v18, v17
    s_lshl_b32 s35, s3, 1
    v_xor_b32 v18, s35, v18
    v_lshl_add_u32 v19, v16, 7, s31
    v_lshlrev_b32 v20, 9, v17
    v_bfe_u32 v21, v1, 2, 2
    v_lshl_add_u32 v20, v21, 6, v20
    v_bfe_u32 v21, v1, 3, 1
    v_lshl_add_u32 v22, v21, 6, v20
    v_sub_u32 v4, 65536, v22
    v_add_u32 v20, v20, v22
    v_bfe_u32 v21, v1, 4, 1
    v_lshl_add_u32 v20, v21, 5, v20
    v_and_b32 v22, 3, v1
    v_lshl_add_u32 v20, v22, 3, v20
    v_xor_b32 v22, 0, v18
    v_lshl_add_u32 v7, v22, 4, v19
    s_xor_b32 s35, s32, 0
    v_add_u32 v11, s35, v20
    v_xor_b32 v100, 64, v11
    v_xor_b32 v22, 2, v18
    v_lshl_add_u32 v8, v22, 4, v19
    s_xor_b32 s35, s32, 2048
    v_add_u32 v12, s35, v20
    v_xor_b32 v101, 64, v12
    v_xor_b32 v22, 4, v18
    v_lshl_add_u32 v9, v22, 4, v19
    s_xor_b32 s35, s32, 4096
    v_add_u32 v13, s35, v20
    v_xor_b32 v102, 64, v13
    v_xor_b32 v22, 6, v18
    v_lshl_add_u32 v10, v22, 4, v19
    s_xor_b32 s35, s32, 6144
    v_add_u32 v14, s35, v20
    v_xor_b32 v103, 64, v14
    v_lshlrev_b32 v21, 2, v21
    v_and_b32 v22, 7, v1
    v_cmp_eq_u32 vcc, v21, v22
    s_mov_b32 s20, 0x3f803f80
    v_mov_b32 v21, s20
    v_cndmask_b32 v21, 0, v21, vcc
    v_accvgpr_write_b32 a0, v21
    v_accvgpr_write_b32 a1, v21
    v_accvgpr_write_b32 a2, v21
    v_accvgpr_write_b32 a3, v21
    s_mov_b32 vcc_lo, 0
    s_mov_b32 vcc_hi, -1
    v_mov_b32 v21, 0xffff0000
    v_mov_b32 v104, 0
    v_mov_b32 v105, 0
    v_cndmask_b32 v106, 0, v21, vcc
    s_lshl_b32 s35, s3, 2
    s_add_u32 s35, s35, 131072
    v_lshl_add_u32 v107, v1, 4, s35
    v_mov_b32 v109, 0
    v_mov_b32 v110, 0
    v_mov_b32 v111, 0
    s_mov_b32 s35, 131072
    v_lshl_add_u32 v5, v16, 4, s35
    s_lshl_b32 s35, s19, 7
    s_add_u32 s35, s35, s18
    s_lshl_b32 s21, s35, 11
    s_add_u32 s21, s21, 2097152
    s_lshl_b32 s35, s13, 8
    s_add_u32 s35, s35, s18
    s_add_u32 s34, s12, 10
    s_lshl_b32 s14, s35, s34
    s_lshl_b32 s35, 64, s34
    s_cmp_eq_u32 s12, 0
    s_cselect_b32 s34, 0, 2097152
    s_cselect_b32 s33, 0x3eb8aa3b, 1.0
    s_cselect_b64 s[58:59], -1, 0
    s_add_u32 s14, s14, s34
    s_add_u32 s15, s14, s35
    s_add_u32 s16, s15, s35
    s_add_u32 s17, s16, s35
    v_lshrrev_b32 v20, 3, v1
    v_mul_u32_u24 v21, s35, v20
    v_add_u32 v21, s14, v21
    v_and_b32 v20, 1, v20
    v_lshlrev_b32 v20, 17, v20
    s_add_u32 s35, s21, 1024
    v_add_u32 v20, s35, v20
    v_cndmask_b32 v20, v21, v20, vcc
    v_and_b32 v21, 7, v1
    v_lshl_add_u32 v6, v21, 7, v20
    v_and_b32 v20, 3, v1
    v_bfe_u32 v21, v1, 2, 1
    v_lshl_add_u32 v20, v21, 3, v20
    v_bfe_u32 v21, v1, 3, 1
    v_lshl_add_u32 v20, v21, 2, v20
    v_lshlrev_b32 v20, 4, v20
    v_and_b32 v21, 48, v1
    v_lshl_add_u32 v21, v21, 4, v20
    v_lshlrev_b32 v22, 4, v1
    v_cndmask_b32 v2, v21, v22, s[58:59]
    v_lshl_add_u32 v20, v17, 8, v20
    v_bfe_u32 v21, v1, 4, 1
    v_lshl_add_u32 v3, v21, 17, v20
    s_mov_b32 s44, s6
    s_mov_b32 s45, s7
    s_mov_b32 s46, 33554432
    s_mov_b32 s47, 0x20000
    s_mov_b32 s52, s6
    s_mov_b32 s53, s7
    s_mov_b32 s54, 33554432
    s_mov_b32 s55, 0x20000
    s_mov_b32 s51, 0x20000
    s_mov_b32 s60, 2048
    s_mov_b32 s62, 9
    s_lshl_b32 s65, s3, 16
    v_lshrrev_b32 v15, 3, v1
    s_cmp_lt_u32 s2, 96
    s_cbranch_scc0 K1_N512
    s_and_b32 s58, s2, 15
    s_lshr_b32 s59, s2, 4
    s_mov_b32 s48, s24
    s_mov_b32 s49, s25
    s_mov_b32 s50, 1409024
    s_mul_i32 s56, s58, 88064
    s_mov_b32 s57, 22016
    s_mov_b32 s63, s57
    s_mov_b32 s60, 512
    s_mov_b32 s62, 10
    s_lshl_b32 s90, s59, 18
    s_lshl_b32 s35, s58, 10
    s_add_u32 s90, s90, s35
    s_add_u32 s90, s90, s65
    s_add_u32 s90, s90, 7340032
    s_add_u32 s91, s90, 16384
    s_add_u32 s92, s90, 32768
    s_add_u32 s93, s90, 49152
    v_mul_u32_u24 v15, 2752, v15
    s_branch K1_ROLE
K1_N512:
    s_sub_u32 s35, s2, 96
    s_and_b32 s59, s35, 1
    s_lshr_b32 s58, s35, 1
    s_mov_b32 s57, 8192
    s_mov_b32 s63, 8192
    s_cmp_lt_u32 s58, 16
    s_cbranch_scc0 K1_W2
    s_mov_b32 s48, s22
    s_mov_b32 s49, s23
    s_mov_b32 s50, 524288
    s_lshl_b32 s56, s58, 15
    s_lshr_b32 s64, s58, 2
    s_lshl_b32 s90, s59, 6
    s_add_u32 s90, s90, s58
    s_lshl_b32 s90, s90, 12
    s_add_u32 s90, s90, 6291456
    s_mov_b32 s60, 512
    s_mov_b32 s62, 10
    s_branch K1_N512B
K1_W2:
    s_sub_u32 s58, s58, 16
    s_mov_b32 s48, s26
    s_mov_b32 s49, s27
    s_cmp_lt_u32 s58, 43
    s_cselect_b32 s50, 1409024, 0
    s_cmp_lt_u32 s58, 44
    s_cselect_b32 s54, 33554432, 0
    s_min_u32 s58, s58, 43
    s_lshl_b32 s56, s58, 14
    s_sub_u32 s35, s58, 32
    s_max_i32 s35, s35, 0
    s_lshl_b32 s35, s35, 14
    s_add_u32 s56, s56, s35
    s_cmp_lt_u32 s58, 32
    s_cselect_b32 s63, 516096, s63
    s_cselect_b32 s60, s60, 512
    s_cselect_b32 s62, s62, 10
    s_cselect_b32 s35, 0, 524288
    s_add_u32 s56, s56, s35
    s_mul_i32 s64, s58, 47
    s_lshr_b32 s64, s64, 9
    s_mul_i32 s90, s59, 176
    s_add_u32 s90, s90, s58
    s_lshl_b32 s90, s90, 12
    s_add_u32 s90, s90, 9437184
    s_mul_i32 s65, s3, 180224
K1_N512B:
    s_add_u32 s90, s90, s65
    s_sub_u32 s35, 1, s64
    s_and_b32 s35, s35, 3
    s_lshl_b32 s35, s35, 10
    s_add_u32 s91, s90, s35
    s_sub_u32 s35, 2, s64
    s_and_b32 s35, s35, 3
    s_lshl_b32 s35, s35, 10
    s_add_u32 s92, s90, s35
    s_sub_u32 s35, 3, s64
    s_lshl_b32 s35, s35, 10
    s_add_u32 s93, s90, s35
    s_sub_u32 s35, 0, s64
    s_and_b32 s35, s35, 3
    s_lshl_b32 s35, s35, 10
    s_add_u32 s90, s90, s35
    v_lshlrev_b32 v15, 10, v15
K1_ROLE:
    s_lshl_b32 s35, s59, 2
    s_add_u32 s35, s35, s3
    s_lshl_b32 s35, s35, 7
    s_add_u32 s56, s56, s35
    v_and_b32 v16, 7, v1
    v_lshl_add_u32 v15, v16, 4, v15
    s_lshl_b32 s61, s3, 12
    s_add_u32 s61, s61, 147456
    s_xor_b32 s35, s30, 1
    s_add_u32 m0, s31, 16384
    s_lshl_b32 s28, s35, 7
    buffer_load_dwordx4 v112, s[36:39], s28 offen offset:0 lds
    buffer_load_dwordx4 v113, s[36:39], s28 offen offset:1024 lds
    buffer_load_dwordx4 v114, s[36:39], s28 offen offset:2048 lds
    buffer_load_dwordx4 v115, s[36:39], s28 offen offset:3072 lds
    s_add_u32 m0, s32, 8192
    s_mul_i32 s29, s35, 196608
    buffer_load_dwordx4 v116, s[40:43], s29 offen offset:0 lds
    buffer_load_dwordx4 v117, s[40:43], s29 offen offset:1024 lds
    s_xor_b32 s35, s30, 0
    s_add_u32 m0, s32, 65536
    s_mul_i32 s29, s35, 196608
    buffer_load_dwordx4 v118, s[40:43], s29 offen lds
    s_getreg_b32 s68, hwreg(HW_REG_XCC_ID, 0, 3)
    s_mov_b32 s67, 0x100000
    s_add_u32 s68, s68, 1
    s_mov_b32 s0, 0
    v_mov_b32 v123, 0
    v_mov_b32 v124, 1
    s_getpc_b64 s[34:35]
K1_PC:
    s_lshr_b32 s28, s2, 3
    s_lshl_b32 s28, s28, 2
    s_add_u32 s28, s28, s3
    s_lshl_b32 s28, s28, 10
    v_lshl_add_u32 v16, v1, 4, s28
    v_min_u32 v16, k2_LAST-K1_PC-16, v16
    global_load_dwordx4 a[4:7], v16, s[34:35]
    s_waitcnt vmcnt(8)
    ds_read_b128 v[128:131], v7 offset:0
    ds_read_b64_tr_b16 v[64:65], v11 offset:0
    ds_read_b64_tr_b16 v[66:67], v11 offset:512
    ds_read_b64_tr_b16 v[68:69], v100 offset:0
    ds_read_b64_tr_b16 v[70:71], v100 offset:512
    ds_read_b128 v[132:135], v8 offset:0
    s_cmp_lt_u32 s69, 8
    s_cbranch_scc0 K1_AR3
    s_mov_b64 exec, 1
    global_atomic_add v123, v124, s[10:11] sc1
    s_mov_b64 exec, -1
K1_AR3:
    s_barrier
    ds_read_b64_tr_b16 v[72:73], v12 offset:0
    ds_read_b64_tr_b16 v[74:75], v12 offset:512
    ds_read_b64_tr_b16 v[76:77], v101 offset:0
    ds_read_b64_tr_b16 v[78:79], v101 offset:512
    s_waitcnt lgkmcnt(7)
    v_mfma_f32_32x32x16_bf16 v[16:31], v[64:67], v[128:131], 0
    ds_read_b64_tr_b16 v[80:81], v13 offset:0
    ds_read_b64_tr_b16 v[82:83], v13 offset:512
    ds_read_b128 v[136:139], v9 offset:0
    s_xor_b32 s35, s30, 2
    s_add_u32 m0, s31, 32768
    s_lshl_b32 s28, s35, 7
    buffer_load_dwordx4 v112, s[36:39], s28 offen offset:0 lds
    v_mfma_f32_16x16x32_bf16 v[88:91], a[0:3], v[64:67], 0
    s_waitcnt lgkmcnt(8)
    v_mfma_f32_32x32x16_bf16 v[32:47], v[68:71], v[128:131], 0
    ds_read_b64_tr_b16 v[84:85], v102 offset:0
    ds_read_b64_tr_b16 v[86:87], v102 offset:512
    buffer_load_dwordx4 v113, s[36:39], s28 offen offset:1024 lds
    buffer_load_dwordx4 v114, s[36:39], s28 offen offset:2048 lds
    buffer_load_dwordx4 v115, s[36:39], s28 offen offset:3072 lds
    s_add_u32 m0, s32, 16384
    v_mfma_f32_16x16x32_bf16 v[92:95], a[0:3], v[68:71], 0
    s_waitcnt lgkmcnt(7)
    v_mfma_f32_32x32x16_bf16 v[16:31], v[72:75], v[132:135], v[16:31]
    ds_read_b64_tr_b16 v[64:65], v14 offset:0
    ds_read_b64_tr_b16 v[66:67], v14 offset:512
    ds_read_b128 v[140:143], v10 offset:0
    s_mul_i32 s29, s35, 196608
    buffer_load_dwordx4 v116, s[40:43], s29 offen offset:0 lds
    buffer_load_dwordx4 v117, s[40:43], s29 offen offset:1024 lds
    s_waitcnt lgkmcnt(8)
    v_mfma_f32_32x32x16_bf16 v[32:47], v[76:79], v[132:135], v[32:47]
    ds_read_b64_tr_b16 v[68:69], v103 offset:0
    ds_read_b64_tr_b16 v[70:71], v103 offset:512
    v_dot2c_f32_bf16 v104, s20, v128
    v_dot2c_f32_bf16 v105, v128, v128
    v_dot2c_f32_bf16 v104, s20, v129
    v_dot2c_f32_bf16 v105, v129, v129
    v_dot2c_f32_bf16 v104, s20, v130
    v_dot2c_f32_bf16 v105, v130, v130
    v_dot2c_f32_bf16 v104, s20, v131
    v_dot2c_f32_bf16 v105, v131, v131
    v_dot2c_f32_bf16 v104, s20, v132
    v_dot2c_f32_bf16 v105, v132, v132
    v_dot2c_f32_bf16 v104, s20, v133
    v_dot2c_f32_bf16 v105, v133, v133
    v_dot2c_f32_bf16 v104, s20, v134
    v_dot2c_f32_bf16 v105, v134, v134
    v_dot2c_f32_bf16 v104, s20, v135
    v_dot2c_f32_bf16 v105, v135, v135
    s_waitcnt lgkmcnt(7)
    v_dot2c_f32_bf16 v104, s20, v136
    v_dot2c_f32_bf16 v105, v136, v136
    v_dot2c_f32_bf16 v104, s20, v137
    v_dot2c_f32_bf16 v105, v137, v137
    v_dot2c_f32_bf16 v104, s20, v138
    v_dot2c_f32_bf16 v105, v138, v138
    v_dot2c_f32_bf16 v104, s20, v139
    v_dot2c_f32_bf16 v105, v139, v139
    s_waitcnt lgkmcnt(2)
    v_dot2c_f32_bf16 v104, s20, v140
    v_dot2c_f32_bf16 v105, v140, v140
    v_dot2c_f32_bf16 v104, s20, v141
    v_dot2c_f32_bf16 v105, v141, v141
    v_dot2c_f32_bf16 v104, s20, v142
    v_dot2c_f32_bf16 v105, v142, v142
    v_dot2c_f32_bf16 v104, s20, v143
    v_dot2c_f32_bf16 v105, v143, v143
    s_waitcnt vmcnt(8)
    v_mfma_f32_32x32x16_bf16 v[16:31], v[80:83], v[136:139], v[16:31]
    ds_read_b64_tr_b16 v[72:73], v11 offset:8192
    ds_read_b64_tr_b16 v[74:75], v11 offset:8704
    ds_read_b128 v[144:147], v7 offset:16384
    v_mfma_f32_32x32x16_bf16 v[32:47], v[84:87], v[136:139], v[32:47]
    ds_read_b64_tr_b16 v[76:77], v100 offset:8192
    ds_read_b64_tr_b16 v[78:79], v100 offset:8704
    v_mfma_f32_32x32x16_bf16 v[16:31], v[64:67], v[140:143], v[16:31]
    s_barrier
    ds_read_b64_tr_b16 v[80:81], v12 offset:8192
    ds_read_b64_tr_b16 v[82:83], v12 offset:8704
    ds_read_b128 v[148:151], v8 offset:16384
    s_waitcnt lgkmcnt(8)
    v_mfma_f32_32x32x16_bf16 v[32:47], v[68:71], v[140:143], v[32:47]
    ds_read_b64_tr_b16 v[84:85], v101 offset:8192
    ds_read_b64_tr_b16 v[86:87], v101 offset:8704
    s_waitcnt lgkmcnt(7)
    v_mfma_f32_32x32x16_bf16 v[16:31], v[72:75], v[144:147], v[16:31]
    ds_read_b64_tr_b16 v[64:65], v13 offset:8192
    ds_read_b64_tr_b16 v[66:67], v13 offset:8704
    ds_read_b128 v[152:155], v9 offset:16384
    s_xor_b32 s35, s30, 3
    s_add_u32 m0, s31, 0
    s_lshl_b32 s28, s35, 7
    buffer_load_dwordx4 v112, s[36:39], s28 offen offset:0 lds
    v_mfma_f32_16x16x32_bf16 v[88:91], a[0:3], v[72:75], v[88:91]
    s_waitcnt lgkmcnt(8)
    v_mfma_f32_32x32x16_bf16 v[32:47], v[76:79], v[144:147], v[32:47]
    ds_read_b64_tr_b16 v[68:69], v102 offset:8192
    ds_read_b64_tr_b16 v[70:71], v102 offset:8704
    buffer_load_dwordx4 v113, s[36:39], s28 offen offset:1024 lds
    buffer_load_dwordx4 v114, s[36:39], s28 offen offset:2048 lds
    buffer_load_dwordx4 v115, s[36:39], s28 offen offset:3072 lds
    s_add_u32 m0, s32, 24576
    v_mfma_f32_16x16x32_bf16 v[92:95], a[0:3], v[76:79], v[92:95]
    s_waitcnt lgkmcnt(7)
    v_mfma_f32_32x32x16_bf16 v[16:31], v[80:83], v[148:151], v[16:31]
    ds_read_b64_tr_b16 v[72:73], v14 offset:8192
    ds_read_b64_tr_b16 v[74:75], v14 offset:8704
    ds_read_b128 v[156:159], v10 offset:16384
    s_mul_i32 s29, s35, 196608
    buffer_load_dwordx4 v116, s[40:43], s29 offen offset:0 lds
    buffer_load_dwordx4 v117, s[40:43], s29 offen offset:1024 lds
    s_waitcnt lgkmcnt(8)
    v_mfma_f32_32x32x16_bf16 v[32:47], v[84:87], v[148:151], v[32:47]
    ds_read_b64_tr_b16 v[76:77], v103 offset:8192
    ds_read_b64_tr_b16 v[78:79], v103 offset:8704
    v_dot2c_f32_bf16 v104, s20, v144
    v_dot2c_f32_bf16 v105, v144, v144
    v_dot2c_f32_bf16 v104, s20, v145
    v_dot2c_f32_bf16 v105, v145, v145
    v_dot2c_f32_bf16 v104, s20, v146
    v_dot2c_f32_bf16 v105, v146, v146
    v_dot2c_f32_bf16 v104, s20, v147
    v_dot2c_f32_bf16 v105, v147, v147
    v_dot2c_f32_bf16 v104, s20, v148
    v_dot2c_f32_bf16 v105, v148, v148
    v_dot2c_f32_bf16 v104, s20, v149
    v_dot2c_f32_bf16 v105, v149, v149
    v_dot2c_f32_bf16 v104, s20, v150
    v_dot2c_f32_bf16 v105, v150, v150
    v_dot2c_f32_bf16 v104, s20, v151
    v_dot2c_f32_bf16 v105, v151, v151
    s_waitcnt lgkmcnt(7)
    v_dot2c_f32_bf16 v104, s20, v152
    v_dot2c_f32_bf16 v105, v152, v152
    v_dot2c_f32_bf16 v104, s20, v153
    v_dot2c_f32_bf16 v105, v153, v153
    v_dot2c_f32_bf16 v104, s20, v154
    v_dot2c_f32_bf16 v105, v154, v154
    v_dot2c_f32_bf16 v104, s20, v155
    v_dot2c_f32_bf16 v105, v155, v155
    s_waitcnt lgkmcnt(2)
    v_dot2c_f32_bf16 v104, s20, v156
    v_dot2c_f32_bf16 v105, v156, v156
    v_dot2c_f32_bf16 v104, s20, v157
    v_dot2c_f32_bf16 v105, v157, v157
    v_dot2c_f32_bf16 v104, s20, v158
    v_dot2c_f32_bf16 v105, v158, v158
    v_dot2c_f32_bf16 v104, s20, v159
    v_dot2c_f32_bf16 v105, v159, v159
    s_waitcnt vmcnt(6)
    v_mfma_f32_32x32x16_bf16 v[16:31], v[64:67], v[152:155], v[16:31]
    ds_read_b64_tr_b16 v[80:81], v11 offset:16384
    ds_read_b64_tr_b16 v[82:83], v11 offset:16896
    ds_read_b128 v[160:163], v7 offset:32768
    v_mfma_f32_32x32x16_bf16 v[32:47], v[68:71], v[152:155], v[32:47]
    ds_read_b64_tr_b16 v[84:85], v100 offset:16384
    ds_read_b64_tr_b16 v[86:87], v100 offset:16896
    v_mfma_f32_32x32x16_bf16 v[16:31], v[72:75], v[156:159], v[16:31]
    s_barrier
    ds_read_b64_tr_b16 v[64:65], v12 offset:16384
    ds_read_b64_tr_b16 v[66:67], v12 offset:16896
    ds_read_b128 v[164:167], v8 offset:32768
    s_waitcnt lgkmcnt(8)
    v_mfma_f32_32x32x16_bf16 v[32:47], v[76:79], v[156:159], v[32:47]
    ds_read_b64_tr_b16 v[68:69], v101 offset:16384
    ds_read_b64_tr_b16 v[70:71], v101 offset:16896
    s_waitcnt lgkmcnt(7)
    v_mfma_f32_32x32x16_bf16 v[16:31], v[80:83], v[160:163], v[16:31]
    ds_read_b64_tr_b16 v[72:73], v13 offset:16384
    ds_read_b64_tr_b16 v[74:75], v13 offset:16896
    ds_read_b128 v[168:171], v9 offset:32768
    s_xor_b32 s35, s30, 4
    s_add_u32 m0, s31, 16384
    s_lshl_b32 s28, s35, 7
    buffer_load_dwordx4 v112, s[36:39], s28 offen offset:0 lds
    v_mfma_f32_16x16x32_bf16 v[88:91], a[0:3], v[80:83], v[88:91]
    s_waitcnt lgkmcnt(8)
    v_mfma_f32_32x32x16_bf16 v[32:47], v[84:87], v[160:163], v[32:47]
    ds_read_b64_tr_b16 v[76:77], v102 offset:16384
    ds_read_b64_tr_b16 v[78:79], v102 offset:16896
    buffer_load_dwordx4 v113, s[36:39], s28 offen offset:1024 lds
    buffer_load_dwordx4 v114, s[36:39], s28 offen offset:2048 lds
    buffer_load_dwordx4 v115, s[36:39], s28 offen offset:3072 lds
    s_add_u32 m0, s32, 32768
    v_mfma_f32_16x16x32_bf16 v[92:95], a[0:3], v[84:87], v[92:95]
    s_waitcnt lgkmcnt(7)
    v_mfma_f32_32x32x16_bf16 v[16:31], v[64:67], v[164:167], v[16:31]
    ds_read_b64_tr_b16 v[80:81], v14 offset:16384
    ds_read_b64_tr_b16 v[82:83], v14 offset:16896
    ds_read_b128 v[172:175], v10 offset:32768
    s_mul_i32 s29, s35, 196608
    buffer_load_dwordx4 v116, s[40:43], s29 offen offset:0 lds
    buffer_load_dwordx4 v117, s[40:43], s29 offen offset:1024 lds
    s_waitcnt lgkmcnt(8)
    v_mfma_f32_32x32x16_bf16 v[32:47], v[68:71], v[164:167], v[32:47]
    ds_read_b64_tr_b16 v[84:85], v103 offset:16384
    ds_read_b64_tr_b16 v[86:87], v103 offset:16896
    s_xor_b32 s35, s30, 1
    s_add_u32 m0, s32, 66560
    s_mul_i32 s29, s35, 196608
    v_dot2c_f32_bf16 v104, s20, v160
    v_dot2c_f32_bf16 v105, v160, v160
    v_dot2c_f32_bf16 v104, s20, v161
    v_dot2c_f32_bf16 v105, v161, v161
    v_dot2c_f32_bf16 v104, s20, v162
    v_dot2c_f32_bf16 v105, v162, v162
    v_dot2c_f32_bf16 v104, s20, v163
    v_dot2c_f32_bf16 v105, v163, v163
    v_dot2c_f32_bf16 v104, s20, v164
    v_dot2c_f32_bf16 v105, v164, v164
    v_dot2c_f32_bf16 v104, s20, v165
    v_dot2c_f32_bf16 v105, v165, v165
    v_dot2c_f32_bf16 v104, s20, v166
    v_dot2c_f32_bf16 v105, v166, v166
    v_dot2c_f32_bf16 v104, s20, v167
    v_dot2c_f32_bf16 v105, v167, v167
    s_waitcnt lgkmcnt(7)
    v_dot2c_f32_bf16 v104, s20, v168
    v_dot2c_f32_bf16 v105, v168, v168
    v_dot2c_f32_bf16 v104, s20, v169
    v_dot2c_f32_bf16 v105, v169, v169
    v_dot2c_f32_bf16 v104, s20, v170
    v_dot2c_f32_bf16 v105, v170, v170
    v_dot2c_f32_bf16 v104, s20, v171
    v_dot2c_f32_bf16 v105, v171, v171
    s_waitcnt lgkmcnt(2)
    v_dot2c_f32_bf16 v104, s20, v172
    v_dot2c_f32_bf16 v105, v172, v172
    v_dot2c_f32_bf16 v104, s20, v173
    v_dot2c_f32_bf16 v105, v173, v173
    v_dot2c_f32_bf16 v104, s20, v174
    v_dot2c_f32_bf16 v105, v174, v174
    v_dot2c_f32_bf16 v104, s20, v175
    v_dot2c_f32_bf16 v105, v175, v175
    s_waitcnt vmcnt(6)
    v_mfma_f32_32x32x16_bf16 v[16:31], v[72:75], v[168:171], v[16:31]
    ds_read_b64_tr_b16 v[64:65], v11 offset:24576
    ds_read_b64_tr_b16 v[66:67], v11 offset:25088
    ds_read_b128 v[176:179], v7 offset:0
    buffer_load_dwordx4 v118, s[40:43], s29 offen lds
    v_mfma_f32_32x32x16_bf16 v[32:47], v[76:79], v[168:171], v[32:47]
    ds_read_b64_tr_b16 v[68:69], v100 offset:24576
    ds_read_b64_tr_b16 v[70:71], v100 offset:25088
    v_mfma_f32_32x32x16_bf16 v[16:31], v[80:83], v[172:175], v[16:31]
    s_barrier
    ds_read_b64_tr_b16 v[72:73], v12 offset:24576
    ds_read_b64_tr_b16 v[74:75], v12 offset:25088
    ds_read_b128 v[180:183], v8 offset:0
    s_waitcnt lgkmcnt(8)
    v_mfma_f32_32x32x16_bf16 v[32:47], v[84:87], v[172:175], v[32:47]
    ds_read_b64_tr_b16 v[76:77], v101 offset:24576
    ds_read_b64_tr_b16 v[78:79], v101 offset:25088
    s_waitcnt lgkmcnt(7)
    v_mfma_f32_32x32x16_bf16 v[16:31], v[64:67], v[176:179], v[16:31]
    ds_read_b64_tr_b16 v[80:81], v13 offset:24576
    ds_read_b64_tr_b16 v[82:83], v13 offset:25088
    ds_read_b128 v[184:187], v9 offset:0
    s_xor_b32 s35, s30, 5
    s_add_u32 m0, s31, 32768
    s_lshl_b32 s28, s35, 7
    buffer_load_dwordx4 v112, s[36:39], s28 offen offset:0 lds
    v_mfma_f32_16x16x32_bf16 v[88:91], a[0:3], v[64:67], v[88:91]
    s_waitcnt lgkmcnt(8)
    v_mfma_f32_32x32x16_bf16 v[32:47], v[68:71], v[176:179], v[32:47]
    ds_read_b64_tr_b16 v[84:85], v102 offset:24576
    ds_read_b64_tr_b16 v[86:87], v102 offset:25088
    buffer_load_dwordx4 v113, s[36:39], s28 offen offset:1024 lds
    buffer_load_dwordx4 v114, s[36:39], s28 offen offset:2048 lds
    buffer_load_dwordx4 v115, s[36:39], s28 offen offset:3072 lds
    s_add_u32 m0, s32, 40960
    v_mfma_f32_16x16x32_bf16 v[92:95], a[0:3], v[68:71], v[92:95]
    s_waitcnt lgkmcnt(7)
    v_mfma_f32_32x32x16_bf16 v[16:31], v[72:75], v[180:183], v[16:31]
    ds_read_b64_tr_b16 v[64:65], v14 offset:24576
    ds_read_b64_tr_b16 v[66:67], v14 offset:25088
    ds_read_b128 v[188:191], v10 offset:0
    s_mul_i32 s29, s35, 196608
    buffer_load_dwordx4 v116, s[40:43], s29 offen offset:0 lds
    buffer_load_dwordx4 v117, s[40:43], s29 offen offset:1024 lds
    s_waitcnt lgkmcnt(8)
    v_mfma_f32_32x32x16_bf16 v[32:47], v[76:79], v[180:183], v[32:47]
    ds_read_b64_tr_b16 v[68:69], v103 offset:24576
    ds_read_b64_tr_b16 v[70:71], v103 offset:25088
    s_xor_b32 s35, s30, 2
    s_add_u32 m0, s32, 73728
    s_mul_i32 s29, s35, 196608
    v_dot2c_f32_bf16 v104, s20, v176
    v_dot2c_f32_bf16 v105, v176, v176
    v_dot2c_f32_bf16 v104, s20, v177
    v_dot2c_f32_bf16 v105, v177, v177
    v_dot2c_f32_bf16 v104, s20, v178
    v_dot2c_f32_bf16 v105, v178, v178
    v_dot2c_f32_bf16 v104, s20, v179
    v_dot2c_f32_bf16 v105, v179, v179
    v_dot2c_f32_bf16 v104, s20, v180
    v_dot2c_f32_bf16 v105, v180, v180
    v_dot2c_f32_bf16 v104, s20, v181
    v_dot2c_f32_bf16 v105, v181, v181
    v_dot2c_f32_bf16 v104, s20, v182
    v_dot2c_f32_bf16 v105, v182, v182
    v_dot2c_f32_bf16 v104, s20, v183
    v_dot2c_f32_bf16 v105, v183, v183
    s_waitcnt lgkmcnt(7)
    v_dot2c_f32_bf16 v104, s20, v184
    v_dot2c_f32_bf16 v105, v184, v184
    v_dot2c_f32_bf16 v104, s20, v185
    v_dot2c_f32_bf16 v105, v185, v185
    v_dot2c_f32_bf16 v104, s20, v186
    v_dot2c_f32_bf16 v105, v186, v186
    v_dot2c_f32_bf16 v104, s20, v187
    v_dot2c_f32_bf16 v105, v187, v187
    s_waitcnt lgkmcnt(2)
    v_dot2c_f32_bf16 v104, s20, v188
    v_dot2c_f32_bf16 v105, v188, v188
    v_dot2c_f32_bf16 v104, s20, v189
    v_dot2c_f32_bf16 v105, v189, v189
    v_dot2c_f32_bf16 v104, s20, v190
    v_dot2c_f32_bf16 v105, v190, v190
    v_dot2c_f32_bf16 v104, s20, v191
    v_dot2c_f32_bf16 v105, v191, v191
    s_waitcnt vmcnt(7)
    v_mfma_f32_32x32x16_bf16 v[16:31], v[80:83], v[184:187], v[16:31]
    ds_read_b64_tr_b16 v[72:73], v11 offset:32768
    ds_read_b64_tr_b16 v[74:75], v11 offset:33280
    ds_read_b128 v[192:195], v7 offset:16384
    buffer_load_dwordx4 v118, s[40:43], s29 offen lds
    v_mfma_f32_32x32x16_bf16 v[32:47], v[84:87], v[184:187], v[32:47]
    ds_read_b64_tr_b16 v[76:77], v100 offset:32768
    ds_read_b64_tr_b16 v[78:79], v100 offset:33280
    v_mfma_f32_32x32x16_bf16 v[16:31], v[64:67], v[188:191], v[16:31]
    s_barrier
    ds_read_b64_tr_b16 v[80:81], v12 offset:32768
    ds_read_b64_tr_b16 v[82:83], v12 offset:33280
    ds_read_b128 v[196:199], v8 offset:16384
    s_waitcnt lgkmcnt(8)
    v_mfma_f32_32x32x16_bf16 v[32:47], v[68:71], v[188:191], v[32:47]
    ds_read_b64_tr_b16 v[84:85], v101 offset:32768
    ds_read_b64_tr_b16 v[86:87], v101 offset:33280
    s_waitcnt lgkmcnt(7)
    v_mfma_f32_32x32x16_bf16 v[16:31], v[72:75], v[192:195], v[16:31]
    ds_read_b64_tr_b16 v[64:65], v13 offset:32768
    ds_read_b64_tr_b16 v[66:67], v13 offset:33280
    ds_read_b128 v[200:203], v9 offset:16384
    s_xor_b32 s35, s30, 6
    s_add_u32 m0, s31, 0
    s_lshl_b32 s28, s35, 7
    buffer_load_dwordx4 v112, s[36:39], s28 offen offset:0 lds
    v_mfma_f32_16x16x32_bf16 v[88:91], a[0:3], v[72:75], v[88:91]
    s_waitcnt lgkmcnt(8)
    v_mfma_f32_32x32x16_bf16 v[32:47], v[76:79], v[192:195], v[32:47]
    ds_read_b64_tr_b16 v[68:69], v102 offset:32768
    ds_read_b64_tr_b16 v[70:71], v102 offset:33280
    buffer_load_dwordx4 v113, s[36:39], s28 offen offset:1024 lds
    buffer_load_dwordx4 v114, s[36:39], s28 offen offset:2048 lds
    buffer_load_dwordx4 v115, s[36:39], s28 offen offset:3072 lds
    s_add_u32 m0, s32, 49152
    v_mfma_f32_16x16x32_bf16 v[92:95], a[0:3], v[76:79], v[92:95]
    s_waitcnt lgkmcnt(7)
    v_mfma_f32_32x32x16_bf16 v[16:31], v[80:83], v[196:199], v[16:31]
    ds_read_b64_tr_b16 v[72:73], v14 offset:32768
    ds_read_b64_tr_b16 v[74:75], v14 offset:33280
    ds_read_b128 v[204:207], v10 offset:16384
    s_mul_i32 s29, s35, 196608
    buffer_load_dwordx4 v116, s[40:43], s29 offen offset:0 lds
    buffer_load_dwordx4 v117, s[40:43], s29 offen offset:1024 lds
    s_waitcnt lgkmcnt(8)
    v_mfma_f32_32x32x16_bf16 v[32:47], v[84:87], v[196:199], v[32:47]
    ds_read_b64_tr_b16 v[76:77], v103 offset:32768
    ds_read_b64_tr_b16 v[78:79], v103 offset:33280
    s_xor_b32 s35, s30, 3
    s_add_u32 m0, s32, 74752
    s_mul_i32 s29, s35, 196608
    v_dot2c_f32_bf16 v104, s20, v192
    v_dot2c_f32_bf16 v105, v192, v192
    v_dot2c_f32_bf16 v104, s20, v193
    v_dot2c_f32_bf16 v105, v193, v193
    v_dot2c_f32_bf16 v104, s20, v194
    v_dot2c_f32_bf16 v105, v194, v194
    v_dot2c_f32_bf16 v104, s20, v195
    v_dot2c_f32_bf16 v105, v195, v195
    v_dot2c_f32_bf16 v104, s20, v196
    v_dot2c_f32_bf16 v105, v196, v196
    v_dot2c_f32_bf16 v104, s20, v197
    v_dot2c_f32_bf16 v105, v197, v197
    v_dot2c_f32_bf16 v104, s20, v198
    v_dot2c_f32_bf16 v105, v198, v198
    v_dot2c_f32_bf16 v104, s20, v199
    v_dot2c_f32_bf16 v105, v199, v199
    s_waitcnt lgkmcnt(7)
    v_dot2c_f32_bf16 v104, s20, v200
    v_dot2c_f32_bf16 v105, v200, v200
    v_dot2c_f32_bf16 v104, s20, v201
    v_dot2c_f32_bf16 v105, v201, v201
    v_dot2c_f32_bf16 v104, s20, v202
    v_dot2c_f32_bf16 v105, v202, v202
    v_dot2c_f32_bf16 v104, s20, v203
    v_dot2c_f32_bf16 v105, v203, v203
    s_waitcnt lgkmcnt(2)
    v_dot2c_f32_bf16 v104, s20, v204
    v_dot2c_f32_bf16 v105, v204, v204
    v_dot2c_f32_bf16 v104, s20, v205
    v_dot2c_f32_bf16 v105, v205, v205
    v_dot2c_f32_bf16 v104, s20, v206
    v_dot2c_f32_bf16 v105, v206, v206
    v_dot2c_f32_bf16 v104, s20, v207
    v_dot2c_f32_bf16 v105, v207, v207
    s_waitcnt vmcnt(7)
    v_mfma_f32_32x32x16_bf16 v[16:31], v[64:67], v[200:203], v[16:31]
    ds_read_b64_tr_b16 v[80:81], v11 offset:40960
    ds_read_b64_tr_b16 v[82:83], v11 offset:41472
    ds_read_b128 v[208:211], v7 offset:32768
    buffer_load_dwordx4 v118, s[40:43], s29 offen lds
    v_mfma_f32_32x32x16_bf16 v[32:47], v[68:71], v[200:203], v[32:47]
    ds_read_b64_tr_b16 v[84:85], v100 offset:40960
    ds_read_b64_tr_b16 v[86:87], v100 offset:41472
    v_mfma_f32_32x32x16_bf16 v[16:31], v[72:75], v[204:207], v[16:31]
    s_barrier
    ds_read_b64_tr_b16 v[64:65], v12 offset:40960
    ds_read_b64_tr_b16 v[66:67], v12 offset:41472
    ds_read_b128 v[212:215], v8 offset:32768
    s_waitcnt lgkmcnt(8)
    v_mfma_f32_32x32x16_bf16 v[32:47], v[76:79], v[204:207], v[32:47]
    ds_read_b64_tr_b16 v[68:69], v101 offset:40960
    ds_read_b64_tr_b16 v[70:71], v101 offset:41472
    s_waitcnt lgkmcnt(7)
    v_mfma_f32_32x32x16_bf16 v[16:31], v[80:83], v[208:211], v[16:31]
    ds_read_b64_tr_b16 v[72:73], v13 offset:40960
    ds_read_b64_tr_b16 v[74:75], v13 offset:41472
    ds_read_b128 v[216:219], v9 offset:32768
    s_xor_b32 s35, s30, 7
    s_add_u32 m0, s31, 16384
    s_lshl_b32 s28, s35, 7
    buffer_load_dwordx4 v112, s[36:39], s28 offen offset:0 lds
    v_mfma_f32_16x16x32_bf16 v[88:91], a[0:3], v[80:83], v[88:91]
    s_waitcnt lgkmcnt(8)
    v_mfma_f32_32x32x16_bf16 v[32:47], v[84:87], v[208:211], v[32:47]
    ds_read_b64_tr_b16 v[76:77], v102 offset:40960
    ds_read_b64_tr_b16 v[78:79], v102 offset:41472
    buffer_load_dwordx4 v113, s[36:39], s28 offen offset:1024 lds
    buffer_load_dwordx4 v114, s[36:39], s28 offen offset:2048 lds
    buffer_load_dwordx4 v115, s[36:39], s28 offen offset:3072 lds
    s_add_u32 m0, s32, 57344
    v_mfma_f32_16x16x32_bf16 v[92:95], a[0:3], v[84:87], v[92:95]
    s_waitcnt lgkmcnt(7)
    v_mfma_f32_32x32x16_bf16 v[16:31], v[64:67], v[212:215], v[16:31]
    ds_read_b64_tr_b16 v[80:81], v14 offset:40960
    ds_read_b64_tr_b16 v[82:83], v14 offset:41472
    ds_read_b128 v[220:223], v10 offset:32768
    s_mul_i32 s29, s35, 196608
    buffer_load_dwordx4 v116, s[40:43], s29 offen offset:0 lds
    buffer_load_dwordx4 v117, s[40:43], s29 offen offset:1024 lds
    s_waitcnt lgkmcnt(8)
    v_mfma_f32_32x32x16_bf16 v[32:47], v[68:71], v[212:215], v[32:47]
    ds_read_b64_tr_b16 v[84:85], v103 offset:40960
    ds_read_b64_tr_b16 v[86:87], v103 offset:41472
    global_load_dword v122, v123, s[10:11] sc1
    v_dot2c_f32_bf16 v104, s20, v208
    v_dot2c_f32_bf16 v105, v208, v208
    v_dot2c_f32_bf16 v104, s20, v209
    v_dot2c_f32_bf16 v105, v209, v209
    v_dot2c_f32_bf16 v104, s20, v210
    v_dot2c_f32_bf16 v105, v210, v210
    v_dot2c_f32_bf16 v104, s20, v211
    v_dot2c_f32_bf16 v105, v211, v211
    v_dot2c_f32_bf16 v104, s20, v212
    v_dot2c_f32_bf16 v105, v212, v212
    v_dot2c_f32_bf16 v104, s20, v213
    v_dot2c_f32_bf16 v105, v213, v213
    v_dot2c_f32_bf16 v104, s20, v214
    v_dot2c_f32_bf16 v105, v214, v214
    v_dot2c_f32_bf16 v104, s20, v215
    v_dot2c_f32_bf16 v105, v215, v215
    s_waitcnt lgkmcnt(7)
    v_dot2c_f32_bf16 v104, s20, v216
    v_dot2c_f32_bf16 v105, v216, v216
    v_dot2c_f32_bf16 v104, s20, v217
    v_dot2c_f32_bf16 v105, v217, v217
    v_dot2c_f32_bf16 v104, s20, v218
    v_dot2c_f32_bf16 v105, v218, v218
    v_dot2c_f32_bf16 v104, s20, v219
    v_dot2c_f32_bf16 v105, v219, v219
    s_waitcnt lgkmcnt(2)
    v_dot2c_f32_bf16 v104, s20, v220
    v_dot2c_f32_bf16 v105, v220, v220
    v_dot2c_f32_bf16 v104, s20, v221
    v_dot2c_f32_bf16 v105, v221, v221
    v_dot2c_f32_bf16 v104, s20, v222
    v_dot2c_f32_bf16 v105, v222, v222
    v_dot2c_f32_bf16 v104, s20, v223
    v_dot2c_f32_bf16 v105, v223, v223
    s_waitcnt vmcnt(8)
    v_mfma_f32_32x32x16_bf16 v[16:31], v[72:75], v[216:219], v[16:31]
    ds_read_b64_tr_b16 v[64:65], v11 offset:49152
    ds_read_b64_tr_b16 v[66:67], v11 offset:49664
    ds_read_b128 v[224:227], v7 offset:0
    v_mfma_f32_32x32x16_bf16 v[32:47], v[76:79], v[216:219], v[32:47]
    ds_read_b64_tr_b16 v[68:69], v100 offset:49152
    ds_read_b64_tr_b16 v[70:71], v100 offset:49664
    v_mfma_f32_32x32x16_bf16 v[16:31], v[80:83], v[220:223], v[16:31]
    s_barrier
    ds_read_b64_tr_b16 v[72:73], v12 offset:49152
    ds_read_b64_tr_b16 v[74:75], v12 offset:49664
    ds_read_b128 v[228:231], v8 offset:0
    s_waitcnt lgkmcnt(8)
    v_mfma_f32_32x32x16_bf16 v[32:47], v[84:87], v[220:223], v[32:47]
    ds_read_b64_tr_b16 v[76:77], v101 offset:49152
    ds_read_b64_tr_b16 v[78:79], v101 offset:49664
    s_waitcnt lgkmcnt(7)
    v_mfma_f32_32x32x16_bf16 v[16:31], v[64:67], v[224:227], v[16:31]
    ds_read_b64_tr_b16 v[80:81], v13 offset:49152
    ds_read_b64_tr_b16 v[82:83], v13 offset:49664
    ds_read_b128 v[232:235], v9 offset:0
    s_xor_b32 s35, s30, 4
    s_add_u32 m0, s32, 81920
    s_mul_i32 s29, s35, 196608
    buffer_load_dwordx4 v118, s[40:43], s29 offen lds
    v_mfma_f32_16x16x32_bf16 v[88:91], a[0:3], v[64:67], v[88:91]
    s_waitcnt lgkmcnt(8)
    v_mfma_f32_32x32x16_bf16 v[32:47], v[68:71], v[224:227], v[32:47]
    ds_read_b64_tr_b16 v[84:85], v102 offset:49152
    ds_read_b64_tr_b16 v[86:87], v102 offset:49664
    s_xor_b32 s35, s30, 5
    s_add_u32 m0, s32, 82944
    s_mul_i32 s29, s35, 196608
    buffer_load_dwordx4 v118, s[40:43], s29 offen lds
    v_mfma_f32_16x16x32_bf16 v[92:95], a[0:3], v[68:71], v[92:95]
    s_waitcnt lgkmcnt(7)
    v_mfma_f32_32x32x16_bf16 v[16:31], v[72:75], v[228:231], v[16:31]
    ds_read_b64_tr_b16 v[64:65], v14 offset:49152
    ds_read_b64_tr_b16 v[66:67], v14 offset:49664
    ds_read_b128 v[236:239], v10 offset:0
    s_xor_b32 s35, s30, 6
    s_add_u32 m0, s32, 90112
    s_mul_i32 s29, s35, 196608
    s_waitcnt lgkmcnt(8)
    v_mfma_f32_32x32x16_bf16 v[32:47], v[76:79], v[228:231], v[32:47]
    ds_read_b64_tr_b16 v[68:69], v103 offset:49152
    ds_read_b64_tr_b16 v[70:71], v103 offset:49664
    buffer_load_dwordx4 v118, s[40:43], s29 offen lds
    s_xor_b32 s35, s30, 7
    s_add_u32 m0, s32, 91136
    v_dot2c_f32_bf16 v104, s20, v224
    v_dot2c_f32_bf16 v105, v224, v224
    v_dot2c_f32_bf16 v104, s20, v225
    v_dot2c_f32_bf16 v105, v225, v225
    v_dot2c_f32_bf16 v104, s20, v226
    v_dot2c_f32_bf16 v105, v226, v226
    v_dot2c_f32_bf16 v104, s20, v227
    v_dot2c_f32_bf16 v105, v227, v227
    v_dot2c_f32_bf16 v104, s20, v228
    v_dot2c_f32_bf16 v105, v228, v228
    v_dot2c_f32_bf16 v104, s20, v229
    v_dot2c_f32_bf16 v105, v229, v229
    v_dot2c_f32_bf16 v104, s20, v230
    v_dot2c_f32_bf16 v105, v230, v230
    v_dot2c_f32_bf16 v104, s20, v231
    v_dot2c_f32_bf16 v105, v231, v231
    s_waitcnt lgkmcnt(7)
    v_dot2c_f32_bf16 v104, s20, v232
    v_dot2c_f32_bf16 v105, v232, v232
    v_dot2c_f32_bf16 v104, s20, v233
    v_dot2c_f32_bf16 v105, v233, v233
    v_dot2c_f32_bf16 v104, s20, v234
    v_dot2c_f32_bf16 v105, v234, v234
    v_dot2c_f32_bf16 v104, s20, v235
    v_dot2c_f32_bf16 v105, v235, v235
    s_waitcnt lgkmcnt(2)
    v_dot2c_f32_bf16 v104, s20, v236
    v_dot2c_f32_bf16 v105, v236, v236
    v_dot2c_f32_bf16 v104, s20, v237
    v_dot2c_f32_bf16 v105, v237, v237
    v_dot2c_f32_bf16 v104, s20, v238
    v_dot2c_f32_bf16 v105, v238, v238
    v_dot2c_f32_bf16 v104, s20, v239
    v_dot2c_f32_bf16 v105, v239, v239
    s_waitcnt vmcnt(4)
    v_mfma_f32_32x32x16_bf16 v[16:31], v[80:83], v[232:235], v[16:31]
    ds_read_b64_tr_b16 v[72:73], v11 offset:57344
    ds_read_b64_tr_b16 v[74:75], v11 offset:57856
    ds_read_b128 v[240:243], v7 offset:16384
    s_mul_i32 s29, s35, 196608
    buffer_load_dwordx4 v118, s[40:43], s29 offen lds
    v_mfma_f32_32x32x16_bf16 v[32:47], v[84:87], v[232:235], v[32:47]
    ds_read_b64_tr_b16 v[76:77], v100 offset:57344
    ds_read_b64_tr_b16 v[78:79], v100 offset:57856
    ds_read_b128 v[244:247], v8 offset:16384
    v_mfma_f32_32x32x16_bf16 v[16:31], v[64:67], v[236:239], v[16:31]
    s_barrier
    ds_read_b64_tr_b16 v[80:81], v12 offset:57344
    ds_read_b64_tr_b16 v[82:83], v12 offset:57856
    ds_read_b128 v[248:251], v9 offset:16384
    s_waitcnt lgkmcnt(9)
    v_mfma_f32_32x32x16_bf16 v[32:47], v[68:71], v[236:239], v[32:47]
    ds_read_b64_tr_b16 v[84:85], v101 offset:57344
    ds_read_b64_tr_b16 v[86:87], v101 offset:57856
    ds_read_b128 v[252:255], v10 offset:16384
    s_waitcnt lgkmcnt(9)
    v_mfma_f32_32x32x16_bf16 v[16:31], v[72:75], v[240:243], v[16:31]
    ds_read_b64_tr_b16 v[64:65], v13 offset:57344
    ds_read_b64_tr_b16 v[66:67], v13 offset:57856
    v_mfma_f32_16x16x32_bf16 v[88:91], a[0:3], v[72:75], v[88:91]
    s_waitcnt lgkmcnt(9)
    v_mfma_f32_32x32x16_bf16 v[32:47], v[76:79], v[240:243], v[32:47]
    ds_read_b64_tr_b16 v[68:69], v102 offset:57344
    ds_read_b64_tr_b16 v[70:71], v102 offset:57856
    v_mfma_f32_16x16x32_bf16 v[92:95], a[0:3], v[76:79], v[92:95]
    v_dot2c_f32_bf16 v104, s20, v240
    v_dot2c_f32_bf16 v105, v240, v240
    v_dot2c_f32_bf16 v104, s20, v241
    v_dot2c_f32_bf16 v105, v241, v241
    v_dot2c_f32_bf16 v104, s20, v242
    v_dot2c_f32_bf16 v105, v242, v242
    v_dot2c_f32_bf16 v104, s20, v243
    v_dot2c_f32_bf16 v105, v243, v243
    s_waitcnt lgkmcnt(10)
    v_dot2c_f32_bf16 v104, s20, v244
    v_dot2c_f32_bf16 v105, v244, v244
    v_dot2c_f32_bf16 v104, s20, v245
    v_dot2c_f32_bf16 v105, v245, v245
    v_dot2c_f32_bf16 v104, s20, v246
    v_dot2c_f32_bf16 v105, v246, v246
    v_dot2c_f32_bf16 v104, s20, v247
    v_dot2c_f32_bf16 v105, v247, v247
    s_waitcnt lgkmcnt(7)
    v_dot2c_f32_bf16 v104, s20, v248
    v_dot2c_f32_bf16 v105, v248, v248
    v_dot2c_f32_bf16 v104, s20, v249
    v_dot2c_f32_bf16 v105, v249, v249
    v_dot2c_f32_bf16 v104, s20, v250
    v_dot2c_f32_bf16 v105, v250, v250
    v_dot2c_f32_bf16 v104, s20, v251
    v_dot2c_f32_bf16 v105, v251, v251
    s_waitcnt lgkmcnt(4)
    v_dot2c_f32_bf16 v104, s20, v252
    v_dot2c_f32_bf16 v105, v252, v252
    v_dot2c_f32_bf16 v104, s20, v253
    v_dot2c_f32_bf16 v105, v253, v253
    v_dot2c_f32_bf16 v104, s20, v254
    v_dot2c_f32_bf16 v105, v254, v254
    v_dot2c_f32_bf16 v104, s20, v255
    v_dot2c_f32_bf16 v105, v255, v255
    v_mfma_f32_32x32x16_bf16 v[16:31], v[80:83], v[244:247], v[16:31]
    ds_read_b64_tr_b16 v[72:73], v14 offset:57344
    ds_read_b64_tr_b16 v[74:75], v14 offset:57856
    v_permlane32_swap_b32 v104, v105
    v_add_f32 v104, v104, v105
    v_mov_b32 v105, v104
    s_nop 1
    v_permlane32_swap_b32 v104, v105
    v_mfma_f32_32x32x16_bf16 v[32:47], v[84:87], v[244:247], v[32:47]
    v_cndmask_b32 v112, v88, v92, vcc
    ds_write_b32 v107, v112
    ds_read_b64_tr_b16 v[76:77], v103 offset:57344
    ds_read_b64_tr_b16 v[78:79], v103 offset:57856
    v_mul_f32 v104, 0xbb000000, v104
    v_mul_f32 v105, 0x3b000000, v105
    v_fma_f32 v105, -v104, v104, v105
    v_cvt_pk_bf16_f32 v108, v104, v104
    s_waitcnt lgkmcnt(7)
    v_mfma_f32_32x32x16_bf16 v[16:31], v[64:67], v[248:251], v[16:31]
    s_waitcnt lgkmcnt(2)
    s_barrier
    ds_read_b128 v[116:119], v5 offset:512
    ds_read_b128 v[112:115], v5
    v_add_u32 v11, v4, v11
    ds_read_b64_tr_b16 v[80:81], v11 offset:0
    ds_read_b64_tr_b16 v[82:83], v11 offset:256
    v_max_f32 v105, 0, v105
    v_and_b32 v108, 0xffff0000, v108
    v_add_f32 v105, 0x3727c5ac, v105
    v_sub_f32 v108, v104, v108
    v_mfma_f32_32x32x16_bf16 v[32:47], v[68:71], v[248:251], v[32:47]
    ds_read_b64_tr_b16 v[84:85], v11 offset:1024
    ds_read_b64_tr_b16 v[86:87], v11 offset:1280
    v_rsq_f32 v105, v105
    v_cvt_pk_bf16_f32 v108, v104, v108
    v_add_u32 v12, v4, v12
    v_add_u32 v13, v4, v13
    v_mfma_f32_32x32x16_bf16 v[16:31], v[72:75], v[252:255], v[16:31]
    ds_read_b64_tr_b16 v[64:65], v11 offset:8192
    ds_read_b64_tr_b16 v[66:67], v11 offset:8448
    v_add_u32 v14, v4, v14
    s_waitcnt vmcnt(4)
    v_cmp_gt_u32 vcc, 8, v122
    s_cbranch_vccnz k2_L_1S
k2_L_1B:
    global_load_dword a8, v0, s[6:7] sc1
    s_waitcnt lgkmcnt(8)
    v_mfma_f32_32x32x16_bf16 v[32:47], v[76:79], v[252:255], v[32:47]
    ds_read_b64_tr_b16 v[68:69], v11 offset:9216
    ds_read_b64_tr_b16 v[70:71], v11 offset:9472
    s_waitcnt lgkmcnt(8)
    v_add_f32 v116, v116, v117
    v_add_f32 v112, v112, v113
    v_add_f32 v118, v118, v119
    s_waitcnt lgkmcnt(6)
    v_mfma_f32_32x32x16_bf16 v[48:63], v[128:131], v[80:83], 0
    ds_read_b64_tr_b16 v[72:73], v12 offset:0
    ds_read_b64_tr_b16 v[74:75], v12 offset:256
    v_add_f32 v114, v114, v115
    v_add_f32 v92, v116, v118
    v_add_f32 v88, v112, v114
    v_cvt_pk_bf16_f32 v93, v92, v92
    v_cvt_pk_bf16_f32 v89, v88, v88
    v_and_b32 v93, v93, v106
    v_and_b32 v89, v89, v106
    v_sub_f32 v92, v92, v93
    v_sub_f32 v88, v88, v89
    v_mov_b32 v93, 0
    v_mov_b32 v89, 0
    v_cvt_pk_bf16_f32 v92, v92, v92
    v_cvt_pk_bf16_f32 v88, v88, v88
    v_mfma_f32_16x16x32_bf16 v[96:99], a[0:3], v[80:83], 0
    v_mfma_f32_32x32x16_bf16 v[32:47], v[92:95], v[108:111], v[32:47]
    v_mfma_f32_32x32x16_bf16 v[16:31], v[88:91], v[108:111], v[16:31]
    s_lshl_b32 s35, s3, 7
    v_and_b32 v112, 31, v1
    s_add_u32 s35, s35, 133120
    v_lshrrev_b32 v113, 5, v1
    s_waitcnt lgkmcnt(6)
    v_mfma_f32_32x32x16_bf16 v[48:63], v[144:147], v[84:87], v[48:63]
    ds_read_b64_tr_b16 v[76:77], v13 offset:0
    ds_read_b64_tr_b16 v[78:79], v13 offset:256
    v_lshl_add_u32 v112, v112, 2, s35
    v_lshl_add_u32 v104, v113, 4, s35
    ds_write_b32 v112, v105
    ds_read_b128 v[112:115], v104 offset:0
    ds_read_b128 v[116:119], v104 offset:32
    ds_read_b128 v[120:123], v104 offset:64
    v_mfma_f32_16x16x32_bf16 v[96:99], a[0:3], v[84:87], v[96:99]
    s_waitcnt lgkmcnt(10)
    v_mfma_f32_32x32x16_bf16 v[48:63], v[160:163], v[64:67], v[48:63]
    ds_read_b64_tr_b16 v[80:81], v14 offset:0
    ds_read_b64_tr_b16 v[82:83], v14 offset:256
    ds_read_b128 v[124:127], v104 offset:96
    v_mul_f32 v104, s33, v105
    v_mul_f32 v32, v104, v32
    v_mul_f32 v33, v104, v33
    v_mul_f32 v34, v104, v34
    v_mul_f32 v35, v104, v35
    v_mfma_f32_16x16x32_bf16 v[96:99], a[0:3], v[64:67], v[96:99]
    s_waitcnt lgkmcnt(11)
    v_mfma_f32_32x32x16_bf16 v[48:63], v[176:179], v[68:71], v[48:63]
    ds_read_b64_tr_b16 v[84:85], v12 offset:1024
    ds_read_b64_tr_b16 v[86:87], v12 offset:1280
    v_mul_f32 v36, v104, v36
    v_mul_f32 v37, v104, v37
    v_mul_f32 v38, v104, v38
    v_mul_f32 v39, v104, v39
    v_cvt_pk_bf16_f32 v32, v32, v33
    v_cvt_pk_bf16_f32 v33, v34, v35
    v_mfma_f32_16x16x32_bf16 v[96:99], a[0:3], v[68:71], v[96:99]
    s_waitcnt lgkmcnt(11)
    v_mfma_f32_32x32x16_bf16 v[48:63], v[132:135], v[72:75], v[48:63]
    ds_read_b64_tr_b16 v[64:65], v13 offset:1024
    ds_read_b64_tr_b16 v[66:67], v13 offset:1280
    v_cvt_pk_bf16_f32 v34, v36, v37
    v_cvt_pk_bf16_f32 v35, v38, v39
    buffer_store_dwordx4 v[32:35], v2, s[44:47], s16 offen sc0 sc1
    s_waitcnt lgkmcnt(11)
    v_mfma_f32_32x32x16_bf16 v[48:63], v[136:139], v[76:79], v[48:63]
    ds_read_b64_tr_b16 v[68:69], v14 offset:1024
    ds_read_b64_tr_b16 v[70:71], v14 offset:1280
    v_mul_f32 v40, v104, v40
    v_mul_f32 v41, v104, v41
    v_mul_f32 v42, v104, v42
    v_mul_f32 v43, v104, v43
    s_waitcnt lgkmcnt(7)
    v_mfma_f32_32x32x16_bf16 v[48:63], v[140:143], v[80:83], v[48:63]
    s_waitcnt vmcnt(2)
    ds_read_b64_tr_b16 v[72:73], v11 offset:16384
    ds_read_b64_tr_b16 v[74:75], v11 offset:16640
    v_mul_f32 v44, v104, v44
    v_mul_f32 v45, v104, v45
    v_mul_f32 v46, v104, v46
    v_mul_f32 v47, v104, v47
    s_waitcnt lgkmcnt(6)
    v_mfma_f32_32x32x16_bf16 v[48:63], v[148:151], v[84:87], v[48:63]
    ds_read_b64_tr_b16 v[76:77], v11 offset:17408
    ds_read_b64_tr_b16 v[78:79], v11 offset:17664
    v_cvt_pk_bf16_f32 v40, v40, v41
    v_cvt_pk_bf16_f32 v41, v42, v43
    v_cvt_pk_bf16_f32 v42, v44, v45
    v_cvt_pk_bf16_f32 v43, v46, v47
    s_waitcnt lgkmcnt(6)
    v_mfma_f32_32x32x16_bf16 v[48:63], v[152:155], v[64:67], v[48:63]
    ds_read_b64_tr_b16 v[80:81], v11 offset:24576
    ds_read_b64_tr_b16 v[82:83], v11 offset:24832
    buffer_store_dwordx4 v[40:43], v2, s[44:47], s17 offen sc0 sc1
    s_waitcnt lgkmcnt(6)
    v_mfma_f32_32x32x16_bf16 v[48:63], v[156:159], v[68:71], v[48:63]
    ds_read_b64_tr_b16 v[84:85], v11 offset:25600
    ds_read_b64_tr_b16 v[86:87], v11 offset:25856
    v_mul_f32 v16, v104, v16
    v_mul_f32 v17, v104, v17
    v_mul_f32 v18, v104, v18
    v_mul_f32 v19, v104, v19
    s_waitcnt lgkmcnt(6)
    v_mfma_f32_32x32x16_bf16 v[48:63], v[192:195], v[72:75], v[48:63]
    ds_read_b64_tr_b16 v[64:65], v12 offset:8192
    ds_read_b64_tr_b16 v[66:67], v12 offset:8448
    v_mul_f32 v20, v104, v20
    v_mul_f32 v21, v104, v21
    v_mul_f32 v22, v104, v22
    v_mul_f32 v23, v104, v23
    v_cvt_pk_bf16_f32 v16, v16, v17
    v_cvt_pk_bf16_f32 v17, v18, v19
    v_mfma_f32_16x16x32_bf16 v[96:99], a[0:3], v[72:75], v[96:99]
    s_waitcnt lgkmcnt(6)
    v_mfma_f32_32x32x16_bf16 v[48:63], v[208:211], v[76:79], v[48:63]
    ds_read_b64_tr_b16 v[68:69], v13 offset:8192
    ds_read_b64_tr_b16 v[70:71], v13 offset:8448
    v_cvt_pk_bf16_f32 v18, v20, v21
    v_cvt_pk_bf16_f32 v19, v22, v23
    buffer_store_dwordx4 v[16:19], v2, s[44:47], s14 offen sc0 sc1
    v_mfma_f32_16x16x32_bf16 v[96:99], a[0:3], v[76:79], v[96:99]
    s_waitcnt lgkmcnt(6)
    v_mfma_f32_32x32x16_bf16 v[48:63], v[224:227], v[80:83], v[48:63]
    ds_read_b64_tr_b16 v[72:73], v14 offset:8192
    ds_read_b64_tr_b16 v[74:75], v14 offset:8448
    v_mul_f32 v24, v104, v24
    v_mul_f32 v25, v104, v25
    v_mul_f32 v26, v104, v26
    v_mul_f32 v27, v104, v27
    v_mul_f32 v28, v104, v28
    v_mul_f32 v29, v104, v29
    v_mfma_f32_16x16x32_bf16 v[96:99], a[0:3], v[80:83], v[96:99]
    s_waitcnt lgkmcnt(6)
    v_mfma_f32_32x32x16_bf16 v[48:63], v[240:243], v[84:87], v[48:63]
    ds_read_b64_tr_b16 v[76:77], v12 offset:9216
    ds_read_b64_tr_b16 v[78:79], v12 offset:9472
    v_mul_f32 v30, v104, v30
    v_mul_f32 v31, v104, v31
    v_cvt_pk_bf16_f32 v24, v24, v25
    v_cvt_pk_bf16_f32 v25, v26, v27
    v_cvt_pk_bf16_f32 v26, v28, v29
    v_cvt_pk_bf16_f32 v27, v30, v31
    v_mfma_f32_16x16x32_bf16 v[96:99], a[0:3], v[84:87], v[96:99]
    s_waitcnt lgkmcnt(6)
    v_mfma_f32_32x32x16_bf16 v[48:63], v[164:167], v[64:67], v[48:63]
    s_nop 5
    ds_write_b32 v107, v96 offset:1024
    ds_read_b64_tr_b16 v[80:81], v13 offset:9216
    ds_read_b64_tr_b16 v[82:83], v13 offset:9472
    buffer_store_dwordx4 v[24:27], v2, s[44:47], s15 offen sc0 sc1
    s_waitcnt lgkmcnt(7)
    v_mfma_f32_32x32x16_bf16 v[48:63], v[168:171], v[68:71], v[48:63]
    ds_read_b64_tr_b16 v[84:85], v14 offset:9216
    ds_read_b64_tr_b16 v[86:87], v14 offset:9472
    s_waitcnt lgkmcnt(7)
    v_mfma_f32_32x32x16_bf16 v[48:63], v[172:175], v[72:75], v[48:63]
    s_waitcnt lgkmcnt(4)
    s_barrier
    ds_read_b128 v[88:91], v5 offset:1024
    ds_read_b64_tr_b16 v[64:65], v12 offset:16384
    ds_read_b64_tr_b16 v[66:67], v12 offset:16640
    v_mfma_f32_32x32x16_bf16 v[48:63], v[180:183], v[76:79], v[48:63]
    ds_read_b64_tr_b16 v[68:69], v13 offset:16384
    ds_read_b64_tr_b16 v[70:71], v13 offset:16640
    s_waitcnt lgkmcnt(7)
    v_mfma_f32_32x32x16_bf16 v[48:63], v[184:187], v[80:83], v[48:63]
    ds_read_b64_tr_b16 v[72:73], v14 offset:16384
    ds_read_b64_tr_b16 v[74:75], v14 offset:16640
    s_waitcnt lgkmcnt(7)
    v_mfma_f32_32x32x16_bf16 v[48:63], v[188:191], v[84:87], v[48:63]
    ds_read_b64_tr_b16 v[76:77], v12 offset:17408
    ds_read_b64_tr_b16 v[78:79], v12 offset:17664
    s_waitcnt lgkmcnt(8)
    v_add_f32 v88, v88, v89
    v_add_f32 v90, v90, v91
    v_add_f32 v96, v88, v90
    s_waitcnt lgkmcnt(6)
    v_mfma_f32_32x32x16_bf16 v[48:63], v[196:199], v[64:67], v[48:63]
    ds_read_b64_tr_b16 v[80:81], v13 offset:17408
    ds_read_b64_tr_b16 v[82:83], v13 offset:17664
    v_cvt_pk_bf16_f32 v97, v96, v96
    v_and_b32 v97, v97, v106
    v_sub_f32 v96, v96, v97
    v_mov_b32 v97, 0
    s_waitcnt lgkmcnt(6)
    v_mfma_f32_32x32x16_bf16 v[48:63], v[200:203], v[68:71], v[48:63]
    ds_read_b64_tr_b16 v[84:85], v14 offset:17408
    ds_read_b64_tr_b16 v[86:87], v14 offset:17664
    v_cvt_pk_bf16_f32 v96, v96, v96
    s_nop 1
    v_mfma_f32_32x32x16_bf16 v[48:63], v[108:111], v[96:99], v[48:63]
    s_waitcnt lgkmcnt(6)
    v_mfma_f32_32x32x16_bf16 v[48:63], v[204:207], v[72:75], v[48:63]
    ds_read_b64_tr_b16 v[64:65], v12 offset:24576
    ds_read_b64_tr_b16 v[66:67], v12 offset:24832
    s_waitcnt lgkmcnt(6)
    v_mfma_f32_32x32x16_bf16 v[48:63], v[212:215], v[76:79], v[48:63]
    ds_read_b64_tr_b16 v[68:69], v13 offset:24576
    ds_read_b64_tr_b16 v[70:71], v13 offset:24832
    s_waitcnt lgkmcnt(6)
    v_mfma_f32_32x32x16_bf16 v[48:63], v[216:219], v[80:83], v[48:63]
    ds_read_b64_tr_b16 v[72:73], v14 offset:24576
    ds_read_b64_tr_b16 v[74:75], v14 offset:24832
    s_waitcnt lgkmcnt(6)
    v_mfma_f32_32x32x16_bf16 v[48:63], v[220:223], v[84:87], v[48:63]
    ds_read_b64_tr_b16 v[76:77], v12 offset:25600
    ds_read_b64_tr_b16 v[78:79], v12 offset:25856
    s_waitcnt lgkmcnt(6)
    v_mfma_f32_32x32x16_bf16 v[48:63], v[228:231], v[64:67], v[48:63]
    ds_read_b64_tr_b16 v[80:81], v13 offset:25600
    ds_read_b64_tr_b16 v[82:83], v13 offset:25856
    s_waitcnt lgkmcnt(6)
    v_mfma_f32_32x32x16_bf16 v[48:63], v[232:235], v[68:71], v[48:63]
    ds_read_b64_tr_b16 v[84:85], v14 offset:25600
    ds_read_b64_tr_b16 v[86:87], v14 offset:25856
    s_waitcnt lgkmcnt(6)
    v_mfma_f32_32x32x16_bf16 v[48:63], v[236:239], v[72:75], v[48:63]
    s_waitcnt lgkmcnt(4)
    v_mfma_f32_32x32x16_bf16 v[48:63], v[244:247], v[76:79], v[48:63]
    s_waitcnt lgkmcnt(2)
    v_mfma_f32_32x32x16_bf16 v[48:63], v[248:251], v[80:83], v[48:63]
    s_waitcnt lgkmcnt(0)
    v_mfma_f32_32x32x16_bf16 v[48:63], v[252:255], v[84:87], v[48:63]
    s_nop 11
    v_mul_f32 v48, v112, v48
    v_mul_f32 v49, v113, v49
    v_mul_f32 v50, v114, v50
    v_mul_f32 v51, v115, v51
    v_mul_f32 v52, v116, v52
    v_mul_f32 v53, v117, v53
    v_mul_f32 v54, v118, v54
    v_mul_f32 v55, v119, v55
    v_cvt_pk_bf16_f32 v48, v48, v49
    v_cvt_pk_bf16_f32 v49, v50, v51
    v_cvt_pk_bf16_f32 v50, v52, v53
    v_cvt_pk_bf16_f32 v51, v54, v55
    buffer_store_dwordx4 v[48:51], v3, s[44:47], s21 offen offset:1024 sc0 sc1
    v_mul_f32 v56, v120, v56
    v_mul_f32 v57, v121, v57
    v_mul_f32 v58, v122, v58
    v_mul_f32 v59, v123, v59
    v_mul_f32 v60, v124, v60
    v_mul_f32 v61, v125, v61
    v_mul_f32 v62, v126, v62
    v_mul_f32 v63, v127, v63
    v_cvt_pk_bf16_f32 v56, v56, v57
    v_cvt_pk_bf16_f32 v57, v58, v59
    v_cvt_pk_bf16_f32 v58, v60, v61
    v_cvt_pk_bf16_f32 v59, v62, v63
    buffer_store_dwordx4 v[56:59], v3, s[44:47], s21 offen offset:1536 sc0 sc1
    s_and_b32 s12, s2, 7
    s_lshr_b32 s13, s2, 3
    s_lshr_b32 s14, s13, 3
    s_and_b32 s15, s13, 7
    s_lshl_b32 s16, s12, 2
    s_add_u32 s16, s16, s14
    v_lshlrev_b32 v2, 4, v1
    v_add_u32 v3, 8192, v2
    v_add_u32 v4, 16384, v2
    v_add_u32 v5, 24576, v2
    v_add_u32 v6, 32768, v2
    v_add_u32 v7, 40960, v2
    v_add_u32 v8, 49152, v2
    v_lshrrev_b32 v164, 4, v1
    v_lshlrev_b32 v164, s62, v164
    v_bfe_u32 v165, v1, 2, 2
    v_lshl_add_u32 v164, v165, 7, v164
    v_and_b32 v165, 3, v1
    v_lshl_add_u32 v164, v165, 3, v164
    v_add_u32 v164, s61, v164
    v_add_u32 v165, s60, v164
    v_add_u32 v160, s90, v2
    v_add_u32 v161, s91, v2
    v_add_u32 v162, s92, v2
    v_add_u32 v163, s93, v2
    v_mov_b32 v166, v15
    s_lshr_b32 s17, s13, 2
    s_and_b32 s13, s13, 3
    s_lshl_b32 s24, s12, 2
    s_add_u32 s13, s13, s24
    s_lshl_b32 s17, s17, 2
    s_add_u32 s17, s17, s3
    s_lshl_b32 s96, s13, 17
    s_add_u32 s96, s96, 2097152
    s_add_u32 s20, s6, s96
    s_addc_u32 s21, s7, 0
    s_lshl_b32 s96, s13, 16
    s_lshl_b32 s97, s17, 11
    s_add_u32 s96, s96, s97
    s_add_u32 s22, s6, s96
    s_addc_u32 s23, s7, 0
    s_lshl_b32 s26, s3, 10
    v_add_u32 v10, s26, v2
    s_lshr_b32 s24, s3, 1
    s_mul_i32 s24, s24, 2304
    s_and_b32 s25, s3, 1
    s_lshl_b32 s25, s25, 10
    s_add_u32 m0, s24, s25
    v_add_u32 v80, 4096, v10
    v_mov_b32 v81, v10
    s_mul_i32 s25, s3, 2304
    v_lshrrev_b32 v64, 4, v1
    s_lshl_b32 s26, s3, 4
    v_add_u32 v64, s26, v64
    v_mul_u32_u24 v64, 2304, v64
    v_and_b32 v65, 15, v1
    v_lshl_add_u32 v64, v65, 4, v64
    v_and_b32 v68, 3, v1
    v_cmp_eq_u32 vcc, 0, v68
    v_mov_b32 v69, 0x3f803f80
    v_lshrrev_b32 v66, 5, v1
    v_cndmask_b32 v68, 0, v69, vcc
    v_mov_b32 v69, v68
    v_mov_b32 v70, v68
    v_mov_b32 v71, v68
    v_lshlrev_b32 v66, 8, v66
    v_lshl_add_u32 v66, v65, 4, v66
    v_add_u32 v66, 1024, v66
    v_add_u32 v67, -4, v65
    v_cmp_gt_u32 vcc, 8, v67
    v_mov_b32 v67, 2048
    v_mov_b32 v72, 2112
    v_cndmask_b32 v67, v67, v72, vcc
    v_and_b32 v72, 11, v65
    v_cmp_eq_u32 vcc, 0, v72
    v_add_u32 v72, 16, v67
    v_and_b32 v73, 16, v1
    v_cndmask_b32 v67, v72, v67, vcc
    v_cmp_eq_u32 vcc, 0, v73
    v_add_u32 v72, 512, v66
    v_mov_b32 v12, v2
    v_cndmask_b32 v15, v67, v66, vcc
    v_cndmask_b32 v18, v67, v72, vcc
    v_add_u32 v13, 64512, v12
    v_add_u32 v16, 64512, v15
    v_add_u32 v19, 64512, v18
    v_add_u32 v14, 129024, v12
    v_add_u32 v17, 129024, v15
    v_add_u32 v20, 129024, v18
    v_mov_b32 v39, 0xdddddddd
    v_mov_b32 v22, 1
    v_mov_b32 v76, s68
    s_lshr_b32 s26, s2, 3
    s_lshl_b64 s[26:27], 1, s26
    s_waitcnt vmcnt(0) lgkmcnt(0)
    s_barrier
    s_cmp_lg_u32 s3, 0
    s_cbranch_scc1 k2_NF
    s_mov_b64 exec, s[26:27]
    global_store_dword v0, v76, s[6:7]
    s_mov_b64 exec, -1
k2_NF:
    global_load_dword v74, v0, s[6:7] sc1
    ds_write_b128 v64, v[68:71] offset:2048
    ds_write_b128 v64, v[68:71] offset:11264
    ds_write_b128 v64, v[68:71] offset:20480
    ds_write_b128 v64, v[68:71] offset:29696
    v_mov_b32 v96, 0
    v_mov_b32 v97, 0
    v_mov_b32 v98, 0
    v_mov_b32 v99, 0
    v_mov_b32 v100, 0
    v_mov_b32 v101, 0
    v_mov_b32 v102, 0
    v_mov_b32 v103, 0
    v_mov_b32 v104, 0
    v_mov_b32 v105, 0
    v_mov_b32 v106, 0
    v_mov_b32 v107, 0
    v_mov_b32 v108, 0
    v_mov_b32 v109, 0
    v_mov_b32 v110, 0
    v_mov_b32 v111, 0
    v_mov_b32 v112, 0
    v_mov_b32 v113, 0
    v_mov_b32 v114, 0
    v_mov_b32 v115, 0
    v_mov_b32 v116, 0
    v_mov_b32 v117, 0
    v_mov_b32 v118, 0
    v_mov_b32 v119, 0
    v_mov_b32 v120, 0
    v_mov_b32 v121, 0
    v_mov_b32 v122, 0
    v_mov_b32 v123, 0
    v_mov_b32 v124, 0
    v_mov_b32 v125, 0
    v_mov_b32 v126, 0
    v_mov_b32 v127, 0
    v_min_u32 v244, 37, v1
    v_and_b32_e64 v245, 3, s16
    v_mad_u32_u24 v244, v245, 38, v244
    v_lshlrev_b32 v244, 7, v244
    v_add_u32 v244, 21504, v244
    s_mov_b32 s24, 8
k2_PL:
    global_load_dword v75, v0, s[6:7] sc1
    s_waitcnt vmcnt(1)
    v_cmp_ne_u32 vcc, s68, v74
    s_cbranch_vccz k2_PX
    global_load_dword v74, v0, s[6:7] sc1
    s_waitcnt vmcnt(1)
    v_cmp_ne_u32 vcc, s68, v75
    s_cbranch_vccz k2_PX
    s_sub_u32 s24, s24, 1
    s_cbranch_scc0 k2_PL
    s_branch k2_PS
k2_PX:
    global_load_lds_dwordx4 v81, s[20:21]
    global_load_dwordx4 v[24:27], v2, s[22:23]
    global_load_dwordx4 v[28:31], v2, s[22:23] offset:1024
    s_add_u32 m0, m0, 4608
    s_lshl_b32 s26, s3, 11
    global_load_lds_dwordx4 v80, s[20:21]
    s_add_u32 s20, s20, s26
    s_addc_u32 s21, s21, 0
    s_add_u32 s18, s20, 57344
    s_addc_u32 s19, s21, 0
    s_add_u32 m0, s25, 9216
    s_nop 0
    global_load_lds_dwordx4 v3, s[20:21]
    global_load_lds_dwordx4 v3, s[20:21] offset:1024
    s_add_u32 m0, s61, 0
    s_add_u32 s56, s56, 0
    buffer_load_dwordx4 v166, s[48:51], s56 offen nt lds
    s_add_u32 m0, s61, 1024
    s_add_u32 s56, s56, s57
    buffer_load_dwordx4 v166, s[48:51], s56 offen nt lds
    s_add_u32 m0, s61, 2048
    s_add_u32 s56, s56, s63
    buffer_load_dwordx4 v166, s[48:51], s56 offen nt lds
    s_add_u32 m0, s61, 3072
    s_add_u32 s56, s56, s57
    buffer_load_dwordx4 v166, s[48:51], s56 offen nt lds
    s_lshr_b32 s28, s3, 1
    s_and_b32 s29, s3, 1
    s_lshr_b32 s30, s15, 1
    s_and_b32 s31, s15, 1
    s_mov_b32 s32, 0xbfb8aa3b
    s_mov_b32 s33, 0x3f803f80
    s_lshl_b32 s69, s15, 2
    s_add_u32 s69, s69, s3
    s_lshl_b32 s96, s16, 16
    s_lshl_b32 s97, s3, 5
    s_add_u32 s96, s96, s97
    s_lshl_b32 s97, s15, 7
    s_add_u32 s96, s96, s97
    s_add_u32 s36, s4, s96
    s_addc_u32 s37, s5, 0
    v_and_b32 v128, 15, v1
    v_lshrrev_b32 v73, 4, v1
    v_lshlrev_b32 v128, 10, v128
    v_lshl_add_u32 v128, v73, 3, v128
    v_add_u32 v132, 16384, v128
    v_add_u32 v136, 32768, v128
    v_add_u32 v140, 49152, v128
    s_lshl_b32 s96, s69, 14
    s_add_u32 s96, s96, 6295552
    s_add_u32 s56, s6, s96
    s_addc_u32 s57, s7, 0
    s_lshl_b32 s96, s69, 14
    s_add_u32 s96, s96, 7344128
    s_add_u32 s58, s6, s96
    s_addc_u32 s59, s7, 0
    s_add_u32 s60, s58, 524288
    s_addc_u32 s61, s59, 0
    s_add_u32 s62, s58, 1048576
    s_addc_u32 s63, s59, 0
    s_mul_i32 s96, s69, 45056
    s_add_u32 s96, s96, 9441280
    s_add_u32 s64, s6, s96
    s_addc_u32 s65, s7, 0
    s_lshl_b32 s96, s16, 16
    s_lshl_b32 s97, s3, 12
    s_add_u32 s96, s96, s97
    s_add_u32 s96, s96, 11534336
    s_add_u32 s34, s6, s96
    s_addc_u32 s35, s7, 0
    s_lshl_b32 s96, s16, 16
    s_lshl_b32 s97, s3, 5
    s_add_u32 s96, s96, s97
    s_lshl_b32 s97, s15, 7
    s_add_u32 s96, s96, s97
    s_add_u32 s38, s8, s96
    s_addc_u32 s39, s9, 0
    s_lshl_b32 s96, s16, 16
    s_lshl_b32 s97, s28, 10
    s_add_u32 s96, s96, s97
    s_lshl_b32 s97, s29, 9
    s_add_u32 s96, s96, s97
    s_lshl_b32 s97, s15, 11
    s_add_u32 s96, s96, s97
    s_add_u32 s40, s8, s96
    s_addc_u32 s41, s9, 0
    s_lshl_b32 s96, s16, 12
    s_lshl_b32 s97, s30, 10
    s_add_u32 s96, s96, s97
    s_lshl_b32 s97, s31, 3
    s_add_u32 s96, s96, s97
    s_lshl_b32 s97, s29, 8
    s_add_u32 s96, s96, s97
    s_add_u32 s96, s96, 15728640
    s_add_u32 s42, s6, s96
    s_addc_u32 s43, s7, 0
    s_lshl_b32 s96, s16, 16
    s_lshl_b32 s97, s3, 12
    s_add_u32 s96, s96, s97
    s_add_u32 s44, s8, s96
    s_addc_u32 s45, s9, 0
    s_lshl_b32 s96, s16, 12
    s_add_u32 s96, s96, 15728640
    s_add_u32 s46, s6, s96
    s_addc_u32 s47, s7, 0
    s_mul_i32 s96, s16, 180224
    s_lshl_b32 s97, s69, 12
    s_add_u32 s96, s96, s97
    s_add_u32 s96, s96, 16777216
    s_add_u32 s48, s6, s96
    s_addc_u32 s49, s7, 0
    s_lshr_b32 s26, s69, 1
    s_min_u32 s26, s26, 11
    s_mul_i32 s96, s16, 180224
    s_lshl_b32 s97, s26, 12
    s_add_u32 s96, s96, s97
    s_lshl_b32 s97, s29, 9
    s_add_u32 s96, s96, s97
    s_add_u32 s96, s96, 16908288
    s_add_u32 s50, s6, s96
    s_addc_u32 s51, s7, 0
    s_lshl_b32 s96, s16, 16
    s_lshl_b32 s97, s69, 11
    s_add_u32 s96, s96, s97
    s_add_u32 s96, s96, 11534336
    s_add_u32 s90, s6, s96
    s_addc_u32 s91, s7, 0
    s_sub_u32 s96, s96, 11534336
    s_add_u32 s92, s8, s96
    s_addc_u32 s93, s9, 0
    s_mul_i32 s96, s16, 180224
    s_mul_i32 s97, s69, 5632
    s_add_u32 s96, s96, s97
    s_add_u32 s96, s96, 16779264
    s_add_u32 s94, s6, s96
    s_addc_u32 s95, s7, 0
    v_and_b32 v72, 15, v1
    v_lshlrev_b32 v9, 7, v72
    v_min_u32 v72, 43, v1
    v_lshlrev_b32 v38, 7, v72
    v_lshlrev_b32 v11, 3, v1
    v_and_b32 v72, 31, v1
    s_lshl_b32 s26, s69, 7
    v_lshl_add_u32 v10, v72, 2, s26
    v_and_b32 v72, 15, v1
    v_lshlrev_b32 v72, 4, v72
    v_bfe_u32 v73, v1, 4, 1
    v_lshl_add_u32 v72, v73, 14, v72
    v_lshrrev_b32 v73, 5, v1
    v_lshl_add_u32 v21, v73, 8, v72
    s_lshr_b32 s27, s2, 5
    s_mov_b32 s26, 16252928
    v_mov_b32 v72, s12
    v_mov_b32 v73, s27
    v_cmp_gt_u32 vcc, 32, v1
    v_and_b32 v37, 7, v1
    v_lshl_add_u32 v37, v37, 10, s26
    v_cndmask_b32 v72, v73, v72, vcc
    v_lshl_add_u32 v23, v72, 10, s26
    v_mov_b32 v32, -1
    v_mov_b32 v33, -1
    v_mov_b32 v34, -1
    v_mov_b32 v35, -1
    s_mov_b64 s[28:29], 0
    s_lshl_b32 s96, s13, 9
    s_lshl_b32 s97, s17, 16
    s_add_u32 s96, s96, s97
    s_add_u32 s96, s96, 11534336
    s_add_u32 s22, s6, s96
    s_addc_u32 s23, s7, 0
    s_waitcnt vmcnt(7) lgkmcnt(0)
    s_barrier
    ds_read_b128 v[40:43], v12 offset:0
    ds_read_b128 v[48:51], v15 offset:0
    ds_read_b128 v[52:55], v18 offset:0
    ds_read_b128 v[44:47], v12 offset:2304
    s_waitcnt lgkmcnt(3)
    v_mfma_f32_32x32x16_bf16 v[64:79], v[40:43], v[24:27], 0
    s_waitcnt lgkmcnt(0)
    s_nop 10
    v_exp_f32 v64, v64
    v_exp_f32 v65, v65
    ds_read_b128 v[56:59], v15 offset:2304
    v_exp_f32 v66, v66
    v_exp_f32 v67, v67
    v_exp_f32 v68, v68
    v_mfma_f32_32x32x16_bf16 v[80:95], v[40:43], v[28:31], 0
    ds_read_b128 v[60:63], v18 offset:2304
    v_exp_f32 v69, v69
    v_exp_f32 v70, v70
    v_exp_f32 v71, v71
    v_exp_f32 v72, v72
    v_exp_f32 v73, v73
    v_smfmac_f32_32x32x32_bf16 v[96:111], v[48:51], v[64:71], v39
    v_exp_f32 v74, v74
    v_exp_f32 v75, v75
    v_exp_f32 v76, v76
    v_exp_f32 v77, v77
    v_exp_f32 v78, v78
    v_exp_f32 v79, v79
    v_exp_f32 v80, v80
    v_exp_f32 v81, v81
    v_smfmac_f32_32x32x32_bf16 v[96:111], v[52:55], v[72:79], v39
    s_waitcnt vmcnt(6) lgkmcnt(0)
    s_barrier
    s_add_u32 m0, s25, 18432
    v_exp_f32 v82, v82
    v_exp_f32 v83, v83
    v_exp_f32 v84, v84
    v_mfma_f32_32x32x16_bf16 v[64:79], v[44:47], v[24:27], 0
    global_load_lds_dwordx4 v4, s[20:21]
    v_exp_f32 v85, v85
    v_exp_f32 v86, v86
    v_exp_f32 v87, v87
    v_exp_f32 v88, v88
    v_exp_f32 v89, v89
    v_smfmac_f32_32x32x32_bf16 v[112:127], v[48:51], v[80:87], v39
    ds_read_b128 v[40:43], v12 offset:4608
    v_exp_f32 v90, v90
    v_exp_f32 v91, v91
    v_exp_f32 v92, v92
    v_exp_f32 v93, v93
    v_exp_f32 v94, v94
    v_exp_f32 v95, v95
    v_exp_f32 v64, v64
    v_exp_f32 v65, v65
    v_smfmac_f32_32x32x32_bf16 v[112:127], v[52:55], v[88:95], v39
    ds_read_b128 v[48:51], v15 offset:4608
    v_exp_f32 v66, v66
    v_exp_f32 v67, v67
    v_exp_f32 v68, v68
    v_mfma_f32_32x32x16_bf16 v[80:95], v[44:47], v[28:31], 0
    ds_read_b128 v[52:55], v18 offset:4608
    v_exp_f32 v69, v69
    v_exp_f32 v70, v70
    v_exp_f32 v71, v71
    v_exp_f32 v72, v72
    v_exp_f32 v73, v73
    v_smfmac_f32_32x32x32_bf16 v[96:111], v[56:59], v[64:71], v39
    global_load_lds_dwordx4 v4, s[20:21] offset:1024
    v_exp_f32 v74, v74
    v_exp_f32 v75, v75
    v_exp_f32 v76, v76
    v_exp_f32 v77, v77
    v_exp_f32 v78, v78
    v_exp_f32 v79, v79
    v_exp_f32 v80, v80
    v_exp_f32 v81, v81
    v_smfmac_f32_32x32x32_bf16 v[96:111], v[60:63], v[72:79], v39
    s_waitcnt lgkmcnt(0)
    v_exp_f32 v82, v82
    v_exp_f32 v83, v83
    v_exp_f32 v84, v84
    v_mfma_f32_32x32x16_bf16 v[64:79], v[40:43], v[24:27], 0
    v_exp_f32 v85, v85
    v_exp_f32 v86, v86
    v_exp_f32 v87, v87
    v_exp_f32 v88, v88
    v_exp_f32 v89, v89
    v_smfmac_f32_32x32x32_bf16 v[112:127], v[56:59], v[80:87], v39
    ds_read_b128 v[44:47], v12 offset:6912
    v_exp_f32 v90, v90
    v_exp_f32 v91, v91
    v_exp_f32 v92, v92
    v_exp_f32 v93, v93
    v_exp_f32 v94, v94
    v_exp_f32 v95, v95
    v_exp_f32 v64, v64
    v_exp_f32 v65, v65
    v_smfmac_f32_32x32x32_bf16 v[112:127], v[60:63], v[88:95], v39
    ds_read_b128 v[56:59], v15 offset:6912
    v_exp_f32 v66, v66
    v_exp_f32 v67, v67
    v_exp_f32 v68, v68
    v_mfma_f32_32x32x16_bf16 v[80:95], v[40:43], v[28:31], 0
    ds_read_b128 v[60:63], v18 offset:6912
    v_exp_f32 v69, v69
    v_exp_f32 v70, v70
    v_exp_f32 v71, v71
    v_exp_f32 v72, v72
    v_exp_f32 v73, v73
    v_smfmac_f32_32x32x32_bf16 v[96:111], v[48:51], v[64:71], v39
    v_exp_f32 v74, v74
    v_exp_f32 v75, v75
    v_exp_f32 v76, v76
    v_exp_f32 v77, v77
    v_exp_f32 v78, v78
    v_exp_f32 v79, v79
    v_exp_f32 v80, v80
    v_exp_f32 v81, v81
    v_smfmac_f32_32x32x32_bf16 v[96:111], v[52:55], v[72:79], v39
    s_waitcnt vmcnt(6) lgkmcnt(0)
    s_barrier
    s_add_u32 m0, s25, 27648
    s_waitcnt vmcnt(2)
    ds_read_b64_tr_b16 v[144:145], v164 offset:0
    ds_read_b64_tr_b16 v[146:147], v165 offset:0
    v_exp_f32 v82, v82
    v_exp_f32 v83, v83
    v_exp_f32 v84, v84
    v_mfma_f32_32x32x16_bf16 v[64:79], v[44:47], v[24:27], 0
    global_load_lds_dwordx4 v5, s[20:21]
    ds_read_b64_tr_b16 v[148:149], v164 offset:32
    ds_read_b64_tr_b16 v[150:151], v165 offset:32
    ds_read_b64_tr_b16 v[152:153], v164 offset:64
    v_exp_f32 v85, v85
    v_exp_f32 v86, v86
    v_exp_f32 v87, v87
    v_exp_f32 v88, v88
    v_exp_f32 v89, v89
    v_smfmac_f32_32x32x32_bf16 v[112:127], v[48:51], v[80:87], v39
    ds_read_b128 v[40:43], v12 offset:9216
    v_exp_f32 v90, v90
    v_exp_f32 v91, v91
    v_exp_f32 v92, v92
    v_exp_f32 v93, v93
    v_exp_f32 v94, v94
    v_exp_f32 v95, v95
    v_exp_f32 v64, v64
    v_exp_f32 v65, v65
    v_smfmac_f32_32x32x32_bf16 v[112:127], v[52:55], v[88:95], v39
    ds_read_b128 v[48:51], v15 offset:9216
    v_exp_f32 v66, v66
    v_exp_f32 v67, v67
    v_exp_f32 v68, v68
    v_mfma_f32_32x32x16_bf16 v[80:95], v[44:47], v[28:31], 0
    ds_read_b128 v[52:55], v18 offset:9216
    v_exp_f32 v69, v69
    v_exp_f32 v70, v70
    v_exp_f32 v71, v71
    v_exp_f32 v72, v72
    v_exp_f32 v73, v73
    v_smfmac_f32_32x32x32_bf16 v[96:111], v[56:59], v[64:71], v39
    global_load_lds_dwordx4 v5, s[20:21] offset:1024
    v_exp_f32 v74, v74
    v_exp_f32 v75, v75
    v_exp_f32 v76, v76
    v_exp_f32 v77, v77
    v_exp_f32 v78, v78
    v_exp_f32 v79, v79
    v_exp_f32 v80, v80
    v_exp_f32 v81, v81
    v_smfmac_f32_32x32x32_bf16 v[96:111], v[60:63], v[72:79], v39
    s_waitcnt lgkmcnt(0)
    ds_read_b64_tr_b16 v[154:155], v165 offset:64
    ds_read_b64_tr_b16 v[156:157], v164 offset:96
    ds_read_b64_tr_b16 v[158:159], v165 offset:96
    v_exp_f32 v82, v82
    v_exp_f32 v83, v83
    v_exp_f32 v84, v84
    v_mfma_f32_32x32x16_bf16 v[64:79], v[40:43], v[24:27], 0
    v_exp_f32 v85, v85
    v_exp_f32 v86, v86
    v_exp_f32 v87, v87
    v_exp_f32 v88, v88
    v_exp_f32 v89, v89
    v_smfmac_f32_32x32x32_bf16 v[112:127], v[56:59], v[80:87], v39
    ds_read_b128 v[44:47], v12 offset:11520
    v_exp_f32 v90, v90
    v_exp_f32 v91, v91
    v_exp_f32 v92, v92
    v_exp_f32 v93, v93
    v_exp_f32 v94, v94
    v_exp_f32 v95, v95
    v_exp_f32 v64, v64
    v_exp_f32 v65, v65
    v_smfmac_f32_32x32x32_bf16 v[112:127], v[60:63], v[88:95], v39
    ds_read_b128 v[56:59], v15 offset:11520
    v_exp_f32 v66, v66
    v_exp_f32 v67, v67
    v_exp_f32 v68, v68
    v_mfma_f32_32x32x16_bf16 v[80:95], v[40:43], v[28:31], 0
    ds_read_b128 v[60:63], v18 offset:11520
    v_exp_f32 v69, v69
    v_exp_f32 v70, v70
    v_exp_f32 v71, v71
    v_exp_f32 v72, v72
    v_exp_f32 v73, v73
    v_smfmac_f32_32x32x32_bf16 v[96:111], v[48:51], v[64:71], v39
    buffer_store_dwordx4 v[144:147], v160, s[52:55], 0 offen sc0 sc1
    v_exp_f32 v74, v74
    v_exp_f32 v75, v75
    v_exp_f32 v76, v76
    v_exp_f32 v77, v77
    v_exp_f32 v78, v78
    v_exp_f32 v79, v79
    v_exp_f32 v80, v80
    v_exp_f32 v81, v81
    v_smfmac_f32_32x32x32_bf16 v[96:111], v[52:55], v[72:79], v39
    s_waitcnt lgkmcnt(0)
    s_add_u32 m0, s25, 36864
    v_exp_f32 v82, v82
    v_exp_f32 v83, v83
    v_exp_f32 v84, v84
    v_mfma_f32_32x32x16_bf16 v[64:79], v[44:47], v[24:27], 0
    global_load_lds_dwordx4 v6, s[20:21]
    buffer_store_dwordx4 v[148:151], v161, s[52:55], 0 offen sc0 sc1
    v_exp_f32 v85, v85
    v_exp_f32 v86, v86
    v_exp_f32 v87, v87
    v_exp_f32 v88, v88
    v_exp_f32 v89, v89
    v_smfmac_f32_32x32x32_bf16 v[112:127], v[48:51], v[80:87], v39
    ds_read_b128 v[40:43], v12 offset:13824
    v_exp_f32 v90, v90
    v_exp_f32 v91, v91
    v_exp_f32 v92, v92
    v_exp_f32 v93, v93
    v_exp_f32 v94, v94
    v_exp_f32 v95, v95
    v_exp_f32 v64, v64
    v_exp_f32 v65, v65
    v_smfmac_f32_32x32x32_bf16 v[112:127], v[52:55], v[88:95], v39
    ds_read_b128 v[48:51], v15 offset:13824
    v_exp_f32 v66, v66
    v_exp_f32 v67, v67
    v_exp_f32 v68, v68
    v_mfma_f32_32x32x16_bf16 v[80:95], v[44:47], v[28:31], 0
    ds_read_b128 v[52:55], v18 offset:13824
    v_exp_f32 v69, v69
    v_exp_f32 v70, v70
    v_exp_f32 v71, v71
    v_exp_f32 v72, v72
    v_exp_f32 v73, v73
    v_smfmac_f32_32x32x32_bf16 v[96:111], v[56:59], v[64:71], v39
    global_load_lds_dwordx4 v6, s[20:21] offset:1024
    buffer_store_dwordx4 v[152:155], v162, s[52:55], 0 offen sc0 sc1
    v_exp_f32 v74, v74
    v_exp_f32 v75, v75
    v_exp_f32 v76, v76
    v_exp_f32 v77, v77
    v_exp_f32 v78, v78
    v_exp_f32 v79, v79
    v_exp_f32 v80, v80
    v_exp_f32 v81, v81
    v_smfmac_f32_32x32x32_bf16 v[96:111], v[60:63], v[72:79], v39
    s_waitcnt lgkmcnt(0)
    v_exp_f32 v82, v82
    v_exp_f32 v83, v83
    v_exp_f32 v84, v84
    v_mfma_f32_32x32x16_bf16 v[64:79], v[40:43], v[24:27], 0
    buffer_store_dwordx4 v[156:159], v163, s[52:55], 0 offen sc0 sc1
    v_exp_f32 v85, v85
    v_exp_f32 v86, v86
    v_exp_f32 v87, v87
    v_exp_f32 v88, v88
    v_exp_f32 v89, v89
    v_smfmac_f32_32x32x32_bf16 v[112:127], v[56:59], v[80:87], v39
    ds_read_b128 v[44:47], v12 offset:16128
    v_exp_f32 v90, v90
    v_exp_f32 v91, v91
    v_exp_f32 v92, v92
    v_exp_f32 v93, v93
    v_exp_f32 v94, v94
    v_exp_f32 v95, v95
    v_exp_f32 v64, v64
    v_exp_f32 v65, v65
    v_smfmac_f32_32x32x32_bf16 v[112:127], v[60:63], v[88:95], v39
    ds_read_b128 v[56:59], v15 offset:16128
    v_exp_f32 v66, v66
    v_exp_f32 v67, v67
    v_exp_f32 v68, v68
    v_mfma_f32_32x32x16_bf16 v[80:95], v[40:43], v[28:31], 0
    ds_read_b128 v[60:63], v18 offset:16128
    v_exp_f32 v69, v69
    v_exp_f32 v70, v70
    v_exp_f32 v71, v71
    v_exp_f32 v72, v72
    v_exp_f32 v73, v73
    v_smfmac_f32_32x32x32_bf16 v[96:111], v[48:51], v[64:71], v39
    v_exp_f32 v74, v74
    v_exp_f32 v75, v75
    v_exp_f32 v76, v76
    v_exp_f32 v77, v77
    v_exp_f32 v78, v78
    v_exp_f32 v79, v79
    v_exp_f32 v80, v80
    v_exp_f32 v81, v81
    v_smfmac_f32_32x32x32_bf16 v[96:111], v[52:55], v[72:79], v39
    s_waitcnt vmcnt(8) lgkmcnt(0)
    s_barrier
    s_add_u32 m0, s25, 46080
    v_exp_f32 v82, v82
    v_exp_f32 v83, v83
    v_exp_f32 v84, v84
    v_mfma_f32_32x32x16_bf16 v[64:79], v[44:47], v[24:27], 0
    global_load_lds_dwordx4 v7, s[20:21]
    v_exp_f32 v85, v85
    v_exp_f32 v86, v86
    v_exp_f32 v87, v87
    v_exp_f32 v88, v88
    v_exp_f32 v89, v89
    v_smfmac_f32_32x32x32_bf16 v[112:127], v[48:51], v[80:87], v39
    ds_read_b128 v[40:43], v12 offset:18432
    v_exp_f32 v90, v90
    v_exp_f32 v91, v91
    v_exp_f32 v92, v92
    v_exp_f32 v93, v93
    v_exp_f32 v94, v94
    v_exp_f32 v95, v95
    v_exp_f32 v64, v64
    v_exp_f32 v65, v65
    v_smfmac_f32_32x32x32_bf16 v[112:127], v[52:55], v[88:95], v39
    ds_read_b128 v[48:51], v15 offset:18432
    v_exp_f32 v66, v66
    v_exp_f32 v67, v67
    v_exp_f32 v68, v68
    v_mfma_f32_32x32x16_bf16 v[80:95], v[44:47], v[28:31], 0
    ds_read_b128 v[52:55], v18 offset:18432
    v_exp_f32 v69, v69
    v_exp_f32 v70, v70
    v_exp_f32 v71, v71
    v_exp_f32 v72, v72
    v_exp_f32 v73, v73
    v_smfmac_f32_32x32x32_bf16 v[96:111], v[56:59], v[64:71], v39
    global_load_lds_dwordx4 v7, s[20:21] offset:1024
    v_exp_f32 v74, v74
    v_exp_f32 v75, v75
    v_exp_f32 v76, v76
    v_exp_f32 v77, v77
    v_exp_f32 v78, v78
    v_exp_f32 v79, v79
    v_exp_f32 v80, v80
    v_exp_f32 v81, v81
    v_smfmac_f32_32x32x32_bf16 v[96:111], v[60:63], v[72:79], v39
    s_waitcnt lgkmcnt(0)
    v_exp_f32 v82, v82
    v_exp_f32 v83, v83
    v_exp_f32 v84, v84
    v_mfma_f32_32x32x16_bf16 v[64:79], v[40:43], v[24:27], 0
    v_exp_f32 v85, v85
    v_exp_f32 v86, v86
    v_exp_f32 v87, v87
    v_exp_f32 v88, v88
    v_exp_f32 v89, v89
    v_smfmac_f32_32x32x32_bf16 v[112:127], v[56:59], v[80:87], v39
    ds_read_b128 v[44:47], v12 offset:20736
    v_exp_f32 v90, v90
    v_exp_f32 v91, v91
    v_exp_f32 v92, v92
    v_exp_f32 v93, v93
    v_exp_f32 v94, v94
    v_exp_f32 v95, v95
    v_exp_f32 v64, v64
    v_exp_f32 v65, v65
    v_smfmac_f32_32x32x32_bf16 v[112:127], v[60:63], v[88:95], v39
    ds_read_b128 v[56:59], v15 offset:20736
    v_exp_f32 v66, v66
    v_exp_f32 v67, v67
    v_exp_f32 v68, v68
    v_mfma_f32_32x32x16_bf16 v[80:95], v[40:43], v[28:31], 0
    ds_read_b128 v[60:63], v18 offset:20736
    v_exp_f32 v69, v69
    v_exp_f32 v70, v70
    v_exp_f32 v71, v71
    v_exp_f32 v72, v72
    v_exp_f32 v73, v73
    v_smfmac_f32_32x32x32_bf16 v[96:111], v[48:51], v[64:71], v39
    v_exp_f32 v74, v74
    v_exp_f32 v75, v75
    v_exp_f32 v76, v76
    v_exp_f32 v77, v77
    v_exp_f32 v78, v78
    v_exp_f32 v79, v79
    v_exp_f32 v80, v80
    v_exp_f32 v81, v81
    v_smfmac_f32_32x32x32_bf16 v[96:111], v[52:55], v[72:79], v39
    s_waitcnt lgkmcnt(0)
    v_exp_f32 v82, v82
    v_exp_f32 v83, v83
    v_exp_f32 v84, v84
    v_mfma_f32_32x32x16_bf16 v[64:79], v[44:47], v[24:27], 0
    v_exp_f32 v85, v85
    v_exp_f32 v86, v86
    v_exp_f32 v87, v87
    v_exp_f32 v88, v88
    v_exp_f32 v89, v89
    v_smfmac_f32_32x32x32_bf16 v[112:127], v[48:51], v[80:87], v39
    ds_read_b128 v[40:43], v12 offset:23040
    v_exp_f32 v90, v90
    v_exp_f32 v91, v91
    v_exp_f32 v92, v92
    v_exp_f32 v93, v93
    v_exp_f32 v94, v94
    v_exp_f32 v95, v95
    v_exp_f32 v64, v64
    v_exp_f32 v65, v65
    v_smfmac_f32_32x32x32_bf16 v[112:127], v[52:55], v[88:95], v39
    ds_read_b128 v[48:51], v15 offset:23040
    v_exp_f32 v66, v66
    v_exp_f32 v67, v67
    v_exp_f32 v68, v68
    v_mfma_f32_32x32x16_bf16 v[80:95], v[44:47], v[28:31], 0
    ds_read_b128 v[52:55], v18 offset:23040
    v_exp_f32 v69, v69
    v_exp_f32 v70, v70
    v_exp_f32 v71, v71
    v_exp_f32 v72, v72
    v_exp_f32 v73, v73
    v_smfmac_f32_32x32x32_bf16 v[96:111], v[56:59], v[64:71], v39
    v_exp_f32 v74, v74
    v_exp_f32 v75, v75
    v_exp_f32 v76, v76
    v_exp_f32 v77, v77
    v_exp_f32 v78, v78
    v_exp_f32 v79, v79
    v_exp_f32 v80, v80
    v_exp_f32 v81, v81
    v_smfmac_f32_32x32x32_bf16 v[96:111], v[60:63], v[72:79], v39
    s_waitcnt lgkmcnt(0)
    v_exp_f32 v82, v82
    v_exp_f32 v83, v83
    v_exp_f32 v84, v84
    v_mfma_f32_32x32x16_bf16 v[64:79], v[40:43], v[24:27], 0
    global_store_dwordx4 v2, v[32:35], s[90:91] offset:0 sc0 sc1
    v_exp_f32 v85, v85
    v_exp_f32 v86, v86
    v_exp_f32 v87, v87
    v_exp_f32 v88, v88
    v_exp_f32 v89, v89
    v_smfmac_f32_32x32x32_bf16 v[112:127], v[56:59], v[80:87], v39
    ds_read_b128 v[44:47], v12 offset:25344
    v_exp_f32 v90, v90
    v_exp_f32 v91, v91
    v_exp_f32 v92, v92
    v_exp_f32 v93, v93
    v_exp_f32 v94, v94
    v_exp_f32 v95, v95
    v_exp_f32 v64, v64
    v_exp_f32 v65, v65
    v_smfmac_f32_32x32x32_bf16 v[112:127], v[60:63], v[88:95], v39
    ds_read_b128 v[56:59], v15 offset:25344
    v_exp_f32 v66, v66
    v_exp_f32 v67, v67
    v_exp_f32 v68, v68
    v_mfma_f32_32x32x16_bf16 v[80:95], v[40:43], v[28:31], 0
    ds_read_b128 v[60:63], v18 offset:25344
    v_exp_f32 v69, v69
    v_exp_f32 v70, v70
    v_exp_f32 v71, v71
    v_exp_f32 v72, v72
    v_exp_f32 v73, v73
    v_smfmac_f32_32x32x32_bf16 v[96:111], v[48:51], v[64:71], v39
    global_load_dwordx2 v[130:131], v128, s[36:37]
    v_exp_f32 v74, v74
    v_exp_f32 v75, v75
    v_exp_f32 v76, v76
    v_exp_f32 v77, v77
    v_exp_f32 v78, v78
    v_exp_f32 v79, v79
    v_exp_f32 v80, v80
    v_exp_f32 v81, v81
    v_smfmac_f32_32x32x32_bf16 v[96:111], v[52:55], v[72:79], v39
    s_waitcnt vmcnt(4) lgkmcnt(0)
    s_barrier
    s_add_u32 m0, s25, 55296
    v_exp_f32 v82, v82
    v_exp_f32 v83, v83
    v_exp_f32 v84, v84
    v_mfma_f32_32x32x16_bf16 v[64:79], v[44:47], v[24:27], 0
    global_load_lds_dwordx4 v8, s[20:21]
    v_exp_f32 v85, v85
    v_exp_f32 v86, v86
    v_exp_f32 v87, v87
    v_exp_f32 v88, v88
    v_exp_f32 v89, v89
    v_smfmac_f32_32x32x32_bf16 v[112:127], v[48:51], v[80:87], v39
    ds_read_b128 v[40:43], v12 offset:27648
    v_exp_f32 v90, v90
    v_exp_f32 v91, v91
    v_exp_f32 v92, v92
    v_exp_f32 v93, v93
    v_exp_f32 v94, v94
    v_exp_f32 v95, v95
    v_exp_f32 v64, v64
    v_exp_f32 v65, v65
    v_smfmac_f32_32x32x32_bf16 v[112:127], v[52:55], v[88:95], v39
    ds_read_b128 v[48:51], v15 offset:27648
    v_exp_f32 v66, v66
    v_exp_f32 v67, v67
    v_exp_f32 v68, v68
    v_mfma_f32_32x32x16_bf16 v[80:95], v[44:47], v[28:31], 0
    ds_read_b128 v[52:55], v18 offset:27648
    v_exp_f32 v69, v69
    v_exp_f32 v70, v70
    v_exp_f32 v71, v71
    v_exp_f32 v72, v72
    v_exp_f32 v73, v73
    v_smfmac_f32_32x32x32_bf16 v[96:111], v[56:59], v[64:71], v39
    global_load_lds_dwordx4 v8, s[20:21] offset:1024
    s_cmp_lg_u32 s3, 0
    s_cbranch_scc1 k2_L_4
    s_mov_b64 exec, 1
    global_atomic_add v0, v22, s[6:7] offset:512 sc1
    s_mov_b64 exec, -1
k2_L_4:
    global_load_dwordx2 v[134:135], v132, s[36:37]
    v_exp_f32 v74, v74
    v_exp_f32 v75, v75
    v_exp_f32 v76, v76
    v_exp_f32 v77, v77
    v_exp_f32 v78, v78
    v_exp_f32 v79, v79
    v_exp_f32 v80, v80
    v_exp_f32 v81, v81
    v_smfmac_f32_32x32x32_bf16 v[96:111], v[60:63], v[72:79], v39
    s_waitcnt lgkmcnt(0)
    v_exp_f32 v82, v82
    v_exp_f32 v83, v83
    v_exp_f32 v84, v84
    v_mfma_f32_32x32x16_bf16 v[64:79], v[40:43], v[24:27], 0
    global_store_dwordx4 v2, v[32:35], s[90:91] offset:1024 sc0 sc1
    v_exp_f32 v85, v85
    v_exp_f32 v86, v86
    v_exp_f32 v87, v87
    v_exp_f32 v88, v88
    v_exp_f32 v89, v89
    v_smfmac_f32_32x32x32_bf16 v[112:127], v[56:59], v[80:87], v39
    ds_read_b128 v[44:47], v12 offset:29952
    v_exp_f32 v90, v90
    v_exp_f32 v91, v91
    v_exp_f32 v92, v92
    v_exp_f32 v93, v93
    v_exp_f32 v94, v94
    v_exp_f32 v95, v95
    v_exp_f32 v64, v64
    v_exp_f32 v65, v65
    v_smfmac_f32_32x32x32_bf16 v[112:127], v[60:63], v[88:95], v39
    ds_read_b128 v[56:59], v15 offset:29952
    v_exp_f32 v66, v66
    v_exp_f32 v67, v67
    v_exp_f32 v68, v68
    v_mfma_f32_32x32x16_bf16 v[80:95], v[40:43], v[28:31], 0
    ds_read_b128 v[60:63], v18 offset:29952
    v_exp_f32 v69, v69
    v_exp_f32 v70, v70
    v_exp_f32 v71, v71
    v_exp_f32 v72, v72
    v_exp_f32 v73, v73
    v_smfmac_f32_32x32x32_bf16 v[96:111], v[48:51], v[64:71], v39
    global_load_dwordx2 v[138:139], v136, s[36:37]
    v_exp_f32 v74, v74
    v_exp_f32 v75, v75
    v_exp_f32 v76, v76
    v_exp_f32 v77, v77
    v_exp_f32 v78, v78
    v_exp_f32 v79, v79
    v_exp_f32 v80, v80
    v_exp_f32 v81, v81
    v_smfmac_f32_32x32x32_bf16 v[96:111], v[52:55], v[72:79], v39
    s_waitcnt lgkmcnt(0)
    v_exp_f32 v82, v82
    v_exp_f32 v83, v83
    v_exp_f32 v84, v84
    v_mfma_f32_32x32x16_bf16 v[64:79], v[44:47], v[24:27], 0
    v_exp_f32 v85, v85
    v_exp_f32 v86, v86
    v_exp_f32 v87, v87
    v_exp_f32 v88, v88
    v_exp_f32 v89, v89
    v_smfmac_f32_32x32x32_bf16 v[112:127], v[48:51], v[80:87], v39
    ds_read_b128 v[40:43], v12 offset:32256
    v_exp_f32 v90, v90
    v_exp_f32 v91, v91
    v_exp_f32 v92, v92
    v_exp_f32 v93, v93
    v_exp_f32 v94, v94
    v_exp_f32 v95, v95
    v_exp_f32 v64, v64
    v_exp_f32 v65, v65
    v_smfmac_f32_32x32x32_bf16 v[112:127], v[52:55], v[88:95], v39
    ds_read_b128 v[48:51], v15 offset:32256
    v_exp_f32 v66, v66
    v_exp_f32 v67, v67
    v_exp_f32 v68, v68
    v_mfma_f32_32x32x16_bf16 v[80:95], v[44:47], v[28:31], 0
    ds_read_b128 v[52:55], v18 offset:32256
    v_exp_f32 v69, v69
    v_exp_f32 v70, v70
    v_exp_f32 v71, v71
    v_exp_f32 v72, v72
    v_exp_f32 v73, v73
    v_smfmac_f32_32x32x32_bf16 v[96:111], v[56:59], v[64:71], v39
    global_load_dwordx2 v[142:143], v140, s[36:37]
    v_exp_f32 v74, v74
    v_exp_f32 v75, v75
    v_exp_f32 v76, v76
    v_exp_f32 v77, v77
    v_exp_f32 v78, v78
    v_exp_f32 v79, v79
    v_exp_f32 v80, v80
    v_exp_f32 v81, v81
    v_smfmac_f32_32x32x32_bf16 v[96:111], v[60:63], v[72:79], v39
    s_waitcnt lgkmcnt(0)
    v_exp_f32 v82, v82
    v_exp_f32 v83, v83
    v_exp_f32 v84, v84
    v_mfma_f32_32x32x16_bf16 v[64:79], v[40:43], v[24:27], 0
    global_store_dwordx4 v2, v[32:35], s[92:93] offset:0 sc0 sc1
    v_exp_f32 v85, v85
    v_exp_f32 v86, v86
    v_exp_f32 v87, v87
    v_exp_f32 v88, v88
    v_exp_f32 v89, v89
    v_smfmac_f32_32x32x32_bf16 v[112:127], v[56:59], v[80:87], v39
    ds_read_b128 v[44:47], v12 offset:34560
    v_exp_f32 v90, v90
    v_exp_f32 v91, v91
    v_exp_f32 v92, v92
    v_exp_f32 v93, v93
    v_exp_f32 v94, v94
    v_exp_f32 v95, v95
    v_exp_f32 v64, v64
    v_exp_f32 v65, v65
    v_smfmac_f32_32x32x32_bf16 v[112:127], v[60:63], v[88:95], v39
    ds_read_b128 v[56:59], v15 offset:34560
    v_exp_f32 v66, v66
    v_exp_f32 v67, v67
    v_exp_f32 v68, v68
    v_mfma_f32_32x32x16_bf16 v[80:95], v[40:43], v[28:31], 0
    ds_read_b128 v[60:63], v18 offset:34560
    v_exp_f32 v69, v69
    v_exp_f32 v70, v70
    v_exp_f32 v71, v71
    v_exp_f32 v72, v72
    v_exp_f32 v73, v73
    v_smfmac_f32_32x32x32_bf16 v[96:111], v[48:51], v[64:71], v39
    s_add_u32 s36, s20, 114688
    s_addc_u32 s37, s21, 0
    v_exp_f32 v74, v74
    v_exp_f32 v75, v75
    v_exp_f32 v76, v76
    v_exp_f32 v77, v77
    v_exp_f32 v78, v78
    v_exp_f32 v79, v79
    v_exp_f32 v80, v80
    v_exp_f32 v81, v81
    v_smfmac_f32_32x32x32_bf16 v[96:111], v[52:55], v[72:79], v39
    s_waitcnt vmcnt(5) lgkmcnt(0)
    s_barrier
    s_add_u32 m0, s25, 64512
    v_exp_f32 v82, v82
    v_exp_f32 v83, v83
    v_exp_f32 v84, v84
    v_mfma_f32_32x32x16_bf16 v[64:79], v[44:47], v[24:27], 0
    global_load_lds_dwordx4 v2, s[18:19]
    v_exp_f32 v85, v85
    v_exp_f32 v86, v86
    v_exp_f32 v87, v87
    v_exp_f32 v88, v88
    v_exp_f32 v89, v89
    v_smfmac_f32_32x32x32_bf16 v[112:127], v[48:51], v[80:87], v39
    ds_read_b128 v[40:43], v12 offset:36864
    v_exp_f32 v90, v90
    v_exp_f32 v91, v91
    v_exp_f32 v92, v92
    v_exp_f32 v93, v93
    v_exp_f32 v94, v94
    v_exp_f32 v95, v95
    v_exp_f32 v64, v64
    v_exp_f32 v65, v65
    v_smfmac_f32_32x32x32_bf16 v[112:127], v[52:55], v[88:95], v39
    ds_read_b128 v[48:51], v15 offset:36864
    v_exp_f32 v66, v66
    v_exp_f32 v67, v67
    v_exp_f32 v68, v68
    v_mfma_f32_32x32x16_bf16 v[80:95], v[44:47], v[28:31], 0
    ds_read_b128 v[52:55], v18 offset:36864
    v_exp_f32 v69, v69
    v_exp_f32 v70, v70
    v_exp_f32 v71, v71
    v_exp_f32 v72, v72
    v_exp_f32 v73, v73
    v_smfmac_f32_32x32x32_bf16 v[96:111], v[56:59], v[64:71], v39
    global_load_lds_dwordx4 v2, s[18:19] offset:1024
    v_exp_f32 v74, v74
    v_exp_f32 v75, v75
    v_exp_f32 v76, v76
    v_exp_f32 v77, v77
    v_exp_f32 v78, v78
    v_exp_f32 v79, v79
    v_exp_f32 v80, v80
    v_exp_f32 v81, v81
    v_smfmac_f32_32x32x32_bf16 v[96:111], v[60:63], v[72:79], v39
    s_waitcnt lgkmcnt(0)
    v_exp_f32 v82, v82
    v_exp_f32 v83, v83
    v_exp_f32 v84, v84
    v_mfma_f32_32x32x16_bf16 v[64:79], v[40:43], v[24:27], 0
    global_store_dwordx4 v2, v[32:35], s[92:93] offset:1024 sc0 sc1
    v_exp_f32 v85, v85
    v_exp_f32 v86, v86
    v_exp_f32 v87, v87
    v_exp_f32 v88, v88
    v_exp_f32 v89, v89
    v_smfmac_f32_32x32x32_bf16 v[112:127], v[56:59], v[80:87], v39
    ds_read_b128 v[44:47], v12 offset:39168
    v_exp_f32 v90, v90
    v_exp_f32 v91, v91
    v_exp_f32 v92, v92
    v_exp_f32 v93, v93
    v_exp_f32 v94, v94
    v_exp_f32 v95, v95
    v_exp_f32 v64, v64
    v_exp_f32 v65, v65
    v_smfmac_f32_32x32x32_bf16 v[112:127], v[60:63], v[88:95], v39
    ds_read_b128 v[56:59], v15 offset:39168
    v_exp_f32 v66, v66
    v_exp_f32 v67, v67
    v_exp_f32 v68, v68
    v_mfma_f32_32x32x16_bf16 v[80:95], v[40:43], v[28:31], 0
    ds_read_b128 v[60:63], v18 offset:39168
    v_exp_f32 v69, v69
    v_exp_f32 v70, v70
    v_exp_f32 v71, v71
    v_exp_f32 v72, v72
    v_exp_f32 v73, v73
    v_smfmac_f32_32x32x32_bf16 v[96:111], v[48:51], v[64:71], v39
    v_exp_f32 v74, v74
    v_exp_f32 v75, v75
    v_exp_f32 v76, v76
    v_exp_f32 v77, v77
    v_exp_f32 v78, v78
    v_exp_f32 v79, v79
    v_exp_f32 v80, v80
    v_exp_f32 v81, v81
    v_smfmac_f32_32x32x32_bf16 v[96:111], v[52:55], v[72:79], v39
    s_waitcnt lgkmcnt(0)
    v_exp_f32 v82, v82
    v_exp_f32 v83, v83
    v_exp_f32 v84, v84
    v_mfma_f32_32x32x16_bf16 v[64:79], v[44:47], v[24:27], 0
    v_exp_f32 v85, v85
    v_exp_f32 v86, v86
    v_exp_f32 v87, v87
    v_exp_f32 v88, v88
    v_exp_f32 v89, v89
    v_smfmac_f32_32x32x32_bf16 v[112:127], v[48:51], v[80:87], v39
    ds_read_b128 v[40:43], v12 offset:41472
    v_exp_f32 v90, v90
    v_exp_f32 v91, v91
    v_exp_f32 v92, v92
    v_exp_f32 v93, v93
    v_exp_f32 v94, v94
    v_exp_f32 v95, v95
    v_exp_f32 v64, v64
    v_exp_f32 v65, v65
    v_smfmac_f32_32x32x32_bf16 v[112:127], v[52:55], v[88:95], v39
    ds_read_b128 v[48:51], v15 offset:41472
    v_exp_f32 v66, v66
    v_exp_f32 v67, v67
    v_exp_f32 v68, v68
    v_mfma_f32_32x32x16_bf16 v[80:95], v[44:47], v[28:31], 0
    ds_read_b128 v[52:55], v18 offset:41472
    v_exp_f32 v69, v69
    v_exp_f32 v70, v70
    v_exp_f32 v71, v71
    v_exp_f32 v72, v72
    v_exp_f32 v73, v73
    v_smfmac_f32_32x32x32_bf16 v[96:111], v[56:59], v[64:71], v39
    v_exp_f32 v74, v74
    v_exp_f32 v75, v75
    v_exp_f32 v76, v76
    v_exp_f32 v77, v77
    v_exp_f32 v78, v78
    v_exp_f32 v79, v79
    v_exp_f32 v80, v80
    v_exp_f32 v81, v81
    v_smfmac_f32_32x32x32_bf16 v[96:111], v[60:63], v[72:79], v39
    s_waitcnt lgkmcnt(0)
    v_exp_f32 v82, v82
    v_exp_f32 v83, v83
    v_exp_f32 v84, v84
    v_mfma_f32_32x32x16_bf16 v[64:79], v[40:43], v[24:27], 0
    global_store_dwordx4 v2, v[32:35], s[94:95] offset:-2048 sc0 sc1
    v_exp_f32 v85, v85
    v_exp_f32 v86, v86
    v_exp_f32 v87, v87
    v_exp_f32 v88, v88
    v_exp_f32 v89, v89
    v_smfmac_f32_32x32x32_bf16 v[112:127], v[56:59], v[80:87], v39
    ds_read_b128 v[44:47], v12 offset:43776
    v_exp_f32 v90, v90
    v_exp_f32 v91, v91
    v_exp_f32 v92, v92
    v_exp_f32 v93, v93
    v_exp_f32 v94, v94
    v_exp_f32 v95, v95
    v_exp_f32 v64, v64
    v_exp_f32 v65, v65
    v_smfmac_f32_32x32x32_bf16 v[112:127], v[60:63], v[88:95], v39
    ds_read_b128 v[56:59], v15 offset:43776
    v_exp_f32 v66, v66
    v_exp_f32 v67, v67
    v_exp_f32 v68, v68
    v_mfma_f32_32x32x16_bf16 v[80:95], v[40:43], v[28:31], 0
    ds_read_b128 v[60:63], v18 offset:43776
    v_exp_f32 v69, v69
    v_exp_f32 v70, v70
    v_exp_f32 v71, v71
    v_exp_f32 v72, v72
    v_exp_f32 v73, v73
    v_smfmac_f32_32x32x32_bf16 v[96:111], v[48:51], v[64:71], v39
    v_exp_f32 v74, v74
    v_exp_f32 v75, v75
    v_exp_f32 v76, v76
    v_exp_f32 v77, v77
    v_exp_f32 v78, v78
    v_exp_f32 v79, v79
    v_exp_f32 v80, v80
    v_exp_f32 v81, v81
    v_smfmac_f32_32x32x32_bf16 v[96:111], v[52:55], v[72:79], v39
    s_waitcnt lgkmcnt(0)
    s_add_u32 m0, s25, 73728
    v_exp_f32 v82, v82
    v_exp_f32 v83, v83
    v_exp_f32 v84, v84
    v_mfma_f32_32x32x16_bf16 v[64:79], v[44:47], v[24:27], 0
    global_load_lds_dwordx4 v3, s[18:19]
    v_exp_f32 v85, v85
    v_exp_f32 v86, v86
    v_exp_f32 v87, v87
    v_exp_f32 v88, v88
    v_exp_f32 v89, v89
    v_smfmac_f32_32x32x32_bf16 v[112:127], v[48:51], v[80:87], v39
    ds_read_b128 v[40:43], v12 offset:46080
    v_exp_f32 v90, v90
    v_exp_f32 v91, v91
    v_exp_f32 v92, v92
    v_exp_f32 v93, v93
    v_exp_f32 v94, v94
    v_exp_f32 v95, v95
    v_exp_f32 v64, v64
    v_exp_f32 v65, v65
    v_smfmac_f32_32x32x32_bf16 v[112:127], v[52:55], v[88:95], v39
    ds_read_b128 v[48:51], v15 offset:46080
    v_exp_f32 v66, v66
    v_exp_f32 v67, v67
    v_exp_f32 v68, v68
    v_mfma_f32_32x32x16_bf16 v[80:95], v[44:47], v[28:31], 0
    ds_read_b128 v[52:55], v18 offset:46080
    v_exp_f32 v69, v69
    v_exp_f32 v70, v70
    v_exp_f32 v71, v71
    v_exp_f32 v72, v72
    v_exp_f32 v73, v73
    v_smfmac_f32_32x32x32_bf16 v[96:111], v[56:59], v[64:71], v39
    global_load_lds_dwordx4 v3, s[18:19] offset:1024
    v_exp_f32 v74, v74
    v_exp_f32 v75, v75
    v_exp_f32 v76, v76
    v_exp_f32 v77, v77
    v_exp_f32 v78, v78
    v_exp_f32 v79, v79
    v_exp_f32 v80, v80
    v_exp_f32 v81, v81
    v_smfmac_f32_32x32x32_bf16 v[96:111], v[60:63], v[72:79], v39
    s_waitcnt lgkmcnt(0)
    v_exp_f32 v82, v82
    v_exp_f32 v83, v83
    v_exp_f32 v84, v84
    v_mfma_f32_32x32x16_bf16 v[64:79], v[40:43], v[24:27], 0
    global_store_dwordx4 v2, v[32:35], s[94:95] offset:-1024 sc0 sc1
    v_exp_f32 v85, v85
    v_exp_f32 v86, v86
    v_exp_f32 v87, v87
    v_exp_f32 v88, v88
    v_exp_f32 v89, v89
    v_smfmac_f32_32x32x32_bf16 v[112:127], v[56:59], v[80:87], v39
    ds_read_b128 v[44:47], v12 offset:48384
    v_exp_f32 v90, v90
    v_exp_f32 v91, v91
    v_exp_f32 v92, v92
    v_exp_f32 v93, v93
    v_exp_f32 v94, v94
    v_exp_f32 v95, v95
    v_exp_f32 v64, v64
    v_exp_f32 v65, v65
    v_smfmac_f32_32x32x32_bf16 v[112:127], v[60:63], v[88:95], v39
    ds_read_b128 v[56:59], v15 offset:48384
    v_exp_f32 v66, v66
    v_exp_f32 v67, v67
    v_exp_f32 v68, v68
    v_mfma_f32_32x32x16_bf16 v[80:95], v[40:43], v[28:31], 0
    ds_read_b128 v[60:63], v18 offset:48384
    v_exp_f32 v69, v69
    v_exp_f32 v70, v70
    v_exp_f32 v71, v71
    v_exp_f32 v72, v72
    v_exp_f32 v73, v73
    v_smfmac_f32_32x32x32_bf16 v[96:111], v[48:51], v[64:71], v39
    v_exp_f32 v74, v74
    v_exp_f32 v75, v75
    v_exp_f32 v76, v76
    v_exp_f32 v77, v77
    v_exp_f32 v78, v78
    v_exp_f32 v79, v79
    v_exp_f32 v80, v80
    v_exp_f32 v81, v81
    v_smfmac_f32_32x32x32_bf16 v[96:111], v[52:55], v[72:79], v39
    s_waitcnt lgkmcnt(0)
    v_exp_f32 v82, v82
    v_exp_f32 v83, v83
    v_exp_f32 v84, v84
    v_mfma_f32_32x32x16_bf16 v[64:79], v[44:47], v[24:27], 0
    v_exp_f32 v85, v85
    v_exp_f32 v86, v86
    v_exp_f32 v87, v87
    v_exp_f32 v88, v88
    v_exp_f32 v89, v89
    v_smfmac_f32_32x32x32_bf16 v[112:127], v[48:51], v[80:87], v39
    ds_read_b128 v[40:43], v12 offset:50688
    v_exp_f32 v90, v90
    v_exp_f32 v91, v91
    v_exp_f32 v92, v92
    v_exp_f32 v93, v93
    v_exp_f32 v94, v94
    v_exp_f32 v95, v95
    v_exp_f32 v64, v64
    v_exp_f32 v65, v65
    v_smfmac_f32_32x32x32_bf16 v[112:127], v[52:55], v[88:95], v39
    ds_read_b128 v[48:51], v15 offset:50688
    v_exp_f32 v66, v66
    v_exp_f32 v67, v67
    v_exp_f32 v68, v68
    v_mfma_f32_32x32x16_bf16 v[80:95], v[44:47], v[28:31], 0
    ds_read_b128 v[52:55], v18 offset:50688
    v_exp_f32 v69, v69
    v_exp_f32 v70, v70
    v_exp_f32 v71, v71
    v_exp_f32 v72, v72
    v_exp_f32 v73, v73
    v_smfmac_f32_32x32x32_bf16 v[96:111], v[56:59], v[64:71], v39
    global_load_dword v37, v37, s[6:7] offset:512 sc1
    v_exp_f32 v74, v74
    v_exp_f32 v75, v75
    v_exp_f32 v76, v76
    v_exp_f32 v77, v77
    v_exp_f32 v78, v78
    v_exp_f32 v79, v79
    v_exp_f32 v80, v80
    v_exp_f32 v81, v81
    v_smfmac_f32_32x32x32_bf16 v[96:111], v[60:63], v[72:79], v39
    s_waitcnt lgkmcnt(0)
    v_exp_f32 v82, v82
    v_exp_f32 v83, v83
    v_exp_f32 v84, v84
    v_mfma_f32_32x32x16_bf16 v[64:79], v[40:43], v[24:27], 0
    global_store_dwordx4 v2, v[32:35], s[94:95] offset:0 sc0 sc1
    v_exp_f32 v85, v85
    v_exp_f32 v86, v86
    v_exp_f32 v87, v87
    v_exp_f32 v88, v88
    v_exp_f32 v89, v89
    v_smfmac_f32_32x32x32_bf16 v[112:127], v[56:59], v[80:87], v39
    ds_read_b128 v[44:47], v12 offset:52992
    v_exp_f32 v90, v90
    v_exp_f32 v91, v91
    v_exp_f32 v92, v92
    v_exp_f32 v93, v93
    v_exp_f32 v94, v94
    v_exp_f32 v95, v95
    v_exp_f32 v64, v64
    v_exp_f32 v65, v65
    v_smfmac_f32_32x32x32_bf16 v[112:127], v[60:63], v[88:95], v39
    ds_read_b128 v[56:59], v15 offset:52992
    v_exp_f32 v66, v66
    v_exp_f32 v67, v67
    v_exp_f32 v68, v68
    v_mfma_f32_32x32x16_bf16 v[80:95], v[40:43], v[28:31], 0
    ds_read_b128 v[60:63], v18 offset:52992
    v_exp_f32 v69, v69
    v_exp_f32 v70, v70
    v_exp_f32 v71, v71
    v_exp_f32 v72, v72
    v_exp_f32 v73, v73
    v_smfmac_f32_32x32x32_bf16 v[96:111], v[48:51], v[64:71], v39
    v_exp_f32 v74, v74
    v_exp_f32 v75, v75
    v_exp_f32 v76, v76
    v_exp_f32 v77, v77
    v_exp_f32 v78, v78
    v_exp_f32 v79, v79
    v_exp_f32 v80, v80
    v_exp_f32 v81, v81
    v_smfmac_f32_32x32x32_bf16 v[96:111], v[52:55], v[72:79], v39
    s_waitcnt lgkmcnt(0)
    s_add_u32 m0, s25, 82944
    v_exp_f32 v82, v82
    v_exp_f32 v83, v83
    v_exp_f32 v84, v84
    v_mfma_f32_32x32x16_bf16 v[64:79], v[44:47], v[24:27], 0
    global_load_lds_dwordx4 v4, s[18:19]
    v_exp_f32 v85, v85
    v_exp_f32 v86, v86
    v_exp_f32 v87, v87
    v_exp_f32 v88, v88
    v_exp_f32 v89, v89
    v_smfmac_f32_32x32x32_bf16 v[112:127], v[48:51], v[80:87], v39
    ds_read_b128 v[40:43], v12 offset:55296
    v_exp_f32 v90, v90
    v_exp_f32 v91, v91
    v_exp_f32 v92, v92
    v_exp_f32 v93, v93
    v_exp_f32 v94, v94
    v_exp_f32 v95, v95
    v_exp_f32 v64, v64
    v_exp_f32 v65, v65
    v_smfmac_f32_32x32x32_bf16 v[112:127], v[52:55], v[88:95], v39
    ds_read_b128 v[48:51], v15 offset:55296
    v_exp_f32 v66, v66
    v_exp_f32 v67, v67
    v_exp_f32 v68, v68
    v_mfma_f32_32x32x16_bf16 v[80:95], v[44:47], v[28:31], 0
    ds_read_b128 v[52:55], v18 offset:55296
    v_exp_f32 v69, v69
    v_exp_f32 v70, v70
    v_exp_f32 v71, v71
    v_exp_f32 v72, v72
    v_exp_f32 v73, v73
    v_smfmac_f32_32x32x32_bf16 v[96:111], v[56:59], v[64:71], v39
    global_load_lds_dwordx4 v4, s[18:19] offset:1024
    s_waitcnt vmcnt(3)
    v_cmp_ne_u32 vcc, 32, v37
    s_cbranch_vccnz k2_L_5S
k2_L_5B:
    v_exp_f32 v74, v74
    v_exp_f32 v75, v75
    v_exp_f32 v76, v76
    v_exp_f32 v77, v77
    v_exp_f32 v78, v78
    v_exp_f32 v79, v79
    v_exp_f32 v80, v80
    v_exp_f32 v81, v81
    v_smfmac_f32_32x32x32_bf16 v[96:111], v[60:63], v[72:79], v39
    s_waitcnt lgkmcnt(0)
    v_exp_f32 v82, v82
    v_exp_f32 v83, v83
    v_exp_f32 v84, v84
    v_mfma_f32_32x32x16_bf16 v[64:79], v[40:43], v[24:27], 0
    global_store_dwordx4 v2, v[32:35], s[94:95] offset:1024 sc0 sc1
    v_exp_f32 v85, v85
    v_exp_f32 v86, v86
    v_exp_f32 v87, v87
    v_exp_f32 v88, v88
    v_exp_f32 v89, v89
    v_smfmac_f32_32x32x32_bf16 v[112:127], v[56:59], v[80:87], v39
    ds_read_b128 v[44:47], v12 offset:57600
    v_exp_f32 v90, v90
    v_exp_f32 v91, v91
    v_exp_f32 v92, v92
    v_exp_f32 v93, v93
    v_exp_f32 v94, v94
    v_exp_f32 v95, v95
    v_exp_f32 v64, v64
    v_exp_f32 v65, v65
    v_smfmac_f32_32x32x32_bf16 v[112:127], v[60:63], v[88:95], v39
    ds_read_b128 v[56:59], v15 offset:57600
    v_exp_f32 v66, v66
    v_exp_f32 v67, v67
    v_exp_f32 v68, v68
    v_mfma_f32_32x32x16_bf16 v[80:95], v[40:43], v[28:31], 0
    ds_read_b128 v[60:63], v18 offset:57600
    v_exp_f32 v69, v69
    v_exp_f32 v70, v70
    v_exp_f32 v71, v71
    v_exp_f32 v72, v72
    v_exp_f32 v73, v73
    v_smfmac_f32_32x32x32_bf16 v[96:111], v[48:51], v[64:71], v39
    global_load_dwordx4 a[0:3], v2, s[56:57] offset:-4096
    global_load_dwordx4 a[4:7], v2, s[56:57] offset:-3072
    v_exp_f32 v74, v74
    v_exp_f32 v75, v75
    v_exp_f32 v76, v76
    v_exp_f32 v77, v77
    v_exp_f32 v78, v78
    v_exp_f32 v79, v79
    v_exp_f32 v80, v80
    v_exp_f32 v81, v81
    v_smfmac_f32_32x32x32_bf16 v[96:111], v[52:55], v[72:79], v39
    s_waitcnt lgkmcnt(0)
    v_exp_f32 v82, v82
    v_exp_f32 v83, v83
    v_exp_f32 v84, v84
    v_mfma_f32_32x32x16_bf16 v[64:79], v[44:47], v[24:27], 0
    global_load_dwordx4 a[8:11], v2, s[56:57] offset:-2048
    global_load_dwordx4 a[12:15], v2, s[56:57] offset:-1024
    v_exp_f32 v85, v85
    v_exp_f32 v86, v86
    v_exp_f32 v87, v87
    v_exp_f32 v88, v88
    v_exp_f32 v89, v89
    v_smfmac_f32_32x32x32_bf16 v[112:127], v[48:51], v[80:87], v39
    ds_read_b128 v[40:43], v12 offset:59904
    v_exp_f32 v90, v90
    v_exp_f32 v91, v91
    v_exp_f32 v92, v92
    v_exp_f32 v93, v93
    v_exp_f32 v94, v94
    v_exp_f32 v95, v95
    v_exp_f32 v64, v64
    v_exp_f32 v65, v65
    v_smfmac_f32_32x32x32_bf16 v[112:127], v[52:55], v[88:95], v39
    ds_read_b128 v[48:51], v15 offset:59904
    v_exp_f32 v66, v66
    v_exp_f32 v67, v67
    v_exp_f32 v68, v68
    v_mfma_f32_32x32x16_bf16 v[80:95], v[44:47], v[28:31], 0
    ds_read_b128 v[52:55], v18 offset:59904
    v_exp_f32 v69, v69
    v_exp_f32 v70, v70
    v_exp_f32 v71, v71
    v_exp_f32 v72, v72
    v_exp_f32 v73, v73
    v_smfmac_f32_32x32x32_bf16 v[96:111], v[56:59], v[64:71], v39
    global_load_dwordx4 a[16:19], v2, s[56:57] offset:0
    global_load_dwordx4 a[20:23], v2, s[56:57] offset:1024
    v_exp_f32 v74, v74
    v_exp_f32 v75, v75
    v_exp_f32 v76, v76
    v_exp_f32 v77, v77
    v_exp_f32 v78, v78
    v_exp_f32 v79, v79
    v_exp_f32 v80, v80
    v_exp_f32 v81, v81
    v_smfmac_f32_32x32x32_bf16 v[96:111], v[60:63], v[72:79], v39
    s_waitcnt lgkmcnt(0)
    v_exp_f32 v82, v82
    v_exp_f32 v83, v83
    v_exp_f32 v84, v84
    v_mfma_f32_32x32x16_bf16 v[64:79], v[40:43], v[24:27], 0
    global_store_dwordx4 v2, v[32:35], s[94:95] offset:2048 sc0 sc1
    v_exp_f32 v85, v85
    v_exp_f32 v86, v86
    v_exp_f32 v87, v87
    v_exp_f32 v88, v88
    v_exp_f32 v89, v89
    v_smfmac_f32_32x32x32_bf16 v[112:127], v[56:59], v[80:87], v39
    ds_read_b128 v[44:47], v12 offset:62208
    v_exp_f32 v90, v90
    v_exp_f32 v91, v91
    v_exp_f32 v92, v92
    v_exp_f32 v93, v93
    v_exp_f32 v94, v94
    v_exp_f32 v95, v95
    v_exp_f32 v64, v64
    v_exp_f32 v65, v65
    v_smfmac_f32_32x32x32_bf16 v[112:127], v[60:63], v[88:95], v39
    ds_read_b128 v[56:59], v15 offset:62208
    v_exp_f32 v66, v66
    v_exp_f32 v67, v67
    v_exp_f32 v68, v68
    v_mfma_f32_32x32x16_bf16 v[80:95], v[40:43], v[28:31], 0
    ds_read_b128 v[60:63], v18 offset:62208
    v_exp_f32 v69, v69
    v_exp_f32 v70, v70
    v_exp_f32 v71, v71
    v_exp_f32 v72, v72
    v_exp_f32 v73, v73
    v_smfmac_f32_32x32x32_bf16 v[96:111], v[48:51], v[64:71], v39
    global_load_dwordx4 a[24:27], v2, s[56:57] offset:2048
    global_load_dwordx4 a[28:31], v2, s[56:57] offset:3072
    v_exp_f32 v74, v74
    v_exp_f32 v75, v75
    v_exp_f32 v76, v76
    v_exp_f32 v77, v77
    v_exp_f32 v78, v78
    v_exp_f32 v79, v79
    v_exp_f32 v80, v80
    v_exp_f32 v81, v81
    v_smfmac_f32_32x32x32_bf16 v[96:111], v[52:55], v[72:79], v39
    s_waitcnt vmcnt(10) lgkmcnt(0)
    s_barrier
    s_add_u32 m0, s25, 92160
    v_exp_f32 v82, v82
    v_exp_f32 v83, v83
    v_exp_f32 v84, v84
    v_mfma_f32_32x32x16_bf16 v[64:79], v[44:47], v[24:27], 0
    global_load_lds_dwordx4 v5, s[18:19]
    v_exp_f32 v85, v85
    v_exp_f32 v86, v86
    v_exp_f32 v87, v87
    v_exp_f32 v88, v88
    v_exp_f32 v89, v89
    v_smfmac_f32_32x32x32_bf16 v[112:127], v[48:51], v[80:87], v39
    ds_read_b128 v[40:43], v13 offset:0
    v_exp_f32 v90, v90
    v_exp_f32 v91, v91
    v_exp_f32 v92, v92
    v_exp_f32 v93, v93
    v_exp_f32 v94, v94
    v_exp_f32 v95, v95
    v_exp_f32 v64, v64
    v_exp_f32 v65, v65
    v_smfmac_f32_32x32x32_bf16 v[112:127], v[52:55], v[88:95], v39
    ds_read_b128 v[48:51], v16 offset:0
    v_exp_f32 v66, v66
    v_exp_f32 v67, v67
    v_exp_f32 v68, v68
    v_mfma_f32_32x32x16_bf16 v[80:95], v[44:47], v[28:31], 0
    ds_read_b128 v[52:55], v19 offset:0
    v_exp_f32 v69, v69
    v_exp_f32 v70, v70
    v_exp_f32 v71, v71
    v_exp_f32 v72, v72
    v_exp_f32 v73, v73
    v_smfmac_f32_32x32x32_bf16 v[96:111], v[56:59], v[64:71], v39
    global_load_lds_dwordx4 v5, s[18:19] offset:1024
    v_exp_f32 v74, v74
    v_exp_f32 v75, v75
    v_exp_f32 v76, v76
    v_exp_f32 v77, v77
    v_exp_f32 v78, v78
    v_exp_f32 v79, v79
    v_exp_f32 v80, v80
    v_exp_f32 v81, v81
    v_smfmac_f32_32x32x32_bf16 v[96:111], v[60:63], v[72:79], v39
    s_waitcnt lgkmcnt(0)
    v_exp_f32 v82, v82
    v_exp_f32 v83, v83
    v_exp_f32 v84, v84
    v_mfma_f32_32x32x16_bf16 v[64:79], v[40:43], v[24:27], 0
    global_store_dwordx2 v11, v[32:33], s[94:95] offset:3072 sc0 sc1
    v_exp_f32 v85, v85
    v_exp_f32 v86, v86
    v_exp_f32 v87, v87
    v_exp_f32 v88, v88
    v_exp_f32 v89, v89
    v_smfmac_f32_32x32x32_bf16 v[112:127], v[56:59], v[80:87], v39
    ds_read_b128 v[44:47], v13 offset:2304
    v_exp_f32 v90, v90
    v_exp_f32 v91, v91
    v_exp_f32 v92, v92
    v_exp_f32 v93, v93
    v_exp_f32 v94, v94
    v_exp_f32 v95, v95
    v_exp_f32 v64, v64
    v_exp_f32 v65, v65
    v_smfmac_f32_32x32x32_bf16 v[112:127], v[60:63], v[88:95], v39
    ds_read_b128 v[56:59], v16 offset:2304
    v_exp_f32 v66, v66
    v_exp_f32 v67, v67
    v_exp_f32 v68, v68
    v_mfma_f32_32x32x16_bf16 v[80:95], v[40:43], v[28:31], 0
    ds_read_b128 v[60:63], v19 offset:2304
    v_exp_f32 v69, v69
    v_exp_f32 v70, v70
    v_exp_f32 v71, v71
    v_exp_f32 v72, v72
    v_exp_f32 v73, v73
    v_smfmac_f32_32x32x32_bf16 v[96:111], v[48:51], v[64:71], v39
    global_load_dwordx4 a[32:35], v3, s[56:57] offset:-4096
    global_load_dwordx4 a[36:39], v3, s[56:57] offset:-3072
    v_exp_f32 v74, v74
    v_exp_f32 v75, v75
    v_exp_f32 v76, v76
    v_exp_f32 v77, v77
    v_exp_f32 v78, v78
    v_exp_f32 v79, v79
    v_exp_f32 v80, v80
    v_exp_f32 v81, v81
    v_smfmac_f32_32x32x32_bf16 v[96:111], v[52:55], v[72:79], v39
    s_waitcnt lgkmcnt(0)
    v_exp_f32 v82, v82
    v_exp_f32 v83, v83
    v_exp_f32 v84, v84
    v_mfma_f32_32x32x16_bf16 v[64:79], v[44:47], v[24:27], 0
    global_load_dwordx4 a[40:43], v3, s[56:57] offset:-2048
    global_load_dwordx4 a[44:47], v3, s[56:57] offset:-1024
    v_exp_f32 v85, v85
    v_exp_f32 v86, v86
    v_exp_f32 v87, v87
    v_exp_f32 v88, v88
    v_exp_f32 v89, v89
    v_smfmac_f32_32x32x32_bf16 v[112:127], v[48:51], v[80:87], v39
    ds_read_b128 v[40:43], v13 offset:4608
    v_exp_f32 v90, v90
    v_exp_f32 v91, v91
    v_exp_f32 v92, v92
    v_exp_f32 v93, v93
    v_exp_f32 v94, v94
    v_exp_f32 v95, v95
    v_exp_f32 v64, v64
    v_exp_f32 v65, v65
    v_smfmac_f32_32x32x32_bf16 v[112:127], v[52:55], v[88:95], v39
    ds_read_b128 v[48:51], v16 offset:4608
    v_exp_f32 v66, v66
    v_exp_f32 v67, v67
    v_exp_f32 v68, v68
    v_mfma_f32_32x32x16_bf16 v[80:95], v[44:47], v[28:31], 0
    ds_read_b128 v[52:55], v19 offset:4608
    v_exp_f32 v69, v69
    v_exp_f32 v70, v70
    v_exp_f32 v71, v71
    v_exp_f32 v72, v72
    v_exp_f32 v73, v73
    v_smfmac_f32_32x32x32_bf16 v[96:111], v[56:59], v[64:71], v39
    global_load_dwordx4 a[48:51], v3, s[56:57] offset:0
    global_load_dwordx4 a[52:55], v3, s[56:57] offset:1024
    v_exp_f32 v74, v74
    v_exp_f32 v75, v75
    v_exp_f32 v76, v76
    v_exp_f32 v77, v77
    v_exp_f32 v78, v78
    v_exp_f32 v79, v79
    v_exp_f32 v80, v80
    v_exp_f32 v81, v81
    v_smfmac_f32_32x32x32_bf16 v[96:111], v[60:63], v[72:79], v39
    s_waitcnt lgkmcnt(0)
    v_exp_f32 v82, v82
    v_exp_f32 v83, v83
    v_exp_f32 v84, v84
    v_mfma_f32_32x32x16_bf16 v[64:79], v[40:43], v[24:27], 0
    global_store_dword v10, v32, s[46:47] sc0 sc1
    v_exp_f32 v85, v85
    v_exp_f32 v86, v86
    v_exp_f32 v87, v87
    v_exp_f32 v88, v88
    v_exp_f32 v89, v89
    v_smfmac_f32_32x32x32_bf16 v[112:127], v[56:59], v[80:87], v39
    ds_read_b128 v[44:47], v13 offset:6912
    v_exp_f32 v90, v90
    v_exp_f32 v91, v91
    v_exp_f32 v92, v92
    v_exp_f32 v93, v93
    v_exp_f32 v94, v94
    v_exp_f32 v95, v95
    v_exp_f32 v64, v64
    v_exp_f32 v65, v65
    v_smfmac_f32_32x32x32_bf16 v[112:127], v[60:63], v[88:95], v39
    ds_read_b128 v[56:59], v16 offset:6912
    v_exp_f32 v66, v66
    v_exp_f32 v67, v67
    v_exp_f32 v68, v68
    v_mfma_f32_32x32x16_bf16 v[80:95], v[40:43], v[28:31], 0
    ds_read_b128 v[60:63], v19 offset:6912
    v_exp_f32 v69, v69
    v_exp_f32 v70, v70
    v_exp_f32 v71, v71
    v_exp_f32 v72, v72
    v_exp_f32 v73, v73
    v_smfmac_f32_32x32x32_bf16 v[96:111], v[48:51], v[64:71], v39
    global_load_dwordx4 a[56:59], v3, s[56:57] offset:2048
    global_load_dwordx4 a[60:63], v3, s[56:57] offset:3072
    v_exp_f32 v74, v74
    v_exp_f32 v75, v75
    v_exp_f32 v76, v76
    v_exp_f32 v77, v77
    v_exp_f32 v78, v78
    v_exp_f32 v79, v79
    v_exp_f32 v80, v80
    v_exp_f32 v81, v81
    v_smfmac_f32_32x32x32_bf16 v[96:111], v[52:55], v[72:79], v39
    s_waitcnt lgkmcnt(0)
    s_add_u32 m0, s25, 101376
    v_exp_f32 v82, v82
    v_exp_f32 v83, v83
    v_exp_f32 v84, v84
    v_mfma_f32_32x32x16_bf16 v[64:79], v[44:47], v[24:27], 0
    global_load_lds_dwordx4 v6, s[18:19]
    v_exp_f32 v85, v85
    v_exp_f32 v86, v86
    v_exp_f32 v87, v87
    v_exp_f32 v88, v88
    v_exp_f32 v89, v89
    v_smfmac_f32_32x32x32_bf16 v[112:127], v[48:51], v[80:87], v39
    ds_read_b128 v[40:43], v13 offset:9216
    v_exp_f32 v90, v90
    v_exp_f32 v91, v91
    v_exp_f32 v92, v92
    v_exp_f32 v93, v93
    v_exp_f32 v94, v94
    v_exp_f32 v95, v95
    v_exp_f32 v64, v64
    v_exp_f32 v65, v65
    v_smfmac_f32_32x32x32_bf16 v[112:127], v[52:55], v[88:95], v39
    ds_read_b128 v[48:51], v16 offset:9216
    v_exp_f32 v66, v66
    v_exp_f32 v67, v67
    v_exp_f32 v68, v68
    v_mfma_f32_32x32x16_bf16 v[80:95], v[44:47], v[28:31], 0
    ds_read_b128 v[52:55], v19 offset:9216
    v_exp_f32 v69, v69
    v_exp_f32 v70, v70
    v_exp_f32 v71, v71
    v_exp_f32 v72, v72
    v_exp_f32 v73, v73
    v_smfmac_f32_32x32x32_bf16 v[96:111], v[56:59], v[64:71], v39
    global_load_lds_dwordx4 v6, s[18:19] offset:1024
    v_exp_f32 v74, v74
    v_exp_f32 v75, v75
    v_exp_f32 v76, v76
    v_exp_f32 v77, v77
    v_exp_f32 v78, v78
    v_exp_f32 v79, v79
    v_exp_f32 v80, v80
    v_exp_f32 v81, v81
    v_smfmac_f32_32x32x32_bf16 v[96:111], v[60:63], v[72:79], v39
    s_waitcnt lgkmcnt(0)
    v_exp_f32 v82, v82
    v_exp_f32 v83, v83
    v_exp_f32 v84, v84
    v_mfma_f32_32x32x16_bf16 v[64:79], v[40:43], v[24:27], 0
    global_load_dwordx4 a[64:67], v2, s[58:59] offset:-4096
    global_load_dwordx4 a[68:71], v2, s[58:59] offset:-3072
    v_exp_f32 v85, v85
    v_exp_f32 v86, v86
    v_exp_f32 v87, v87
    v_exp_f32 v88, v88
    v_exp_f32 v89, v89
    v_smfmac_f32_32x32x32_bf16 v[112:127], v[56:59], v[80:87], v39
    ds_read_b128 v[44:47], v13 offset:11520
    v_exp_f32 v90, v90
    v_exp_f32 v91, v91
    v_exp_f32 v92, v92
    v_exp_f32 v93, v93
    v_exp_f32 v94, v94
    v_exp_f32 v95, v95
    v_exp_f32 v64, v64
    v_exp_f32 v65, v65
    v_smfmac_f32_32x32x32_bf16 v[112:127], v[60:63], v[88:95], v39
    ds_read_b128 v[56:59], v16 offset:11520
    v_exp_f32 v66, v66
    v_exp_f32 v67, v67
    v_exp_f32 v68, v68
    v_mfma_f32_32x32x16_bf16 v[80:95], v[40:43], v[28:31], 0
    ds_read_b128 v[60:63], v19 offset:11520
    v_exp_f32 v69, v69
    v_exp_f32 v70, v70
    v_exp_f32 v71, v71
    v_exp_f32 v72, v72
    v_exp_f32 v73, v73
    v_smfmac_f32_32x32x32_bf16 v[96:111], v[48:51], v[64:71], v39
    global_load_dwordx4 a[72:75], v2, s[58:59] offset:-2048
    global_load_dwordx4 a[76:79], v2, s[58:59] offset:-1024
    v_exp_f32 v74, v74
    v_exp_f32 v75, v75
    v_exp_f32 v76, v76
    v_exp_f32 v77, v77
    v_exp_f32 v78, v78
    v_exp_f32 v79, v79
    v_exp_f32 v80, v80
    v_exp_f32 v81, v81
    v_smfmac_f32_32x32x32_bf16 v[96:111], v[52:55], v[72:79], v39
    s_waitcnt lgkmcnt(0)
    v_exp_f32 v82, v82
    v_exp_f32 v83, v83
    v_exp_f32 v84, v84
    v_mfma_f32_32x32x16_bf16 v[64:79], v[44:47], v[24:27], 0
    global_load_dwordx4 a[80:83], v2, s[58:59] offset:0
    global_load_dwordx4 a[84:87], v2, s[58:59] offset:1024
    v_exp_f32 v85, v85
    v_exp_f32 v86, v86
    v_exp_f32 v87, v87
    v_exp_f32 v88, v88
    v_exp_f32 v89, v89
    v_smfmac_f32_32x32x32_bf16 v[112:127], v[48:51], v[80:87], v39
    ds_read_b128 v[40:43], v13 offset:13824
    v_exp_f32 v90, v90
    v_exp_f32 v91, v91
    v_exp_f32 v92, v92
    v_exp_f32 v93, v93
    v_exp_f32 v94, v94
    v_exp_f32 v95, v95
    v_exp_f32 v64, v64
    v_exp_f32 v65, v65
    v_smfmac_f32_32x32x32_bf16 v[112:127], v[52:55], v[88:95], v39
    ds_read_b128 v[48:51], v16 offset:13824
    v_exp_f32 v66, v66
    v_exp_f32 v67, v67
    v_exp_f32 v68, v68
    v_mfma_f32_32x32x16_bf16 v[80:95], v[44:47], v[28:31], 0
    ds_read_b128 v[52:55], v19 offset:13824
    v_exp_f32 v69, v69
    v_exp_f32 v70, v70
    v_exp_f32 v71, v71
    v_exp_f32 v72, v72
    v_exp_f32 v73, v73
    v_smfmac_f32_32x32x32_bf16 v[96:111], v[56:59], v[64:71], v39
    global_load_dwordx4 a[88:91], v2, s[58:59] offset:2048
    global_load_dwordx4 a[92:95], v2, s[58:59] offset:3072
    v_exp_f32 v74, v74
    v_exp_f32 v75, v75
    v_exp_f32 v76, v76
    v_exp_f32 v77, v77
    v_exp_f32 v78, v78
    v_exp_f32 v79, v79
    v_exp_f32 v80, v80
    v_exp_f32 v81, v81
    v_smfmac_f32_32x32x32_bf16 v[96:111], v[60:63], v[72:79], v39
    s_waitcnt lgkmcnt(0)
    v_exp_f32 v82, v82
    v_exp_f32 v83, v83
    v_exp_f32 v84, v84
    v_mfma_f32_32x32x16_bf16 v[64:79], v[40:43], v[24:27], 0
    global_load_dwordx4 a[96:99], v3, s[58:59] offset:-4096
    global_load_dwordx4 a[100:103], v3, s[58:59] offset:-3072
    v_exp_f32 v85, v85
    v_exp_f32 v86, v86
    v_exp_f32 v87, v87
    v_exp_f32 v88, v88
    v_exp_f32 v89, v89
    v_smfmac_f32_32x32x32_bf16 v[112:127], v[56:59], v[80:87], v39
    ds_read_b128 v[44:47], v13 offset:16128
    v_exp_f32 v90, v90
    v_exp_f32 v91, v91
    v_exp_f32 v92, v92
    v_exp_f32 v93, v93
    v_exp_f32 v94, v94
    v_exp_f32 v95, v95
    v_exp_f32 v64, v64
    v_exp_f32 v65, v65
    v_smfmac_f32_32x32x32_bf16 v[112:127], v[60:63], v[88:95], v39
    ds_read_b128 v[56:59], v16 offset:16128
    v_exp_f32 v66, v66
    v_exp_f32 v67, v67
    v_exp_f32 v68, v68
    v_mfma_f32_32x32x16_bf16 v[80:95], v[40:43], v[28:31], 0
    ds_read_b128 v[60:63], v19 offset:16128
    v_exp_f32 v69, v69
    v_exp_f32 v70, v70
    v_exp_f32 v71, v71
    v_exp_f32 v72, v72
    v_exp_f32 v73, v73
    v_smfmac_f32_32x32x32_bf16 v[96:111], v[48:51], v[64:71], v39
    global_load_dwordx4 a[104:107], v3, s[58:59] offset:-2048
    global_load_dwordx4 a[108:111], v3, s[58:59] offset:-1024
    v_exp_f32 v74, v74
    v_exp_f32 v75, v75
    v_exp_f32 v76, v76
    v_exp_f32 v77, v77
    v_exp_f32 v78, v78
    v_exp_f32 v79, v79
    v_exp_f32 v80, v80
    v_exp_f32 v81, v81
    v_smfmac_f32_32x32x32_bf16 v[96:111], v[52:55], v[72:79], v39
    s_waitcnt lgkmcnt(0)
    s_add_u32 m0, s25, 110592
    v_exp_f32 v82, v82
    v_exp_f32 v83, v83
    v_exp_f32 v84, v84
    v_mfma_f32_32x32x16_bf16 v[64:79], v[44:47], v[24:27], 0
    global_load_lds_dwordx4 v7, s[18:19]
    v_exp_f32 v85, v85
    v_exp_f32 v86, v86
    v_exp_f32 v87, v87
    v_exp_f32 v88, v88
    v_exp_f32 v89, v89
    v_smfmac_f32_32x32x32_bf16 v[112:127], v[48:51], v[80:87], v39
    ds_read_b128 v[40:43], v13 offset:18432
    v_exp_f32 v90, v90
    v_exp_f32 v91, v91
    v_exp_f32 v92, v92
    v_exp_f32 v93, v93
    v_exp_f32 v94, v94
    v_exp_f32 v95, v95
    v_exp_f32 v64, v64
    v_exp_f32 v65, v65
    v_smfmac_f32_32x32x32_bf16 v[112:127], v[52:55], v[88:95], v39
    ds_read_b128 v[48:51], v16 offset:18432
    v_exp_f32 v66, v66
    v_exp_f32 v67, v67
    v_exp_f32 v68, v68
    v_mfma_f32_32x32x16_bf16 v[80:95], v[44:47], v[28:31], 0
    ds_read_b128 v[52:55], v19 offset:18432
    v_exp_f32 v69, v69
    v_exp_f32 v70, v70
    v_exp_f32 v71, v71
    v_exp_f32 v72, v72
    v_exp_f32 v73, v73
    v_smfmac_f32_32x32x32_bf16 v[96:111], v[56:59], v[64:71], v39
    global_load_lds_dwordx4 v7, s[18:19] offset:1024
    v_exp_f32 v74, v74
    v_exp_f32 v75, v75
    v_exp_f32 v76, v76
    v_exp_f32 v77, v77
    v_exp_f32 v78, v78
    v_exp_f32 v79, v79
    v_exp_f32 v80, v80
    v_exp_f32 v81, v81
    v_smfmac_f32_32x32x32_bf16 v[96:111], v[60:63], v[72:79], v39
    s_waitcnt lgkmcnt(0)
    v_exp_f32 v82, v82
    v_exp_f32 v83, v83
    v_exp_f32 v84, v84
    v_mfma_f32_32x32x16_bf16 v[64:79], v[40:43], v[24:27], 0
    global_load_dwordx4 a[112:115], v3, s[58:59] offset:0
    global_load_dwordx4 a[116:119], v3, s[58:59] offset:1024
    v_exp_f32 v85, v85
    v_exp_f32 v86, v86
    v_exp_f32 v87, v87
    v_exp_f32 v88, v88
    v_exp_f32 v89, v89
    v_smfmac_f32_32x32x32_bf16 v[112:127], v[56:59], v[80:87], v39
    ds_read_b128 v[44:47], v13 offset:20736
    v_exp_f32 v90, v90
    v_exp_f32 v91, v91
    v_exp_f32 v92, v92
    v_exp_f32 v93, v93
    v_exp_f32 v94, v94
    v_exp_f32 v95, v95
    v_exp_f32 v64, v64
    v_exp_f32 v65, v65
    v_smfmac_f32_32x32x32_bf16 v[112:127], v[60:63], v[88:95], v39
    ds_read_b128 v[56:59], v16 offset:20736
    v_exp_f32 v66, v66
    v_exp_f32 v67, v67
    v_exp_f32 v68, v68
    v_mfma_f32_32x32x16_bf16 v[80:95], v[40:43], v[28:31], 0
    ds_read_b128 v[60:63], v19 offset:20736
    v_exp_f32 v69, v69
    v_exp_f32 v70, v70
    v_exp_f32 v71, v71
    v_exp_f32 v72, v72
    v_exp_f32 v73, v73
    v_smfmac_f32_32x32x32_bf16 v[96:111], v[48:51], v[64:71], v39
    global_load_dwordx4 a[120:123], v3, s[58:59] offset:2048
    global_load_dwordx4 a[124:127], v3, s[58:59] offset:3072
    v_exp_f32 v74, v74
    v_exp_f32 v75, v75
    v_exp_f32 v76, v76
    v_exp_f32 v77, v77
    v_exp_f32 v78, v78
    v_exp_f32 v79, v79
    v_exp_f32 v80, v80
    v_exp_f32 v81, v81
    v_smfmac_f32_32x32x32_bf16 v[96:111], v[52:55], v[72:79], v39
    s_waitcnt lgkmcnt(0)
    v_exp_f32 v82, v82
    v_exp_f32 v83, v83
    v_exp_f32 v84, v84
    v_mfma_f32_32x32x16_bf16 v[64:79], v[44:47], v[24:27], 0
    global_load_dwordx4 a[128:131], v2, s[60:61] offset:-4096
    global_load_dwordx4 a[132:135], v2, s[60:61] offset:-3072
    v_exp_f32 v85, v85
    v_exp_f32 v86, v86
    v_exp_f32 v87, v87
    v_exp_f32 v88, v88
    v_exp_f32 v89, v89
    v_smfmac_f32_32x32x32_bf16 v[112:127], v[48:51], v[80:87], v39
    ds_read_b128 v[40:43], v13 offset:23040
    v_exp_f32 v90, v90
    v_exp_f32 v91, v91
    v_exp_f32 v92, v92
    v_exp_f32 v93, v93
    v_exp_f32 v94, v94
    v_exp_f32 v95, v95
    v_exp_f32 v64, v64
    v_exp_f32 v65, v65
    v_smfmac_f32_32x32x32_bf16 v[112:127], v[52:55], v[88:95], v39
    ds_read_b128 v[48:51], v16 offset:23040
    v_exp_f32 v66, v66
    v_exp_f32 v67, v67
    v_exp_f32 v68, v68
    v_mfma_f32_32x32x16_bf16 v[80:95], v[44:47], v[28:31], 0
    ds_read_b128 v[52:55], v19 offset:23040
    v_exp_f32 v69, v69
    v_exp_f32 v70, v70
    v_exp_f32 v71, v71
    v_exp_f32 v72, v72
    v_exp_f32 v73, v73
    v_smfmac_f32_32x32x32_bf16 v[96:111], v[56:59], v[64:71], v39
    global_load_dwordx4 a[136:139], v2, s[60:61] offset:-2048
    global_load_dwordx4 a[140:143], v2, s[60:61] offset:-1024
    v_exp_f32 v74, v74
    v_exp_f32 v75, v75
    v_exp_f32 v76, v76
    v_exp_f32 v77, v77
    v_exp_f32 v78, v78
    v_exp_f32 v79, v79
    v_exp_f32 v80, v80
    v_exp_f32 v81, v81
    v_smfmac_f32_32x32x32_bf16 v[96:111], v[60:63], v[72:79], v39
    s_waitcnt lgkmcnt(0)
    v_exp_f32 v82, v82
    v_exp_f32 v83, v83
    v_exp_f32 v84, v84
    v_mfma_f32_32x32x16_bf16 v[64:79], v[40:43], v[24:27], 0
    global_load_dwordx4 a[144:147], v2, s[60:61] offset:0
    global_load_dwordx4 a[148:151], v2, s[60:61] offset:1024
    v_exp_f32 v85, v85
    v_exp_f32 v86, v86
    v_exp_f32 v87, v87
    v_exp_f32 v88, v88
    v_exp_f32 v89, v89
    v_smfmac_f32_32x32x32_bf16 v[112:127], v[56:59], v[80:87], v39
    ds_read_b128 v[44:47], v13 offset:25344
    v_exp_f32 v90, v90
    v_exp_f32 v91, v91
    v_exp_f32 v92, v92
    v_exp_f32 v93, v93
    v_exp_f32 v94, v94
    v_exp_f32 v95, v95
    v_exp_f32 v64, v64
    v_exp_f32 v65, v65
    v_smfmac_f32_32x32x32_bf16 v[112:127], v[60:63], v[88:95], v39
    ds_read_b128 v[56:59], v16 offset:25344
    v_exp_f32 v66, v66
    v_exp_f32 v67, v67
    v_exp_f32 v68, v68
    v_mfma_f32_32x32x16_bf16 v[80:95], v[40:43], v[28:31], 0
    ds_read_b128 v[60:63], v19 offset:25344
    v_exp_f32 v69, v69
    v_exp_f32 v70, v70
    v_exp_f32 v71, v71
    v_exp_f32 v72, v72
    v_exp_f32 v73, v73
    v_smfmac_f32_32x32x32_bf16 v[96:111], v[48:51], v[64:71], v39
    global_load_dwordx4 a[152:155], v2, s[60:61] offset:2048
    global_load_dwordx4 a[156:159], v2, s[60:61] offset:3072
    v_exp_f32 v74, v74
    v_exp_f32 v75, v75
    v_exp_f32 v76, v76
    v_exp_f32 v77, v77
    v_exp_f32 v78, v78
    v_exp_f32 v79, v79
    v_exp_f32 v80, v80
    v_exp_f32 v81, v81
    v_smfmac_f32_32x32x32_bf16 v[96:111], v[52:55], v[72:79], v39
    s_waitcnt vmcnt(12) lgkmcnt(0)
    s_barrier
    s_add_u32 m0, s25, 119808
    v_exp_f32 v82, v82
    v_exp_f32 v83, v83
    v_exp_f32 v84, v84
    v_mfma_f32_32x32x16_bf16 v[64:79], v[44:47], v[24:27], 0
    global_load_lds_dwordx4 v8, s[18:19]
    v_exp_f32 v85, v85
    v_exp_f32 v86, v86
    v_exp_f32 v87, v87
    v_exp_f32 v88, v88
    v_exp_f32 v89, v89
    v_smfmac_f32_32x32x32_bf16 v[112:127], v[48:51], v[80:87], v39
    ds_read_b128 v[40:43], v13 offset:27648
    v_exp_f32 v90, v90
    v_exp_f32 v91, v91
    v_exp_f32 v92, v92
    v_exp_f32 v93, v93
    v_exp_f32 v94, v94
    v_exp_f32 v95, v95
    v_exp_f32 v64, v64
    v_exp_f32 v65, v65
    v_smfmac_f32_32x32x32_bf16 v[112:127], v[52:55], v[88:95], v39
    ds_read_b128 v[48:51], v16 offset:27648
    v_exp_f32 v66, v66
    v_exp_f32 v67, v67
    v_exp_f32 v68, v68
    v_mfma_f32_32x32x16_bf16 v[80:95], v[44:47], v[28:31], 0
    ds_read_b128 v[52:55], v19 offset:27648
    v_exp_f32 v69, v69
    v_exp_f32 v70, v70
    v_exp_f32 v71, v71
    v_exp_f32 v72, v72
    v_exp_f32 v73, v73
    v_smfmac_f32_32x32x32_bf16 v[96:111], v[56:59], v[64:71], v39
    global_load_lds_dwordx4 v8, s[18:19] offset:1024
    s_cmp_lg_u32 s3, 0
    s_cbranch_scc1 k2_L_7
    s_mov_b64 exec, 1
    global_atomic_add v0, v22, s[6:7] offset:384 sc1
    s_mov_b64 exec, -1
k2_L_7:
    v_exp_f32 v74, v74
    v_exp_f32 v75, v75
    v_exp_f32 v76, v76
    v_exp_f32 v77, v77
    v_exp_f32 v78, v78
    v_exp_f32 v79, v79
    v_exp_f32 v80, v80
    v_exp_f32 v81, v81
    v_smfmac_f32_32x32x32_bf16 v[96:111], v[60:63], v[72:79], v39
    s_waitcnt lgkmcnt(0)
    v_exp_f32 v82, v82
    v_exp_f32 v83, v83
    v_exp_f32 v84, v84
    v_mfma_f32_32x32x16_bf16 v[64:79], v[40:43], v[24:27], 0
    global_load_dwordx4 a[160:163], v3, s[60:61] offset:-4096
    global_load_dwordx4 a[164:167], v3, s[60:61] offset:-3072
    v_exp_f32 v85, v85
    v_exp_f32 v86, v86
    v_exp_f32 v87, v87
    v_exp_f32 v88, v88
    v_exp_f32 v89, v89
    v_smfmac_f32_32x32x32_bf16 v[112:127], v[56:59], v[80:87], v39
    ds_read_b128 v[44:47], v13 offset:29952
    v_exp_f32 v90, v90
    v_exp_f32 v91, v91
    v_exp_f32 v92, v92
    v_exp_f32 v93, v93
    v_exp_f32 v94, v94
    v_exp_f32 v95, v95
    v_exp_f32 v64, v64
    v_exp_f32 v65, v65
    v_smfmac_f32_32x32x32_bf16 v[112:127], v[60:63], v[88:95], v39
    ds_read_b128 v[56:59], v16 offset:29952
    v_exp_f32 v66, v66
    v_exp_f32 v67, v67
    v_exp_f32 v68, v68
    v_mfma_f32_32x32x16_bf16 v[80:95], v[40:43], v[28:31], 0
    ds_read_b128 v[60:63], v19 offset:29952
    v_exp_f32 v69, v69
    v_exp_f32 v70, v70
    v_exp_f32 v71, v71
    v_exp_f32 v72, v72
    v_exp_f32 v73, v73
    v_smfmac_f32_32x32x32_bf16 v[96:111], v[48:51], v[64:71], v39
    global_load_dwordx4 a[168:171], v3, s[60:61] offset:-2048
    global_load_dwordx4 a[172:175], v3, s[60:61] offset:-1024
    v_exp_f32 v74, v74
    v_exp_f32 v75, v75
    v_exp_f32 v76, v76
    v_exp_f32 v77, v77
    v_exp_f32 v78, v78
    v_exp_f32 v79, v79
    v_exp_f32 v80, v80
    v_exp_f32 v81, v81
    v_smfmac_f32_32x32x32_bf16 v[96:111], v[52:55], v[72:79], v39
    s_waitcnt lgkmcnt(0)
    s_mul_i32 s96, s16, 180224
    v_exp_f32 v82, v82
    v_exp_f32 v83, v83
    v_exp_f32 v84, v84
    v_mfma_f32_32x32x16_bf16 v[64:79], v[44:47], v[24:27], 0
    global_load_dwordx4 a[176:179], v3, s[60:61] offset:0
    global_load_dwordx4 a[180:183], v3, s[60:61] offset:1024
    v_exp_f32 v85, v85
    v_exp_f32 v86, v86
    v_exp_f32 v87, v87
    v_exp_f32 v88, v88
    v_exp_f32 v89, v89
    v_smfmac_f32_32x32x32_bf16 v[112:127], v[48:51], v[80:87], v39
    ds_read_b128 v[40:43], v13 offset:32256
    v_exp_f32 v90, v90
    v_exp_f32 v91, v91
    v_exp_f32 v92, v92
    v_exp_f32 v93, v93
    v_exp_f32 v94, v94
    v_exp_f32 v95, v95
    v_exp_f32 v64, v64
    v_exp_f32 v65, v65
    v_smfmac_f32_32x32x32_bf16 v[112:127], v[52:55], v[88:95], v39
    ds_read_b128 v[48:51], v16 offset:32256
    v_exp_f32 v66, v66
    v_exp_f32 v67, v67
    v_exp_f32 v68, v68
    v_mfma_f32_32x32x16_bf16 v[80:95], v[44:47], v[28:31], 0
    ds_read_b128 v[52:55], v19 offset:32256
    v_exp_f32 v69, v69
    v_exp_f32 v70, v70
    v_exp_f32 v71, v71
    v_exp_f32 v72, v72
    v_exp_f32 v73, v73
    v_smfmac_f32_32x32x32_bf16 v[96:111], v[56:59], v[64:71], v39
    global_load_dwordx4 a[184:187], v3, s[60:61] offset:2048
    global_load_dwordx4 a[188:191], v3, s[60:61] offset:3072
    v_exp_f32 v74, v74
    v_exp_f32 v75, v75
    v_exp_f32 v76, v76
    v_exp_f32 v77, v77
    v_exp_f32 v78, v78
    v_exp_f32 v79, v79
    v_exp_f32 v80, v80
    v_exp_f32 v81, v81
    v_smfmac_f32_32x32x32_bf16 v[96:111], v[60:63], v[72:79], v39
    s_waitcnt lgkmcnt(0)
    s_mul_i32 s97, s3, 45056
    v_exp_f32 v82, v82
    v_exp_f32 v83, v83
    v_exp_f32 v84, v84
    v_mfma_f32_32x32x16_bf16 v[64:79], v[40:43], v[24:27], 0
    global_load_dwordx4 a[192:195], v2, s[62:63] offset:-4096
    global_load_dwordx4 a[196:199], v2, s[62:63] offset:-3072
    v_exp_f32 v85, v85
    v_exp_f32 v86, v86
    v_exp_f32 v87, v87
    v_exp_f32 v88, v88
    v_exp_f32 v89, v89
    v_smfmac_f32_32x32x32_bf16 v[112:127], v[56:59], v[80:87], v39
    ds_read_b128 v[44:47], v13 offset:34560
    v_exp_f32 v90, v90
    v_exp_f32 v91, v91
    v_exp_f32 v92, v92
    v_exp_f32 v93, v93
    v_exp_f32 v94, v94
    v_exp_f32 v95, v95
    v_exp_f32 v64, v64
    v_exp_f32 v65, v65
    v_smfmac_f32_32x32x32_bf16 v[112:127], v[60:63], v[88:95], v39
    ds_read_b128 v[56:59], v16 offset:34560
    v_exp_f32 v66, v66
    v_exp_f32 v67, v67
    v_exp_f32 v68, v68
    v_mfma_f32_32x32x16_bf16 v[80:95], v[40:43], v[28:31], 0
    ds_read_b128 v[60:63], v19 offset:34560
    v_exp_f32 v69, v69
    v_exp_f32 v70, v70
    v_exp_f32 v71, v71
    v_exp_f32 v72, v72
    v_exp_f32 v73, v73
    v_smfmac_f32_32x32x32_bf16 v[96:111], v[48:51], v[64:71], v39
    global_load_dwordx4 a[200:203], v2, s[62:63] offset:-2048
    global_load_dwordx4 a[204:207], v2, s[62:63] offset:-1024
    v_exp_f32 v74, v74
    v_exp_f32 v75, v75
    v_exp_f32 v76, v76
    v_exp_f32 v77, v77
    v_exp_f32 v78, v78
    v_exp_f32 v79, v79
    v_exp_f32 v80, v80
    v_exp_f32 v81, v81
    v_smfmac_f32_32x32x32_bf16 v[96:111], v[52:55], v[72:79], v39
    s_waitcnt lgkmcnt(0)
    s_add_u32 m0, s25, 129024
    s_add_u32 s96, s96, s97
    v_exp_f32 v82, v82
    v_exp_f32 v83, v83
    v_exp_f32 v84, v84
    v_mfma_f32_32x32x16_bf16 v[64:79], v[44:47], v[24:27], 0
    global_load_lds_dwordx4 v2, s[36:37]
    v_exp_f32 v85, v85
    v_exp_f32 v86, v86
    v_exp_f32 v87, v87
    v_exp_f32 v88, v88
    v_exp_f32 v89, v89
    v_smfmac_f32_32x32x32_bf16 v[112:127], v[48:51], v[80:87], v39
    ds_read_b128 v[40:43], v13 offset:36864
    v_exp_f32 v90, v90
    v_exp_f32 v91, v91
    v_exp_f32 v92, v92
    v_exp_f32 v93, v93
    v_exp_f32 v94, v94
    v_exp_f32 v95, v95
    v_exp_f32 v64, v64
    v_exp_f32 v65, v65
    v_smfmac_f32_32x32x32_bf16 v[112:127], v[52:55], v[88:95], v39
    ds_read_b128 v[48:51], v16 offset:36864
    v_exp_f32 v66, v66
    v_exp_f32 v67, v67
    v_exp_f32 v68, v68
    v_mfma_f32_32x32x16_bf16 v[80:95], v[44:47], v[28:31], 0
    ds_read_b128 v[52:55], v19 offset:36864
    v_exp_f32 v69, v69
    v_exp_f32 v70, v70
    v_exp_f32 v71, v71
    v_exp_f32 v72, v72
    v_exp_f32 v73, v73
    v_smfmac_f32_32x32x32_bf16 v[96:111], v[56:59], v[64:71], v39
    global_load_lds_dwordx4 v2, s[36:37] offset:1024
    v_exp_f32 v74, v74
    v_exp_f32 v75, v75
    v_exp_f32 v76, v76
    v_exp_f32 v77, v77
    v_exp_f32 v78, v78
    v_exp_f32 v79, v79
    v_exp_f32 v80, v80
    v_exp_f32 v81, v81
    v_smfmac_f32_32x32x32_bf16 v[96:111], v[60:63], v[72:79], v39
    s_waitcnt lgkmcnt(0)
    s_add_u32 s96, s96, 16781312
    v_exp_f32 v82, v82
    v_exp_f32 v83, v83
    v_exp_f32 v84, v84
    v_mfma_f32_32x32x16_bf16 v[64:79], v[40:43], v[24:27], 0
    global_load_dwordx4 a[208:211], v2, s[62:63] offset:0
    global_load_dwordx4 a[212:215], v2, s[62:63] offset:1024
    v_exp_f32 v85, v85
    v_exp_f32 v86, v86
    v_exp_f32 v87, v87
    v_exp_f32 v88, v88
    v_exp_f32 v89, v89
    v_smfmac_f32_32x32x32_bf16 v[112:127], v[56:59], v[80:87], v39
    ds_read_b128 v[44:47], v13 offset:39168
    v_exp_f32 v90, v90
    v_exp_f32 v91, v91
    v_exp_f32 v92, v92
    v_exp_f32 v93, v93
    v_exp_f32 v94, v94
    v_exp_f32 v95, v95
    v_exp_f32 v64, v64
    v_exp_f32 v65, v65
    v_smfmac_f32_32x32x32_bf16 v[112:127], v[60:63], v[88:95], v39
    ds_read_b128 v[56:59], v16 offset:39168
    v_exp_f32 v66, v66
    v_exp_f32 v67, v67
    v_exp_f32 v68, v68
    v_mfma_f32_32x32x16_bf16 v[80:95], v[40:43], v[28:31], 0
    ds_read_b128 v[60:63], v19 offset:39168
    v_exp_f32 v69, v69
    v_exp_f32 v70, v70
    v_exp_f32 v71, v71
    v_exp_f32 v72, v72
    v_exp_f32 v73, v73
    v_smfmac_f32_32x32x32_bf16 v[96:111], v[48:51], v[64:71], v39
    global_load_dwordx4 a[216:219], v2, s[62:63] offset:2048
    global_load_dwordx4 a[220:223], v2, s[62:63] offset:3072
    v_exp_f32 v74, v74
    v_exp_f32 v75, v75
    v_exp_f32 v76, v76
    v_exp_f32 v77, v77
    v_exp_f32 v78, v78
    v_exp_f32 v79, v79
    v_exp_f32 v80, v80
    v_exp_f32 v81, v81
    v_smfmac_f32_32x32x32_bf16 v[96:111], v[52:55], v[72:79], v39
    s_waitcnt lgkmcnt(0)
    s_add_u32 s52, s6, s96
    s_addc_u32 s53, s7, 0
    v_exp_f32 v82, v82
    v_exp_f32 v83, v83
    v_exp_f32 v84, v84
    v_mfma_f32_32x32x16_bf16 v[64:79], v[44:47], v[24:27], 0
    global_load_dwordx4 a[224:227], v3, s[62:63] offset:-4096
    global_load_dwordx4 a[228:231], v3, s[62:63] offset:-3072
    v_exp_f32 v85, v85
    v_exp_f32 v86, v86
    v_exp_f32 v87, v87
    v_exp_f32 v88, v88
    v_exp_f32 v89, v89
    v_smfmac_f32_32x32x32_bf16 v[112:127], v[48:51], v[80:87], v39
    ds_read_b128 v[40:43], v13 offset:41472
    v_exp_f32 v90, v90
    v_exp_f32 v91, v91
    v_exp_f32 v92, v92
    v_exp_f32 v93, v93
    v_exp_f32 v94, v94
    v_exp_f32 v95, v95
    v_exp_f32 v64, v64
    v_exp_f32 v65, v65
    v_smfmac_f32_32x32x32_bf16 v[112:127], v[52:55], v[88:95], v39
    ds_read_b128 v[48:51], v16 offset:41472
    v_exp_f32 v66, v66
    v_exp_f32 v67, v67
    v_exp_f32 v68, v68
    v_mfma_f32_32x32x16_bf16 v[80:95], v[44:47], v[28:31], 0
    ds_read_b128 v[52:55], v19 offset:41472
    v_exp_f32 v69, v69
    v_exp_f32 v70, v70
    v_exp_f32 v71, v71
    v_exp_f32 v72, v72
    v_exp_f32 v73, v73
    v_smfmac_f32_32x32x32_bf16 v[96:111], v[56:59], v[64:71], v39
    global_load_dwordx4 a[232:235], v3, s[62:63] offset:-2048
    global_load_dwordx4 a[236:239], v3, s[62:63] offset:-1024
    v_exp_f32 v74, v74
    v_exp_f32 v75, v75
    v_exp_f32 v76, v76
    v_exp_f32 v77, v77
    v_exp_f32 v78, v78
    v_exp_f32 v79, v79
    v_exp_f32 v80, v80
    v_exp_f32 v81, v81
    v_smfmac_f32_32x32x32_bf16 v[96:111], v[60:63], v[72:79], v39
    s_waitcnt lgkmcnt(0)
    s_lshl_b32 s96, s16, 16
    v_exp_f32 v82, v82
    v_exp_f32 v83, v83
    v_exp_f32 v84, v84
    v_mfma_f32_32x32x16_bf16 v[64:79], v[40:43], v[24:27], 0
    global_load_dwordx4 a[240:243], v3, s[62:63] offset:0
    global_load_dwordx4 a[244:247], v3, s[62:63] offset:1024
    v_exp_f32 v85, v85
    v_exp_f32 v86, v86
    v_exp_f32 v87, v87
    v_exp_f32 v88, v88
    v_exp_f32 v89, v89
    v_smfmac_f32_32x32x32_bf16 v[112:127], v[56:59], v[80:87], v39
    ds_read_b128 v[44:47], v13 offset:43776
    v_exp_f32 v90, v90
    v_exp_f32 v91, v91
    v_exp_f32 v92, v92
    v_exp_f32 v93, v93
    v_exp_f32 v94, v94
    v_exp_f32 v95, v95
    v_exp_f32 v64, v64
    v_exp_f32 v65, v65
    v_smfmac_f32_32x32x32_bf16 v[112:127], v[60:63], v[88:95], v39
    ds_read_b128 v[56:59], v16 offset:43776
    v_exp_f32 v66, v66
    v_exp_f32 v67, v67
    v_exp_f32 v68, v68
    v_mfma_f32_32x32x16_bf16 v[80:95], v[40:43], v[28:31], 0
    ds_read_b128 v[60:63], v19 offset:43776
    v_exp_f32 v69, v69
    v_exp_f32 v70, v70
    v_exp_f32 v71, v71
    v_exp_f32 v72, v72
    v_exp_f32 v73, v73
    v_smfmac_f32_32x32x32_bf16 v[96:111], v[48:51], v[64:71], v39
    global_load_dwordx4 a[248:251], v3, s[62:63] offset:2048
    global_load_dwordx4 a[252:255], v3, s[62:63] offset:3072
    v_exp_f32 v74, v74
    v_exp_f32 v75, v75
    v_exp_f32 v76, v76
    v_exp_f32 v77, v77
    v_exp_f32 v78, v78
    v_exp_f32 v79, v79
    v_exp_f32 v80, v80
    v_exp_f32 v81, v81
    v_smfmac_f32_32x32x32_bf16 v[96:111], v[52:55], v[72:79], v39
    s_waitcnt lgkmcnt(0)
    s_add_u32 m0, s25, 138240
    s_add_u32 s54, s8, s96
    s_addc_u32 s55, s9, 0
    v_exp_f32 v82, v82
    v_exp_f32 v83, v83
    v_exp_f32 v84, v84
    v_mfma_f32_32x32x16_bf16 v[64:79], v[44:47], v[24:27], 0
    global_load_lds_dwordx4 v3, s[36:37]
    v_exp_f32 v85, v85
    v_exp_f32 v86, v86
    v_exp_f32 v87, v87
    v_exp_f32 v88, v88
    v_exp_f32 v89, v89
    v_smfmac_f32_32x32x32_bf16 v[112:127], v[48:51], v[80:87], v39
    ds_read_b128 v[40:43], v13 offset:46080
    v_exp_f32 v90, v90
    v_exp_f32 v91, v91
    v_exp_f32 v92, v92
    v_exp_f32 v93, v93
    v_exp_f32 v94, v94
    v_exp_f32 v95, v95
    v_exp_f32 v64, v64
    v_exp_f32 v65, v65
    v_smfmac_f32_32x32x32_bf16 v[112:127], v[52:55], v[88:95], v39
    ds_read_b128 v[48:51], v16 offset:46080
    v_exp_f32 v66, v66
    v_exp_f32 v67, v67
    v_exp_f32 v68, v68
    v_mfma_f32_32x32x16_bf16 v[80:95], v[44:47], v[28:31], 0
    ds_read_b128 v[52:55], v19 offset:46080
    v_exp_f32 v69, v69
    v_exp_f32 v70, v70
    v_exp_f32 v71, v71
    v_exp_f32 v72, v72
    v_exp_f32 v73, v73
    v_smfmac_f32_32x32x32_bf16 v[96:111], v[56:59], v[64:71], v39
    global_load_lds_dwordx4 v3, s[36:37] offset:1024
    v_exp_f32 v74, v74
    v_exp_f32 v75, v75
    v_exp_f32 v76, v76
    v_exp_f32 v77, v77
    v_exp_f32 v78, v78
    v_exp_f32 v79, v79
    v_exp_f32 v80, v80
    v_exp_f32 v81, v81
    v_smfmac_f32_32x32x32_bf16 v[96:111], v[60:63], v[72:79], v39
    s_waitcnt lgkmcnt(0)
    v_exp_f32 v82, v82
    v_exp_f32 v83, v83
    v_exp_f32 v84, v84
    v_mfma_f32_32x32x16_bf16 v[64:79], v[40:43], v[24:27], 0
    global_load_dwordx4 v[144:147], v2, s[64:65] offset:-4096
    global_load_dwordx4 v[148:151], v2, s[64:65] offset:-3072
    v_exp_f32 v85, v85
    v_exp_f32 v86, v86
    v_exp_f32 v87, v87
    v_exp_f32 v88, v88
    v_exp_f32 v89, v89
    v_smfmac_f32_32x32x32_bf16 v[112:127], v[56:59], v[80:87], v39
    ds_read_b128 v[44:47], v13 offset:48384
    v_exp_f32 v90, v90
    v_exp_f32 v91, v91
    v_exp_f32 v92, v92
    v_exp_f32 v93, v93
    v_exp_f32 v94, v94
    v_exp_f32 v95, v95
    v_exp_f32 v64, v64
    v_exp_f32 v65, v65
    v_smfmac_f32_32x32x32_bf16 v[112:127], v[60:63], v[88:95], v39
    ds_read_b128 v[56:59], v16 offset:48384
    v_exp_f32 v66, v66
    v_exp_f32 v67, v67
    v_exp_f32 v68, v68
    v_mfma_f32_32x32x16_bf16 v[80:95], v[40:43], v[28:31], 0
    ds_read_b128 v[60:63], v19 offset:48384
    v_exp_f32 v69, v69
    v_exp_f32 v70, v70
    v_exp_f32 v71, v71
    v_exp_f32 v72, v72
    v_exp_f32 v73, v73
    v_smfmac_f32_32x32x32_bf16 v[96:111], v[48:51], v[64:71], v39
    global_load_dwordx4 v[152:155], v2, s[64:65] offset:-2048
    global_load_dwordx4 v[156:159], v2, s[64:65] offset:-1024
    v_exp_f32 v74, v74
    v_exp_f32 v75, v75
    v_exp_f32 v76, v76
    v_exp_f32 v77, v77
    v_exp_f32 v78, v78
    v_exp_f32 v79, v79
    v_exp_f32 v80, v80
    v_exp_f32 v81, v81
    v_smfmac_f32_32x32x32_bf16 v[96:111], v[52:55], v[72:79], v39
    s_waitcnt lgkmcnt(0)
    v_exp_f32 v82, v82
    v_exp_f32 v83, v83
    v_exp_f32 v84, v84
    v_mfma_f32_32x32x16_bf16 v[64:79], v[44:47], v[24:27], 0
    global_load_dwordx4 v[160:163], v2, s[64:65] offset:0
    global_load_dwordx4 v[164:167], v2, s[64:65] offset:1024
    v_exp_f32 v85, v85
    v_exp_f32 v86, v86
    v_exp_f32 v87, v87
    v_exp_f32 v88, v88
    v_exp_f32 v89, v89
    v_smfmac_f32_32x32x32_bf16 v[112:127], v[48:51], v[80:87], v39
    ds_read_b128 v[40:43], v13 offset:50688
    v_exp_f32 v90, v90
    v_exp_f32 v91, v91
    v_exp_f32 v92, v92
    v_exp_f32 v93, v93
    v_exp_f32 v94, v94
    v_exp_f32 v95, v95
    v_exp_f32 v64, v64
    v_exp_f32 v65, v65
    v_smfmac_f32_32x32x32_bf16 v[112:127], v[52:55], v[88:95], v39
    ds_read_b128 v[48:51], v16 offset:50688
    v_exp_f32 v66, v66
    v_exp_f32 v67, v67
    v_exp_f32 v68, v68
    v_mfma_f32_32x32x16_bf16 v[80:95], v[44:47], v[28:31], 0
    ds_read_b128 v[52:55], v19 offset:50688
    v_exp_f32 v69, v69
    v_exp_f32 v70, v70
    v_exp_f32 v71, v71
    v_exp_f32 v72, v72
    v_exp_f32 v73, v73
    v_smfmac_f32_32x32x32_bf16 v[96:111], v[56:59], v[64:71], v39
    global_load_dwordx4 v[168:171], v2, s[64:65] offset:2048
    global_load_dwordx4 v[172:175], v2, s[64:65] offset:3072
    v_exp_f32 v74, v74
    v_exp_f32 v75, v75
    v_exp_f32 v76, v76
    v_exp_f32 v77, v77
    v_exp_f32 v78, v78
    v_exp_f32 v79, v79
    v_exp_f32 v80, v80
    v_exp_f32 v81, v81
    v_smfmac_f32_32x32x32_bf16 v[96:111], v[60:63], v[72:79], v39
    s_waitcnt lgkmcnt(0)
    v_exp_f32 v82, v82
    v_exp_f32 v83, v83
    v_exp_f32 v84, v84
    v_mfma_f32_32x32x16_bf16 v[64:79], v[40:43], v[24:27], 0
    global_load_dwordx4 v[176:179], v3, s[64:65] offset:-4096
    global_load_dwordx4 v[180:183], v3, s[64:65] offset:-3072
    v_exp_f32 v85, v85
    v_exp_f32 v86, v86
    v_exp_f32 v87, v87
    v_exp_f32 v88, v88
    v_exp_f32 v89, v89
    v_smfmac_f32_32x32x32_bf16 v[112:127], v[56:59], v[80:87], v39
    ds_read_b128 v[44:47], v13 offset:52992
    v_exp_f32 v90, v90
    v_exp_f32 v91, v91
    v_exp_f32 v92, v92
    v_exp_f32 v93, v93
    v_exp_f32 v94, v94
    v_exp_f32 v95, v95
    v_exp_f32 v64, v64
    v_exp_f32 v65, v65
    v_smfmac_f32_32x32x32_bf16 v[112:127], v[60:63], v[88:95], v39
    ds_read_b128 v[56:59], v16 offset:52992
    v_exp_f32 v66, v66
    v_exp_f32 v67, v67
    v_exp_f32 v68, v68
    v_mfma_f32_32x32x16_bf16 v[80:95], v[40:43], v[28:31], 0
    ds_read_b128 v[60:63], v19 offset:52992
    v_exp_f32 v69, v69
    v_exp_f32 v70, v70
    v_exp_f32 v71, v71
    v_exp_f32 v72, v72
    v_exp_f32 v73, v73
    v_smfmac_f32_32x32x32_bf16 v[96:111], v[48:51], v[64:71], v39
    global_load_dwordx4 v[184:187], v3, s[64:65] offset:-2048
    global_load_dwordx4 v[188:191], v3, s[64:65] offset:-1024
    v_exp_f32 v74, v74
    v_exp_f32 v75, v75
    v_exp_f32 v76, v76
    v_exp_f32 v77, v77
    v_exp_f32 v78, v78
    v_exp_f32 v79, v79
    v_exp_f32 v80, v80
    v_exp_f32 v81, v81
    v_smfmac_f32_32x32x32_bf16 v[96:111], v[52:55], v[72:79], v39
    s_waitcnt vmcnt(12) lgkmcnt(0)
    s_barrier
    v_exp_f32 v82, v82
    v_exp_f32 v83, v83
    v_exp_f32 v84, v84
    v_mfma_f32_32x32x16_bf16 v[64:79], v[44:47], v[24:27], 0
    global_load_dwordx4 v[192:195], v3, s[64:65] offset:0
    global_load_dwordx4 v[196:199], v3, s[64:65] offset:1024
    v_exp_f32 v85, v85
    v_exp_f32 v86, v86
    v_exp_f32 v87, v87
    v_exp_f32 v88, v88
    v_exp_f32 v89, v89
    v_smfmac_f32_32x32x32_bf16 v[112:127], v[48:51], v[80:87], v39
    ds_read_b128 v[40:43], v13 offset:55296
    v_exp_f32 v90, v90
    v_exp_f32 v91, v91
    v_exp_f32 v92, v92
    v_exp_f32 v93, v93
    v_exp_f32 v94, v94
    v_exp_f32 v95, v95
    v_exp_f32 v64, v64
    v_exp_f32 v65, v65
    v_smfmac_f32_32x32x32_bf16 v[112:127], v[52:55], v[88:95], v39
    ds_read_b128 v[48:51], v16 offset:55296
    v_exp_f32 v66, v66
    v_exp_f32 v67, v67
    v_exp_f32 v68, v68
    v_mfma_f32_32x32x16_bf16 v[80:95], v[44:47], v[28:31], 0
    ds_read_b128 v[52:55], v19 offset:55296
    v_exp_f32 v69, v69
    v_exp_f32 v70, v70
    v_exp_f32 v71, v71
    v_exp_f32 v72, v72
    v_exp_f32 v73, v73
    v_smfmac_f32_32x32x32_bf16 v[96:111], v[56:59], v[64:71], v39
    global_load_dwordx4 v[200:203], v3, s[64:65] offset:2048
    global_load_dwordx4 v[204:207], v3, s[64:65] offset:3072
    v_exp_f32 v74, v74
    v_exp_f32 v75, v75
    v_exp_f32 v76, v76
    v_exp_f32 v77, v77
    v_exp_f32 v78, v78
    v_exp_f32 v79, v79
    v_exp_f32 v80, v80
    v_exp_f32 v81, v81
    v_smfmac_f32_32x32x32_bf16 v[96:111], v[60:63], v[72:79], v39
    s_waitcnt lgkmcnt(0)
    v_exp_f32 v82, v82
    v_exp_f32 v83, v83
    v_exp_f32 v84, v84
    v_mfma_f32_32x32x16_bf16 v[64:79], v[40:43], v[24:27], 0
    global_load_dword v244, v244, s[64:65]
    global_load_dwordx4 v[208:211], v4, s[64:65] offset:-4096
    v_exp_f32 v85, v85
    v_exp_f32 v86, v86
    v_exp_f32 v87, v87
    v_exp_f32 v88, v88
    v_exp_f32 v89, v89
    v_smfmac_f32_32x32x32_bf16 v[112:127], v[56:59], v[80:87], v39
    ds_read_b128 v[44:47], v13 offset:57600
    v_exp_f32 v90, v90
    v_exp_f32 v91, v91
    v_exp_f32 v92, v92
    v_exp_f32 v93, v93
    v_exp_f32 v94, v94
    v_exp_f32 v95, v95
    v_exp_f32 v64, v64
    v_exp_f32 v65, v65
    v_smfmac_f32_32x32x32_bf16 v[112:127], v[60:63], v[88:95], v39
    ds_read_b128 v[56:59], v16 offset:57600
    v_exp_f32 v66, v66
    v_exp_f32 v67, v67
    v_exp_f32 v68, v68
    v_mfma_f32_32x32x16_bf16 v[80:95], v[40:43], v[28:31], 0
    ds_read_b128 v[60:63], v19 offset:57600
    v_exp_f32 v69, v69
    v_exp_f32 v70, v70
    v_exp_f32 v71, v71
    v_exp_f32 v72, v72
    v_exp_f32 v73, v73
    v_smfmac_f32_32x32x32_bf16 v[96:111], v[48:51], v[64:71], v39
    global_load_dwordx4 v[212:215], v4, s[64:65] offset:-3072
    v_exp_f32 v74, v74
    v_exp_f32 v75, v75
    v_exp_f32 v76, v76
    v_exp_f32 v77, v77
    v_exp_f32 v78, v78
    v_exp_f32 v79, v79
    v_exp_f32 v80, v80
    v_exp_f32 v81, v81
    v_smfmac_f32_32x32x32_bf16 v[96:111], v[52:55], v[72:79], v39
    s_waitcnt lgkmcnt(0)
    v_exp_f32 v82, v82
    v_exp_f32 v83, v83
    v_exp_f32 v84, v84
    v_mfma_f32_32x32x16_bf16 v[64:79], v[44:47], v[24:27], 0
    global_load_dwordx4 v[216:219], v4, s[64:65] offset:-2048
    v_exp_f32 v85, v85
    v_exp_f32 v86, v86
    v_exp_f32 v87, v87
    v_exp_f32 v88, v88
    v_exp_f32 v89, v89
    v_smfmac_f32_32x32x32_bf16 v[112:127], v[48:51], v[80:87], v39
    ds_read_b128 v[40:43], v13 offset:59904
    v_exp_f32 v90, v90
    v_exp_f32 v91, v91
    v_exp_f32 v92, v92
    v_exp_f32 v93, v93
    v_exp_f32 v94, v94
    v_exp_f32 v95, v95
    v_exp_f32 v64, v64
    v_exp_f32 v65, v65
    v_smfmac_f32_32x32x32_bf16 v[112:127], v[52:55], v[88:95], v39
    ds_read_b128 v[48:51], v16 offset:59904
    v_exp_f32 v66, v66
    v_exp_f32 v67, v67
    v_exp_f32 v68, v68
    v_mfma_f32_32x32x16_bf16 v[80:95], v[44:47], v[28:31], 0
    ds_read_b128 v[52:55], v19 offset:59904
    v_exp_f32 v69, v69
    v_exp_f32 v70, v70
    v_exp_f32 v71, v71
    v_exp_f32 v72, v72
    v_exp_f32 v73, v73
    v_smfmac_f32_32x32x32_bf16 v[96:111], v[56:59], v[64:71], v39
    global_load_dwordx4 v[220:223], v4, s[64:65] offset:-1024
    v_exp_f32 v74, v74
    v_exp_f32 v75, v75
    v_exp_f32 v76, v76
    v_exp_f32 v77, v77
    v_exp_f32 v78, v78
    v_exp_f32 v79, v79
    v_exp_f32 v80, v80
    v_exp_f32 v81, v81
    v_smfmac_f32_32x32x32_bf16 v[96:111], v[60:63], v[72:79], v39
    s_waitcnt lgkmcnt(0)
    v_exp_f32 v82, v82
    v_exp_f32 v83, v83
    v_exp_f32 v84, v84
    v_mfma_f32_32x32x16_bf16 v[64:79], v[40:43], v[24:27], 0
    global_load_dwordx4 v[224:227], v4, s[64:65] offset:0
    v_exp_f32 v85, v85
    v_exp_f32 v86, v86
    v_exp_f32 v87, v87
    v_exp_f32 v88, v88
    v_exp_f32 v89, v89
    v_smfmac_f32_32x32x32_bf16 v[112:127], v[56:59], v[80:87], v39
    ds_read_b128 v[44:47], v13 offset:62208
    v_exp_f32 v90, v90
    v_exp_f32 v91, v91
    v_exp_f32 v92, v92
    v_exp_f32 v93, v93
    v_exp_f32 v94, v94
    v_exp_f32 v95, v95
    v_exp_f32 v64, v64
    v_exp_f32 v65, v65
    v_smfmac_f32_32x32x32_bf16 v[112:127], v[60:63], v[88:95], v39
    ds_read_b128 v[56:59], v16 offset:62208
    v_exp_f32 v66, v66
    v_exp_f32 v67, v67
    v_exp_f32 v68, v68
    v_mfma_f32_32x32x16_bf16 v[80:95], v[40:43], v[28:31], 0
    ds_read_b128 v[60:63], v19 offset:62208
    v_exp_f32 v69, v69
    v_exp_f32 v70, v70
    v_exp_f32 v71, v71
    v_exp_f32 v72, v72
    v_exp_f32 v73, v73
    v_smfmac_f32_32x32x32_bf16 v[96:111], v[48:51], v[64:71], v39
    global_load_dword v22, v23, s[6:7] offset:384 sc1
    v_exp_f32 v74, v74
    v_exp_f32 v75, v75
    v_exp_f32 v76, v76
    v_exp_f32 v77, v77
    v_exp_f32 v78, v78
    v_exp_f32 v79, v79
    v_exp_f32 v80, v80
    v_exp_f32 v81, v81
    v_smfmac_f32_32x32x32_bf16 v[96:111], v[52:55], v[72:79], v39
    s_waitcnt lgkmcnt(0)
    v_exp_f32 v82, v82
    v_exp_f32 v83, v83
    v_exp_f32 v84, v84
    v_mfma_f32_32x32x16_bf16 v[64:79], v[44:47], v[24:27], 0
    global_load_dword v9, v9, s[92:93] sc1
    v_exp_f32 v85, v85
    v_exp_f32 v86, v86
    v_exp_f32 v87, v87
    v_exp_f32 v88, v88
    v_exp_f32 v89, v89
    v_smfmac_f32_32x32x32_bf16 v[112:127], v[48:51], v[80:87], v39
    ds_read_b128 v[40:43], v14 offset:0
    v_exp_f32 v90, v90
    v_exp_f32 v91, v91
    v_exp_f32 v92, v92
    v_exp_f32 v93, v93
    v_exp_f32 v94, v94
    v_exp_f32 v95, v95
    v_exp_f32 v64, v64
    v_exp_f32 v65, v65
    v_smfmac_f32_32x32x32_bf16 v[112:127], v[52:55], v[88:95], v39
    ds_read_b128 v[48:51], v17 offset:0
    v_exp_f32 v66, v66
    v_exp_f32 v67, v67
    v_exp_f32 v68, v68
    v_mfma_f32_32x32x16_bf16 v[80:95], v[44:47], v[28:31], 0
    ds_read_b128 v[52:55], v20 offset:0
    v_exp_f32 v69, v69
    v_exp_f32 v70, v70
    v_exp_f32 v71, v71
    v_exp_f32 v72, v72
    v_exp_f32 v73, v73
    v_smfmac_f32_32x32x32_bf16 v[96:111], v[56:59], v[64:71], v39
    global_load_dwordx4 v[228:231], v4, s[64:65] offset:1024
    v_exp_f32 v74, v74
    v_exp_f32 v75, v75
    v_exp_f32 v76, v76
    v_exp_f32 v77, v77
    v_exp_f32 v78, v78
    v_exp_f32 v79, v79
    v_exp_f32 v80, v80
    v_exp_f32 v81, v81
    v_smfmac_f32_32x32x32_bf16 v[96:111], v[60:63], v[72:79], v39
    s_waitcnt lgkmcnt(0)
    v_exp_f32 v82, v82
    v_exp_f32 v83, v83
    v_exp_f32 v84, v84
    v_mfma_f32_32x32x16_bf16 v[64:79], v[40:43], v[24:27], 0
    global_load_dword v10, v10, s[46:47] sc1
    v_exp_f32 v85, v85
    v_exp_f32 v86, v86
    v_exp_f32 v87, v87
    v_exp_f32 v88, v88
    v_exp_f32 v89, v89
    v_smfmac_f32_32x32x32_bf16 v[112:127], v[56:59], v[80:87], v39
    ds_read_b128 v[44:47], v14 offset:2304
    v_exp_f32 v90, v90
    v_exp_f32 v91, v91
    v_exp_f32 v92, v92
    v_exp_f32 v93, v93
    v_exp_f32 v94, v94
    v_exp_f32 v95, v95
    v_exp_f32 v64, v64
    v_exp_f32 v65, v65
    v_smfmac_f32_32x32x32_bf16 v[112:127], v[60:63], v[88:95], v39
    ds_read_b128 v[56:59], v17 offset:2304
    v_exp_f32 v66, v66
    v_exp_f32 v67, v67
    v_exp_f32 v68, v68
    v_mfma_f32_32x32x16_bf16 v[80:95], v[40:43], v[28:31], 0
    ds_read_b128 v[60:63], v20 offset:2304
    v_exp_f32 v69, v69
    v_exp_f32 v70, v70
    v_exp_f32 v71, v71
    v_exp_f32 v72, v72
    v_exp_f32 v73, v73
    v_smfmac_f32_32x32x32_bf16 v[96:111], v[48:51], v[64:71], v39
    global_load_dwordx4 v[232:235], v4, s[64:65] offset:2048
    v_exp_f32 v74, v74
    v_exp_f32 v75, v75
    v_exp_f32 v76, v76
    v_exp_f32 v77, v77
    v_exp_f32 v78, v78
    v_exp_f32 v79, v79
    v_exp_f32 v80, v80
    v_exp_f32 v81, v81
    v_smfmac_f32_32x32x32_bf16 v[96:111], v[52:55], v[72:79], v39
    s_waitcnt lgkmcnt(0)
    v_exp_f32 v82, v82
    v_exp_f32 v83, v83
    v_exp_f32 v84, v84
    v_mfma_f32_32x32x16_bf16 v[64:79], v[44:47], v[24:27], 0
    global_load_dwordx4 v[236:239], v4, s[64:65] offset:3072
    v_exp_f32 v85, v85
    v_exp_f32 v86, v86
    v_exp_f32 v87, v87
    v_exp_f32 v88, v88
    v_exp_f32 v89, v89
    v_smfmac_f32_32x32x32_bf16 v[112:127], v[48:51], v[80:87], v39
    ds_read_b128 v[40:43], v14 offset:4608
    v_exp_f32 v90, v90
    v_exp_f32 v91, v91
    v_exp_f32 v92, v92
    v_exp_f32 v93, v93
    v_exp_f32 v94, v94
    v_exp_f32 v95, v95
    v_exp_f32 v64, v64
    v_exp_f32 v65, v65
    v_smfmac_f32_32x32x32_bf16 v[112:127], v[52:55], v[88:95], v39
    ds_read_b128 v[48:51], v17 offset:4608
    v_exp_f32 v66, v66
    v_exp_f32 v67, v67
    v_exp_f32 v68, v68
    v_mfma_f32_32x32x16_bf16 v[80:95], v[44:47], v[28:31], 0
    ds_read_b128 v[52:55], v20 offset:4608
    ds_read_b128 v[44:47], v14 offset:6912
    v_exp_f32 v69, v69
    v_exp_f32 v70, v70
    v_exp_f32 v71, v71
    v_exp_f32 v72, v72
    v_exp_f32 v73, v73
    v_smfmac_f32_32x32x32_bf16 v[96:111], v[56:59], v[64:71], v39
    global_load_dwordx4 v[240:243], v5, s[64:65] offset:-4096
    v_exp_f32 v74, v74
    v_exp_f32 v75, v75
    v_exp_f32 v76, v76
    v_exp_f32 v77, v77
    v_exp_f32 v78, v78
    v_exp_f32 v79, v79
    v_exp_f32 v80, v80
    v_exp_f32 v81, v81
    v_smfmac_f32_32x32x32_bf16 v[96:111], v[60:63], v[72:79], v39
    s_waitcnt lgkmcnt(3)
    v_exp_f32 v82, v82
    v_exp_f32 v83, v83
    v_exp_f32 v84, v84
    v_mfma_f32_32x32x16_bf16 v[64:79], v[40:43], v[24:27], 0
    ds_read_b128 v[40:43], v14 offset:9216
    v_exp_f32 v85, v85
    v_exp_f32 v86, v86
    v_exp_f32 v87, v87
    v_exp_f32 v88, v88
    v_exp_f32 v89, v89
    v_smfmac_f32_32x32x32_bf16 v[112:127], v[56:59], v[80:87], v39
    ds_read_b128 v[56:59], v17 offset:6912
    v_exp_f32 v90, v90
    v_exp_f32 v91, v91
    v_exp_f32 v92, v92
    v_exp_f32 v93, v93
    v_exp_f32 v94, v94
    v_exp_f32 v95, v95
    v_exp_f32 v64, v64
    v_exp_f32 v65, v65
    v_smfmac_f32_32x32x32_bf16 v[112:127], v[60:63], v[88:95], v39
    ds_read_b128 v[60:63], v20 offset:6912
    s_waitcnt lgkmcnt(3)
    v_exp_f32 v66, v66
    v_exp_f32 v67, v67
    v_exp_f32 v68, v68
    v_mfma_f32_32x32x16_bf16 v[80:95], v[44:47], v[24:27], 0
    ds_read_b128 v[44:47], v14 offset:11520
    v_exp_f32 v69, v69
    v_exp_f32 v70, v70
    v_exp_f32 v71, v71
    v_exp_f32 v72, v72
    v_exp_f32 v73, v73
    v_smfmac_f32_32x32x32_bf16 v[96:111], v[48:51], v[64:71], v39
    ds_read_b128 v[48:51], v17 offset:9216
    v_exp_f32 v74, v74
    v_exp_f32 v75, v75
    v_exp_f32 v76, v76
    v_exp_f32 v77, v77
    v_exp_f32 v78, v78
    v_exp_f32 v79, v79
    v_exp_f32 v80, v80
    v_exp_f32 v81, v81
    v_smfmac_f32_32x32x32_bf16 v[96:111], v[52:55], v[72:79], v39
    ds_read_b128 v[52:55], v20 offset:9216
    s_waitcnt lgkmcnt(5)
    v_exp_f32 v82, v82
    v_exp_f32 v83, v83
    v_exp_f32 v84, v84
    v_mfma_f32_32x32x16_bf16 v[64:79], v[40:43], v[24:27], 0
    ds_read_b128 v[40:43], v14 offset:13824
    s_waitcnt lgkmcnt(5)
    v_exp_f32 v85, v85
    v_exp_f32 v86, v86
    v_exp_f32 v87, v87
    v_exp_f32 v88, v88
    v_exp_f32 v89, v89
    v_smfmac_f32_32x32x32_bf16 v[96:111], v[56:59], v[80:87], v39
    ds_read_b128 v[56:59], v17 offset:11520
    s_waitcnt lgkmcnt(5)
    v_exp_f32 v90, v90
    v_exp_f32 v91, v91
    v_exp_f32 v92, v92
    v_exp_f32 v93, v93
    v_exp_f32 v94, v94
    v_exp_f32 v95, v95
    v_exp_f32 v64, v64
    v_exp_f32 v65, v65
    v_smfmac_f32_32x32x32_bf16 v[96:111], v[60:63], v[88:95], v39
    ds_read_b128 v[60:63], v20 offset:11520
    s_waitcnt lgkmcnt(5)
    v_exp_f32 v66, v66
    v_exp_f32 v67, v67
    v_exp_f32 v68, v68
    v_mfma_f32_32x32x16_bf16 v[80:95], v[44:47], v[24:27], 0
    ds_read_b128 v[44:47], v14 offset:16128
    s_waitcnt lgkmcnt(5)
    v_exp_f32 v69, v69
    v_exp_f32 v70, v70
    v_exp_f32 v71, v71
    v_exp_f32 v72, v72
    v_exp_f32 v73, v73
    v_smfmac_f32_32x32x32_bf16 v[96:111], v[48:51], v[64:71], v39
    ds_read_b128 v[48:51], v17 offset:13824
    s_waitcnt lgkmcnt(5)
    v_exp_f32 v74, v74
    v_exp_f32 v75, v75
    v_exp_f32 v76, v76
    v_exp_f32 v77, v77
    v_exp_f32 v78, v78
    v_exp_f32 v79, v79
    v_exp_f32 v80, v80
    v_exp_f32 v81, v81
    v_smfmac_f32_32x32x32_bf16 v[96:111], v[52:55], v[72:79], v39
    ds_read_b128 v[52:55], v20 offset:13824
    s_waitcnt lgkmcnt(5)
    v_exp_f32 v82, v82
    v_exp_f32 v83, v83
    v_exp_f32 v84, v84
    v_mfma_f32_32x32x16_bf16 v[64:79], v[40:43], v[24:27], 0
    ds_read_b128 v[40:43], v14 offset:4608
    s_waitcnt lgkmcnt(5)
    v_exp_f32 v85, v85
    v_exp_f32 v86, v86
    v_exp_f32 v87, v87
    v_exp_f32 v88, v88
    v_exp_f32 v89, v89
    v_smfmac_f32_32x32x32_bf16 v[96:111], v[56:59], v[80:87], v39
    ds_read_b128 v[56:59], v17 offset:16128
    s_waitcnt lgkmcnt(5)
    v_exp_f32 v90, v90
    v_exp_f32 v91, v91
    v_exp_f32 v92, v92
    v_exp_f32 v93, v93
    v_exp_f32 v94, v94
    v_exp_f32 v95, v95
    v_exp_f32 v64, v64
    v_exp_f32 v65, v65
    v_smfmac_f32_32x32x32_bf16 v[96:111], v[60:63], v[88:95], v39
    ds_read_b128 v[60:63], v20 offset:16128
    s_waitcnt lgkmcnt(5)
    v_exp_f32 v66, v66
    v_exp_f32 v67, v67
    v_exp_f32 v68, v68
    v_mfma_f32_32x32x16_bf16 v[80:95], v[44:47], v[24:27], 0
    ds_read_b128 v[44:47], v14 offset:6912
    s_waitcnt lgkmcnt(5)
    v_exp_f32 v69, v69
    v_exp_f32 v70, v70
    v_exp_f32 v71, v71
    v_exp_f32 v72, v72
    v_exp_f32 v73, v73
    v_smfmac_f32_32x32x32_bf16 v[96:111], v[48:51], v[64:71], v39
    ds_read_b128 v[48:51], v17 offset:4608
    s_waitcnt lgkmcnt(5)
    v_exp_f32 v74, v74
    v_exp_f32 v75, v75
    v_exp_f32 v76, v76
    v_exp_f32 v77, v77
    v_exp_f32 v78, v78
    v_exp_f32 v79, v79
    v_exp_f32 v80, v80
    v_exp_f32 v81, v81
    v_smfmac_f32_32x32x32_bf16 v[96:111], v[52:55], v[72:79], v39
    ds_read_b128 v[52:55], v20 offset:4608
    s_waitcnt lgkmcnt(5)
    v_exp_f32 v82, v82
    v_exp_f32 v83, v83
    v_exp_f32 v84, v84
    v_mfma_f32_32x32x16_bf16 v[64:79], v[40:43], v[28:31], 0
    ds_read_b128 v[40:43], v14 offset:9216
    s_waitcnt lgkmcnt(5)
    v_exp_f32 v85, v85
    v_exp_f32 v86, v86
    v_exp_f32 v87, v87
    v_exp_f32 v88, v88
    v_exp_f32 v89, v89
    v_smfmac_f32_32x32x32_bf16 v[96:111], v[56:59], v[80:87], v39
    ds_read_b128 v[56:59], v17 offset:6912
    s_waitcnt lgkmcnt(5)
    v_exp_f32 v90, v90
    v_exp_f32 v91, v91
    v_exp_f32 v92, v92
    v_exp_f32 v93, v93
    v_exp_f32 v94, v94
    v_exp_f32 v95, v95
    s_waitcnt vmcnt(6)
    v_cmp_ne_u32_e64 s[26:27], 32, v22
    v_exp_f32 v64, v64
    v_exp_f32 v65, v65
    v_smfmac_f32_32x32x32_bf16 v[96:111], v[60:63], v[88:95], v39
    ds_read_b128 v[60:63], v20 offset:6912
    s_waitcnt lgkmcnt(5)
    v_exp_f32 v66, v66
    v_exp_f32 v67, v67
    v_exp_f32 v68, v68
    v_mfma_f32_32x32x16_bf16 v[80:95], v[44:47], v[28:31], 0
    ds_read_b128 v[44:47], v14 offset:11520
    s_waitcnt lgkmcnt(5)
    v_exp_f32 v69, v69
    v_exp_f32 v70, v70
    v_exp_f32 v71, v71
    v_exp_f32 v72, v72
    v_exp_f32 v73, v73
    v_smfmac_f32_32x32x32_bf16 v[112:127], v[48:51], v[64:71], v39
    ds_read_b128 v[48:51], v17 offset:9216
    s_waitcnt lgkmcnt(5)
    v_exp_f32 v74, v74
    v_exp_f32 v75, v75
    v_exp_f32 v76, v76
    v_exp_f32 v77, v77
    v_exp_f32 v78, v78
    v_exp_f32 v79, v79
    s_mov_b32 s90, 0x61800000
    s_mov_b32 s91, 0x70800000
    s_or_b32 s26, s26, s0
    s_cmp_lg_u64 s[26:27], 0
    s_cbranch_scc1 k2_MODE
k2_GO:
    v_rcp_f32 v105, v104
    v_pk_mul_f32 v[32:33], v[96:97], 0 op_sel_hi:[1,0]
    v_pk_fma_f32 v[32:33], v[98:99], 0, v[32:33] op_sel_hi:[1,0,1]
    v_pk_fma_f32 v[32:33], v[100:101], 0, v[32:33] op_sel_hi:[1,0,1]
    v_pk_fma_f32 v[32:33], v[102:103], 0, v[32:33] op_sel_hi:[1,0,1]
    v_pk_mul_f32 v[34:35], v[104:105], s[90:91]
    v_pk_fma_f32 v[32:33], v[34:35], 0, v[32:33] op_sel_hi:[1,0,1]
    v_cmp_u_f32_e64 s[26:27], v32, v33
    v_pk_mul_f32 v[96:97], v[96:97], v[104:105] op_sel:[0,1] op_sel_hi:[1,1]
    v_pk_mul_f32 v[98:99], v[98:99], v[104:105] op_sel:[0,1] op_sel_hi:[1,1]
    v_pk_mul_f32 v[100:101], v[100:101], v[104:105] op_sel:[0,1] op_sel_hi:[1,1]
    v_pk_mul_f32 v[102:103], v[102:103], v[104:105] op_sel:[0,1] op_sel_hi:[1,1]
    v_cvt_pk_bf16_f32 v108, v96, v97
    v_cvt_pk_bf16_f32 v109, v98, v99
    v_cvt_pk_bf16_f32 v110, v100, v101
    v_cvt_pk_bf16_f32 v111, v102, v103
    s_add_u32 s92, s22, 32768
    s_addc_u32 s93, s23, 0
    s_cmp_lg_u64 s[26:27], 0
    s_cbranch_scc1 k2_L_8S
    global_store_dwordx4 v21, v[108:111], s[22:23] sc0 sc1
k2_L_8B:
    v_exp_f32 v80, v80
    v_exp_f32 v81, v81
    v_smfmac_f32_32x32x32_bf16 v[112:127], v[52:55], v[72:79], v39
    ds_read_b128 v[52:55], v20 offset:9216
    s_waitcnt lgkmcnt(5)
    v_exp_f32 v82, v82
    v_exp_f32 v83, v83
    v_exp_f32 v84, v84
    v_mfma_f32_32x32x16_bf16 v[64:79], v[40:43], v[28:31], 0
    ds_read_b128 v[40:43], v14 offset:13824
    s_waitcnt lgkmcnt(5)
    v_exp_f32 v85, v85
    v_exp_f32 v86, v86
    v_exp_f32 v87, v87
    v_exp_f32 v88, v88
    v_exp_f32 v89, v89
    v_smfmac_f32_32x32x32_bf16 v[112:127], v[56:59], v[80:87], v39
    ds_read_b128 v[56:59], v17 offset:11520
    s_waitcnt lgkmcnt(5)
    v_exp_f32 v90, v90
    v_exp_f32 v91, v91
    v_exp_f32 v92, v92
    v_exp_f32 v93, v93
    v_exp_f32 v94, v94
    v_exp_f32 v95, v95
    v_exp_f32 v64, v64
    v_exp_f32 v65, v65
    v_smfmac_f32_32x32x32_bf16 v[112:127], v[60:63], v[88:95], v39
    ds_read_b128 v[60:63], v20 offset:11520
    s_waitcnt lgkmcnt(5)
    v_exp_f32 v66, v66
    v_exp_f32 v67, v67
    v_exp_f32 v68, v68
    v_mfma_f32_32x32x16_bf16 v[80:95], v[44:47], v[28:31], 0
    ds_read_b128 v[44:47], v14 offset:16128
    s_waitcnt lgkmcnt(5)
    v_exp_f32 v69, v69
    v_exp_f32 v70, v70
    v_exp_f32 v71, v71
    v_exp_f32 v72, v72
    v_exp_f32 v73, v73
    v_smfmac_f32_32x32x32_bf16 v[112:127], v[48:51], v[64:71], v39
    ds_read_b128 v[48:51], v17 offset:13824
    s_waitcnt lgkmcnt(5)
    v_exp_f32 v74, v74
    v_exp_f32 v75, v75
    v_exp_f32 v76, v76
    v_exp_f32 v77, v77
    v_exp_f32 v78, v78
    v_exp_f32 v79, v79
    v_exp_f32 v80, v80
    v_exp_f32 v81, v81
    v_smfmac_f32_32x32x32_bf16 v[112:127], v[52:55], v[72:79], v39
    ds_read_b128 v[52:55], v20 offset:13824
    s_waitcnt lgkmcnt(5)
    v_exp_f32 v82, v82
    v_exp_f32 v83, v83
    v_exp_f32 v84, v84
    v_mfma_f32_32x32x16_bf16 v[64:79], v[40:43], v[28:31], 0
    s_waitcnt lgkmcnt(4)
    v_exp_f32 v85, v85
    v_exp_f32 v86, v86
    v_exp_f32 v87, v87
    v_exp_f32 v88, v88
    v_exp_f32 v89, v89
    v_smfmac_f32_32x32x32_bf16 v[112:127], v[56:59], v[80:87], v39
    ds_read_b128 v[56:59], v17 offset:16128
    s_waitcnt lgkmcnt(4)
    v_exp_f32 v90, v90
    v_exp_f32 v91, v91
    v_exp_f32 v92, v92
    v_exp_f32 v93, v93
    v_exp_f32 v94, v94
    v_exp_f32 v95, v95
    v_exp_f32 v64, v64
    v_exp_f32 v65, v65
    v_smfmac_f32_32x32x32_bf16 v[112:127], v[60:63], v[88:95], v39
    ds_read_b128 v[60:63], v20 offset:16128
    s_waitcnt lgkmcnt(4)
    v_exp_f32 v66, v66
    v_exp_f32 v67, v67
    v_exp_f32 v68, v68
    v_mfma_f32_32x32x16_bf16 v[80:95], v[44:47], v[28:31], 0
    global_load_dwordx4 v[96:99], v2, s[34:35] offset:0 sc1
    s_waitcnt lgkmcnt(3)
    v_exp_f32 v69, v69
    v_exp_f32 v70, v70
    v_exp_f32 v71, v71
    v_exp_f32 v72, v72
    v_exp_f32 v73, v73
    v_smfmac_f32_32x32x32_bf16 v[112:127], v[48:51], v[64:71], v39
    global_load_dwordx4 v[100:103], v2, s[34:35] offset:1024 sc1
    s_waitcnt lgkmcnt(2)
    v_exp_f32 v74, v74
    v_exp_f32 v75, v75
    v_exp_f32 v76, v76
    v_exp_f32 v77, v77
    v_exp_f32 v78, v78
    v_exp_f32 v79, v79
    v_exp_f32 v80, v80
    v_exp_f32 v81, v81
    v_smfmac_f32_32x32x32_bf16 v[112:127], v[52:55], v[72:79], v39
    global_load_dwordx4 v[104:107], v2, s[34:35] offset:2048 sc1
    v_exp_f32 v82, v82
    v_exp_f32 v83, v83
    v_exp_f32 v84, v84
    global_load_dwordx4 v[108:111], v2, s[34:35] offset:3072 sc1
    s_waitcnt lgkmcnt(1)
    v_exp_f32 v85, v85
    v_exp_f32 v86, v86
    v_exp_f32 v87, v87
    v_exp_f32 v88, v88
    v_exp_f32 v89, v89
    v_smfmac_f32_32x32x32_bf16 v[112:127], v[56:59], v[80:87], v39
    global_load_dwordx4 v[64:67], v4, s[34:35] offset:0 sc1
    s_waitcnt lgkmcnt(0)
    v_exp_f32 v90, v90
    v_exp_f32 v91, v91
    v_exp_f32 v92, v92
    v_exp_f32 v93, v93
    v_exp_f32 v94, v94
    v_exp_f32 v95, v95
    s_nop 1
    v_smfmac_f32_32x32x32_bf16 v[112:127], v[60:63], v[88:95], v39
    global_load_dwordx4 v[68:71], v4, s[34:35] offset:1024 sc1
    global_load_dwordx4 v[72:75], v4, s[34:35] offset:2048 sc1
    global_load_dwordx4 v[76:79], v4, s[34:35] offset:3072 sc1
    v_lshlrev_b32 v128, 16, v130
    v_and_b32 v129, 0xffff0000, v130
    v_lshlrev_b32 v130, 16, v131
    v_and_b32 v131, 0xffff0000, v131
    v_lshlrev_b32 v132, 16, v134
    v_and_b32 v133, 0xffff0000, v134
    v_lshlrev_b32 v134, 16, v135
    v_and_b32 v135, 0xffff0000, v135
    s_nop 0
    v_rcp_f32 v121, v120
    v_pk_mul_f32 v[32:33], v[112:113], 0 op_sel_hi:[1,0]
    v_pk_fma_f32 v[32:33], v[114:115], 0, v[32:33] op_sel_hi:[1,0,1]
    v_pk_fma_f32 v[32:33], v[116:117], 0, v[32:33] op_sel_hi:[1,0,1]
    v_pk_fma_f32 v[32:33], v[118:119], 0, v[32:33] op_sel_hi:[1,0,1]
    v_pk_mul_f32 v[34:35], v[120:121], s[90:91]
    v_pk_fma_f32 v[32:33], v[34:35], 0, v[32:33] op_sel_hi:[1,0,1]
    v_cmp_u_f32_e64 s[26:27], v32, v33
    v_pk_mul_f32 v[112:113], v[112:113], v[120:121] op_sel:[0,1] op_sel_hi:[1,1]
    v_pk_mul_f32 v[114:115], v[114:115], v[120:121] op_sel:[0,1] op_sel_hi:[1,1]
    v_pk_mul_f32 v[116:117], v[116:117], v[120:121] op_sel:[0,1] op_sel_hi:[1,1]
    v_pk_mul_f32 v[118:119], v[118:119], v[120:121] op_sel:[0,1] op_sel_hi:[1,1]
    v_cvt_pk_bf16_f32 v124, v112, v113
    v_cvt_pk_bf16_f32 v125, v114, v115
    v_cvt_pk_bf16_f32 v126, v116, v117
    v_cvt_pk_bf16_f32 v127, v118, v119
    s_or_b64 s[24:25], s[26:27], s[28:29]
    s_cbranch_scc1 k2_L_9
    global_store_dwordx4 v21, v[124:127], s[92:93] sc0 sc1
    s_waitcnt vmcnt(5)
    v_max3_u32 v36, v96, v100, v104
    v_max_u32 v36, v36, v108
    v_cmp_eq_u32_e64 s[20:21], -1, v36
    v_lshlrev_b32 v136, 16, v138
    v_and_b32 v137, 0xffff0000, v138
    v_lshlrev_b32 v138, 16, v139
    v_and_b32 v139, 0xffff0000, v139
    s_cmp_lg_u64 s[20:21], 0
    s_cbranch_scc1 k2_L_11S
k2_L_11B:
    v_mfma_f32_16x16x32_bf16 v[44:47], a[4:7], v[96:99], 0
    v_and_b32 v60, 15, v1
    v_lshrrev_b32 v61, 4, v1
    v_lshlrev_b32 v140, 16, v142
    v_mfma_f32_16x16x32_bf16 v[48:51], a[8:11], v[96:99], 0
    s_lshl_b32 s31, s3, 10
    v_and_b32 v141, 0xffff0000, v142
    v_lshlrev_b32 v142, 16, v143
    v_mfma_f32_16x16x32_bf16 v[52:55], a[12:15], v[96:99], 0
    s_add_u32 s31, s31, 65536
    v_and_b32 v17, 0xf0, v2
    v_lshl_add_u32 v14, v61, 8, s31
    s_add_u32 s17, s3, 1
    s_and_b32 s17, s17, 3
    s_mul_i32 s17, s17, 3072
    s_add_u32 s17, s17, 110592
    v_add_u32 v9, s17, v2
    v_mfma_f32_16x16x32_bf16 v[44:47], a[20:23], v[100:103], v[44:47]
    v_bfe_u32 v0, v2, 8, 1
    v_lshl_add_u32 v17, v0, 3, v17
    v_mfma_f32_16x16x32_bf16 v[48:51], a[24:27], v[100:103], v[48:51]
    v_lshrrev_b32 v0, 9, v2
    v_lshl_add_u32 v17, v0, 8, v17
    s_add_u32 s17, s3, 2
    s_and_b32 s17, s17, 3
    s_mul_i32 s17, s17, 3072
    s_add_u32 s17, s17, 111616
    v_add_u32 v10, s17, v2
    v_mfma_f32_16x16x32_bf16 v[52:55], a[28:31], v[100:103], v[52:55]
    v_lshl_add_u32 v14, v60, 3, v14
    v_mov_b32 v28, s33
    v_mfma_f32_16x16x32_bf16 v[44:47], a[36:39], v[104:107], v[44:47]
    s_waitcnt vmcnt(1)
    v_max3_u32 v36, v64, v68, v72
    v_max_u32 v36, v36, v76
    s_add_u32 s17, s3, 3
    s_and_b32 s17, s17, 3
    s_mul_i32 s17, s17, 3072
    s_add_u32 s17, s17, 112640
    v_add_u32 v11, s17, v2
    v_mfma_f32_16x16x32_bf16 v[48:51], a[40:43], v[104:107], v[48:51]
    v_cmp_eq_u32_e64 s[24:25], -1, v36
    v_mov_b32 v29, s33
    s_and_b32 s30, s3, 1
    s_lshl_b32 s30, s30, 7
    s_add_u32 s30, s30, 65536
    v_lshl_add_u32 v15, v61, 10, s30
    v_lshl_add_u32 v15, v60, 3, v15
    v_mfma_f32_16x16x32_bf16 v[52:55], a[44:47], v[104:107], v[52:55]
    s_lshl_b32 s30, s3, 12
    v_mov_b32 v30, s33
    v_mov_b32 v31, s33
    s_mul_i32 s17, s3, 3072
    s_add_u32 s17, s17, 110592
    v_lshl_add_u32 v13, v1, 6, s30
    s_cmp_lg_u64 s[24:25], 0
    v_mfma_f32_16x16x32_bf16 v[44:47], a[52:55], v[108:111], v[44:47]
    s_cbranch_scc1 k2_L_13S
k2_L_13B:
    v_add_u32 v12, s17, v2
    v_bfe_u32 v16, v1, 1, 2
    v_mfma_f32_16x16x32_bf16 v[48:51], a[56:59], v[108:111], v[48:51]
    v_lshl_add_u32 v13, v16, 4, v13
    v_and_b32 v143, 0xffff0000, v143
    v_mfma_f32_16x16x32_bf16 v[52:55], a[60:63], v[108:111], v[52:55]
    s_cmp_eq_u32 s3, 3
    s_cselect_b32 s31, 9, 10
    s_cselect_b32 s96, -4096, 0
    s_ashr_i32 s17, s96, 31
    s_add_u32 s94, s52, s96
    s_addc_u32 s95, s53, s17
    v_mfma_f32_16x16x32_bf16 v[40:43], a[0:3], v[96:99], v[128:131]
    ds_write_b128 v9, v[44:47] offset:36864
    v_mfma_f32_16x16x32_bf16 v[40:43], a[16:19], v[100:103], v[40:43]
    v_lshrrev_b32 v16, 2, v1
    v_min_u32 v16, s31, v16
    v_mfma_f32_16x16x32_bf16 v[40:43], a[32:35], v[104:107], v[40:43]
    ds_write_b128 v10, v[48:51] offset:36864
    v_mfma_f32_16x16x32_bf16 v[40:43], a[48:51], v[108:111], v[40:43]
    v_lshlrev_b32 v16, 12, v16
    v_and_b32 v0, 2, v1
    v_lshl_add_u32 v16, v0, 8, v16
    v_mfma_f32_16x16x32_bf16 v[84:87], a[4:7], v[64:67], 0
    ds_write_b128 v11, v[52:55] offset:36864
    v_mfma_f32_16x16x32_bf16 v[88:91], a[8:11], v[64:67], 0
    s_waitcnt lgkmcnt(0)
    s_barrier
    v_mfma_f32_16x16x32_bf16 v[92:95], a[12:15], v[64:67], 0
    ds_read_b128 v[96:99], v12 offset:36864
    ds_read_b128 v[100:103], v12 offset:37888
    v_mfma_f32_16x16x32_bf16 v[84:87], a[20:23], v[68:71], v[84:87]
    ds_read_b128 v[104:107], v12 offset:38912
    v_lshrrev_b32 v61, 5, v1
    v_mfma_f32_16x16x32_bf16 v[88:91], a[24:27], v[68:71], v[88:91]
    v_lshlrev_b32 v60, 4, v60
    v_lshl_add_u32 v21, v61, 2, v60
    v_mfma_f32_16x16x32_bf16 v[92:95], a[28:31], v[68:71], v[92:95]
    v_and_b32 v60, 31, v1
    v_lshlrev_b32 v60, 4, v60
    v_mfma_f32_16x16x32_bf16 v[84:87], a[36:39], v[72:75], v[84:87]
    v_lshl_add_u32 v1, v61, 11, v60
    v_mfma_f32_16x16x32_bf16 v[88:91], a[40:43], v[72:75], v[88:91]
    s_waitcnt lgkmcnt(2)
    v_add_f32 v128, v40, v96
    v_add_f32 v129, v41, v97
    v_mfma_f32_16x16x32_bf16 v[92:95], a[44:47], v[72:75], v[92:95]
    v_add_f32 v130, v42, v98
    v_add_f32 v131, v43, v99
    v_mfma_f32_16x16x32_bf16 v[84:87], a[52:55], v[76:79], v[84:87]
    s_waitcnt lgkmcnt(0)
    v_add_f32 v100, v100, v104
    v_add_f32 v101, v101, v105
    v_mfma_f32_16x16x32_bf16 v[88:91], a[56:59], v[76:79], v[88:91]
    v_add_f32 v102, v102, v106
    v_add_f32 v103, v103, v107
    v_mfma_f32_16x16x32_bf16 v[92:95], a[60:63], v[76:79], v[92:95]
    v_add_f32 v128, v128, v100
    v_add_f32 v129, v129, v101
    v_mfma_f32_16x16x32_bf16 v[80:83], a[0:3], v[64:67], v[132:135]
    ds_write_b128 v9, v[84:87] offset:0
    v_add_f32 v130, v130, v102
    v_add_f32 v131, v131, v103
    v_mfma_f32_16x16x32_bf16 v[80:83], a[16:19], v[68:71], v[80:83]
    ds_write_b128 v10, v[88:91] offset:0
    v_cvt_pk_bf16_f32 v108, v128, v129
    v_cvt_pk_bf16_f32 v109, v130, v131
    v_mfma_f32_16x16x32_bf16 v[80:83], a[32:35], v[72:75], v[80:83]
    global_store_dwordx2 v17, v[108:109], s[40:41]
    s_add_u32 s40, s40, 16384
    s_addc_u32 s41, s41, 0
    v_add_f32 v96, v128, v129
    v_mul_f32 v97, v128, v128
    v_mfma_f32_16x16x32_bf16 v[80:83], a[48:51], v[76:79], v[80:83]
    ds_write_b128 v11, v[92:95] offset:0
    v_add_f32 v98, v130, v131
    v_fmac_f32 v97, v129, v129
    v_mfma_f32_16x16x32_bf16 v[244:247], a[64:67], v[28:31], 0
    global_load_dwordx4 v[112:115], v6, s[34:35] offset:0 sc1
    v_add_f32 v96, v96, v98
    v_fmac_f32 v97, v130, v130
    v_mfma_f32_16x16x32_bf16 v[248:251], a[128:131], v[28:31], 0
    v_fmac_f32 v97, v131, v131
    v_mfma_f32_16x16x32_bf16 v[252:255], a[192:195], v[28:31], 0
    ds_write_b64 v14, v[96:97] offset:0
    v_mfma_f32_16x16x32_bf16 v[244:247], a[68:71], v[28:31], v[244:247]
    s_waitcnt lgkmcnt(0)
    s_barrier
    v_mfma_f32_16x16x32_bf16 v[248:251], a[132:135], v[28:31], v[248:251]
    ds_read_b128 v[64:67], v12 offset:0
    ds_read_b128 v[68:71], v12 offset:1024
    v_mfma_f32_16x16x32_bf16 v[252:255], a[196:199], v[28:31], v[252:255]
    ds_read_b128 v[72:75], v12 offset:2048
    global_load_dwordx4 v[116:119], v6, s[34:35] offset:1024 sc1
    v_mfma_f32_16x16x32_bf16 v[244:247], a[72:75], v[28:31], v[244:247]
    v_mfma_f32_16x16x32_bf16 v[248:251], a[136:139], v[28:31], v[248:251]
    v_mfma_f32_16x16x32_bf16 v[252:255], a[200:203], v[28:31], v[252:255]
    v_mfma_f32_16x16x32_bf16 v[244:247], a[76:79], v[28:31], v[244:247]
    s_waitcnt lgkmcnt(2)
    global_load_dwordx4 v[120:123], v6, s[34:35] offset:2048 sc1
    v_add_f32 v132, v80, v64
    v_add_f32 v133, v81, v65
    v_mfma_f32_16x16x32_bf16 v[248:251], a[140:143], v[28:31], v[248:251]
    v_add_f32 v134, v82, v66
    v_add_f32 v135, v83, v67
    v_mfma_f32_16x16x32_bf16 v[252:255], a[204:207], v[28:31], v[252:255]
    s_waitcnt lgkmcnt(0)
    v_add_f32 v68, v68, v72
    v_add_f32 v69, v69, v73
    v_mfma_f32_16x16x32_bf16 v[244:247], a[80:83], v[28:31], v[244:247]
    v_add_f32 v70, v70, v74
    v_add_f32 v71, v71, v75
    v_mfma_f32_16x16x32_bf16 v[248:251], a[144:147], v[28:31], v[248:251]
    v_add_f32 v132, v132, v68
    v_add_f32 v133, v133, v69
    v_mfma_f32_16x16x32_bf16 v[252:255], a[208:211], v[28:31], v[252:255]
    global_load_dwordx4 v[124:127], v6, s[34:35] offset:3072 sc1
    v_add_f32 v134, v134, v70
    v_add_f32 v135, v135, v71
    v_mfma_f32_16x16x32_bf16 v[244:247], a[84:87], v[28:31], v[244:247]
    v_cvt_pk_bf16_f32 v76, v132, v133
    v_cvt_pk_bf16_f32 v77, v134, v135
    v_mfma_f32_16x16x32_bf16 v[248:251], a[148:151], v[28:31], v[248:251]
    global_store_dwordx2 v17, v[76:77], s[40:41]
    s_add_u32 s40, s40, 16384
    s_addc_u32 s41, s41, 0
    v_add_f32 v64, v132, v133
    v_mul_f32 v65, v132, v132
    v_mfma_f32_16x16x32_bf16 v[252:255], a[212:215], v[28:31], v[252:255]
    v_add_f32 v66, v134, v135
    v_fmac_f32 v65, v133, v133
    v_mfma_f32_16x16x32_bf16 v[244:247], a[88:91], v[28:31], v[244:247]
    v_add_f32 v64, v64, v66
    v_fmac_f32 v65, v134, v134
    v_mfma_f32_16x16x32_bf16 v[248:251], a[152:155], v[28:31], v[248:251]
    v_fmac_f32 v65, v135, v135
    v_mfma_f32_16x16x32_bf16 v[252:255], a[216:219], v[28:31], v[252:255]
    ds_write_b64 v14, v[64:65] offset:128
    global_load_dwordx4 v[96:99], v8, s[34:35] offset:0 sc1
    v_mfma_f32_16x16x32_bf16 v[244:247], a[92:95], v[28:31], v[244:247]
    v_mfma_f32_16x16x32_bf16 v[248:251], a[156:159], v[28:31], v[248:251]
    s_waitcnt lgkmcnt(0)
    s_barrier
    v_mfma_f32_16x16x32_bf16 v[252:255], a[220:223], v[28:31], v[252:255]
    ds_read2_b64 v[56:59], v15 offset0:0 offset1:32
    v_mfma_f32_16x16x32_bf16 v[244:247], a[96:99], v[28:31], v[244:247]
    ds_read2_b64 v[60:63], v15 offset0:64 offset1:96
    v_add_u32 v15, 4096, v15
    v_mfma_f32_16x16x32_bf16 v[248:251], a[160:163], v[28:31], v[248:251]
    global_load_dwordx4 v[100:103], v8, s[34:35] offset:1024 sc1
    v_mfma_f32_16x16x32_bf16 v[252:255], a[224:227], v[28:31], v[252:255]
    v_mfma_f32_16x16x32_bf16 v[244:247], a[100:103], v[28:31], v[244:247]
    v_mfma_f32_16x16x32_bf16 v[248:251], a[164:167], v[28:31], v[248:251]
    v_mfma_f32_16x16x32_bf16 v[252:255], a[228:231], v[28:31], v[252:255]
    s_waitcnt lgkmcnt(0)
    global_load_dwordx4 v[104:107], v8, s[34:35] offset:2048 sc1
    v_add_f32 v56, v56, v58
    v_add_f32 v57, v57, v59
    v_add_f32 v60, v60, v62
    v_add_f32 v61, v61, v63
    v_add_f32 v56, v56, v60
    v_add_f32 v57, v57, v61
    v_mfma_f32_16x16x32_bf16 v[244:247], a[104:107], v[28:31], v[244:247]
    v_mfma_f32_16x16x32_bf16 v[248:251], a[168:171], v[28:31], v[248:251]
    v_permlane32_swap_b32 v56, v57
    v_mfma_f32_16x16x32_bf16 v[252:255], a[232:235], v[28:31], v[252:255]
    v_add_f32 v56, v56, v57
    v_mov_b32 v57, v56
    v_mfma_f32_16x16x32_bf16 v[244:247], a[108:111], v[28:31], v[244:247]
    global_load_dwordx4 v[108:111], v8, s[34:35] offset:3072 sc1
    v_mfma_f32_16x16x32_bf16 v[248:251], a[172:175], v[28:31], v[248:251]
    v_permlane16_swap_b32 v56, v57
    v_mfma_f32_16x16x32_bf16 v[252:255], a[236:239], v[28:31], v[252:255]
    v_add_f32 v56, v56, v57
    v_mfma_f32_16x16x32_bf16 v[244:247], a[112:115], v[28:31], v[244:247]
    s_waitcnt vmcnt(5)
    global_store_dword v21, v56, s[42:43] offset:0
    v_max3_u32 v36, v112, v116, v120
    v_max_u32 v36, v36, v124
    v_cmp_eq_u32_e64 s[24:25], -1, v36
    v_mfma_f32_16x16x32_bf16 v[248:251], a[176:179], v[28:31], v[248:251]
    s_add_u32 m0, s30, 0
    s_cmp_lg_u64 s[24:25], 0
    v_mfma_f32_16x16x32_bf16 v[252:255], a[240:243], v[28:31], v[252:255]
    s_cbranch_scc1 k2_L_19S
k2_L_19B:
    global_load_lds_dwordx4 v2, s[44:45] offset:0 sc1
    v_mfma_f32_16x16x32_bf16 v[244:247], a[116:119], v[28:31], v[244:247]
    v_mfma_f32_16x16x32_bf16 v[248:251], a[180:183], v[28:31], v[248:251]
    v_mfma_f32_16x16x32_bf16 v[252:255], a[244:247], v[28:31], v[252:255]
    v_mfma_f32_16x16x32_bf16 v[244:247], a[120:123], v[28:31], v[244:247]
    v_mfma_f32_16x16x32_bf16 v[248:251], a[184:187], v[28:31], v[248:251]
    global_load_lds_dwordx4 v2, s[44:45] offset:1024 sc1
    v_mfma_f32_16x16x32_bf16 v[252:255], a[248:251], v[28:31], v[252:255]
    v_mfma_f32_16x16x32_bf16 v[244:247], a[124:127], v[28:31], v[244:247]
    v_mfma_f32_16x16x32_bf16 v[248:251], a[188:191], v[28:31], v[248:251]
    v_mfma_f32_16x16x32_bf16 v[252:255], a[252:255], v[28:31], v[252:255]
    global_load_lds_dwordx4 v2, s[44:45] offset:2048 sc1
    v_mfma_f32_16x16x32_bf16 v[44:47], a[4:7], v[112:115], 0
    v_mfma_f32_16x16x32_bf16 v[48:51], a[8:11], v[112:115], 0
    v_mfma_f32_16x16x32_bf16 v[52:55], a[12:15], v[112:115], 0
    v_mfma_f32_16x16x32_bf16 v[44:47], a[20:23], v[116:119], v[44:47]
    v_mfma_f32_16x16x32_bf16 v[48:51], a[24:27], v[116:119], v[48:51]
    global_load_lds_dwordx4 v2, s[44:45] offset:3072 sc1
    s_add_u32 m0, s30, 16384
    v_mfma_f32_16x16x32_bf16 v[52:55], a[28:31], v[116:119], v[52:55]
    v_mfma_f32_16x16x32_bf16 v[44:47], a[36:39], v[120:123], v[44:47]
    v_mfma_f32_16x16x32_bf16 v[48:51], a[40:43], v[120:123], v[48:51]
    v_mfma_f32_16x16x32_bf16 v[52:55], a[44:47], v[120:123], v[52:55]
    global_load_lds_dwordx4 v4, s[44:45] offset:0 sc1
    v_mfma_f32_16x16x32_bf16 v[44:47], a[52:55], v[124:127], v[44:47]
    s_waitcnt vmcnt(6)
    v_max3_u32 v36, v96, v100, v104
    v_max_u32 v36, v36, v108
    v_cmp_eq_u32_e64 s[24:25], -1, v36
    v_mfma_f32_16x16x32_bf16 v[48:51], a[56:59], v[124:127], v[48:51]
    s_cmp_lg_u64 s[24:25], 0
    v_mfma_f32_16x16x32_bf16 v[52:55], a[60:63], v[124:127], v[52:55]
    s_cbranch_scc1 k2_L_21S
k2_L_21B:
    v_mfma_f32_16x16x32_bf16 v[40:43], a[0:3], v[112:115], v[136:139]
    ds_write_b128 v9, v[44:47] offset:12288
    v_mfma_f32_16x16x32_bf16 v[40:43], a[16:19], v[116:119], v[40:43]
    global_load_lds_dwordx4 v4, s[44:45] offset:1024 sc1
    v_mfma_f32_16x16x32_bf16 v[40:43], a[32:35], v[120:123], v[40:43]
    ds_write_b128 v10, v[48:51] offset:12288
    v_mfma_f32_16x16x32_bf16 v[40:43], a[48:51], v[124:127], v[40:43]
    v_mfma_f32_16x16x32_bf16 v[84:87], a[4:7], v[96:99], 0
    ds_write_b128 v11, v[52:55] offset:12288
    v_mfma_f32_16x16x32_bf16 v[88:91], a[8:11], v[96:99], 0
    global_load_lds_dwordx4 v4, s[44:45] offset:2048 sc1
    v_mfma_f32_16x16x32_bf16 v[92:95], a[12:15], v[96:99], 0
    s_waitcnt vmcnt(3)
    ds_read_b96 v[18:20], v13 offset:0
    v_mfma_f32_16x16x32_bf16 v[84:87], a[20:23], v[100:103], v[84:87]
    v_mfma_f32_16x16x32_bf16 v[88:91], a[24:27], v[100:103], v[88:91]
    v_mfma_f32_16x16x32_bf16 v[92:95], a[28:31], v[100:103], v[92:95]
    global_load_lds_dwordx4 v4, s[44:45] offset:3072 sc1
    v_mfma_f32_16x16x32_bf16 v[84:87], a[36:39], v[104:107], v[84:87]
    s_waitcnt lgkmcnt(0)
    v_max_u32 v18, v18, v20
    v_cmp_eq_u32_e64 s[20:21], -1, v18
    v_mfma_f32_16x16x32_bf16 v[88:91], a[40:43], v[104:107], v[88:91]
    s_cmp_lg_u64 s[20:21], 0
    v_mfma_f32_16x16x32_bf16 v[92:95], a[44:47], v[104:107], v[92:95]
    s_cbranch_scc1 k2_L_15S
k2_L_15B:
    v_mfma_f32_16x16x32_bf16 v[84:87], a[52:55], v[108:111], v[84:87]
    s_barrier
    v_mfma_f32_16x16x32_bf16 v[88:91], a[56:59], v[108:111], v[88:91]
    ds_read_b128 v[28:31], v2 offset:0
    ds_read_b128 v[112:115], v12 offset:12288
    v_mfma_f32_16x16x32_bf16 v[92:95], a[60:63], v[108:111], v[92:95]
    ds_read_b128 v[32:35], v2 offset:1024
    ds_read_b128 v[116:119], v12 offset:13312
    v_mfma_f32_16x16x32_bf16 v[80:83], a[0:3], v[96:99], v[140:143]
    ds_read_b128 v[36:39], v2 offset:2048
    ds_read_b128 v[120:123], v12 offset:14336
    v_mfma_f32_16x16x32_bf16 v[80:83], a[16:19], v[100:103], v[80:83]
    ds_write_b128 v9, v[84:87] offset:24576
    v_mfma_f32_16x16x32_bf16 v[80:83], a[32:35], v[104:107], v[80:83]
    v_mfma_f32_16x16x32_bf16 v[80:83], a[48:51], v[108:111], v[80:83]
    s_waitcnt lgkmcnt(6)
    v_mfma_f32_16x16x32_bf16 v[60:63], a[64:67], v[28:31], 0
    ds_read_b128 v[56:59], v2 offset:3072
    s_waitcnt lgkmcnt(6)
    v_add_f32 v136, v40, v112
    v_add_f32 v137, v41, v113
    v_mfma_f32_16x16x32_bf16 v[64:67], a[128:131], v[28:31], 0
    ds_write_b128 v10, v[88:91] offset:24576
    v_add_f32 v138, v42, v114
    v_add_f32 v139, v43, v115
    v_mfma_f32_16x16x32_bf16 v[68:71], a[192:195], v[28:31], 0
    s_waitcnt lgkmcnt(3)
    ds_write_b128 v11, v[92:95] offset:24576
    v_add_f32 v116, v116, v120
    v_add_f32 v117, v117, v121
    v_mfma_f32_16x16x32_bf16 v[60:63], a[68:71], v[32:35], v[60:63]
    ds_read_b128 v[28:31], v2 offset:4096
    v_add_f32 v118, v118, v122
    v_add_f32 v119, v119, v123
    v_mfma_f32_16x16x32_bf16 v[64:67], a[132:135], v[32:35], v[64:67]
    s_waitcnt vmcnt(0)
    ds_read_b96 v[18:20], v13 offset:16384
    v_add_f32 v136, v136, v116
    v_add_f32 v137, v137, v117
    v_mfma_f32_16x16x32_bf16 v[68:71], a[196:199], v[32:35], v[68:71]
    v_add_f32 v138, v138, v118
    v_add_f32 v139, v139, v119
    v_mfma_f32_16x16x32_bf16 v[60:63], a[72:75], v[36:39], v[60:63]
    ds_read_b128 v[32:35], v2 offset:5120
    v_cvt_pk_bf16_f32 v124, v136, v137
    v_cvt_pk_bf16_f32 v125, v138, v139
    v_mfma_f32_16x16x32_bf16 v[64:67], a[136:139], v[36:39], v[64:67]
    global_store_dwordx2 v17, v[124:125], s[40:41]
    s_add_u32 s40, s40, 16384
    s_addc_u32 s41, s41, 0
    v_add_f32 v112, v136, v137
    v_mul_f32 v113, v136, v136
    v_mfma_f32_16x16x32_bf16 v[68:71], a[200:203], v[36:39], v[68:71]
    s_waitcnt lgkmcnt(1)
    v_max_u32 v18, v18, v20
    v_cmp_eq_u32_e64 s[20:21], -1, v18
    v_add_f32 v114, v138, v139
    v_fmac_f32 v113, v137, v137
    v_mfma_f32_16x16x32_bf16 v[60:63], a[76:79], v[56:59], v[60:63]
    ds_read_b128 v[36:39], v2 offset:6144
    v_add_f32 v112, v112, v114
    v_fmac_f32 v113, v138, v138
    s_cmp_lg_u64 s[20:21], 0
    v_mfma_f32_16x16x32_bf16 v[64:67], a[140:143], v[56:59], v[64:67]
    s_cbranch_scc1 k2_L_17S
k2_L_17B:
    v_fmac_f32 v113, v139, v139
    v_mfma_f32_16x16x32_bf16 v[68:71], a[204:207], v[56:59], v[68:71]
    ds_write_b64 v14, v[112:113] offset:4096
    v_mfma_f32_16x16x32_bf16 v[60:63], a[80:83], v[28:31], v[60:63]
    ds_read_b128 v[56:59], v2 offset:7168
    v_mfma_f32_16x16x32_bf16 v[64:67], a[144:147], v[28:31], v[64:67]
    s_waitcnt lgkmcnt(1)
    s_barrier
    v_mfma_f32_16x16x32_bf16 v[68:71], a[208:211], v[28:31], v[68:71]
    global_load_dwordx4 v[72:75], v1, s[46:47] offset:0 sc1
    ds_read_b128 v[96:99], v12 offset:24576
    v_mfma_f32_16x16x32_bf16 v[60:63], a[84:87], v[32:35], v[60:63]
    ds_read_b128 v[28:31], v2 offset:8192
    ds_read_b128 v[100:103], v12 offset:25600
    v_mfma_f32_16x16x32_bf16 v[64:67], a[148:151], v[32:35], v[64:67]
    ds_read_b128 v[104:107], v12 offset:26624
    v_mfma_f32_16x16x32_bf16 v[68:71], a[212:215], v[32:35], v[68:71]
    v_mfma_f32_16x16x32_bf16 v[60:63], a[88:91], v[36:39], v[60:63]
    ds_read_b128 v[32:35], v2 offset:9216
    global_load_dwordx4 v[76:79], v1, s[46:47] offset:1024 sc1
    v_mfma_f32_16x16x32_bf16 v[64:67], a[152:155], v[36:39], v[64:67]
    v_mfma_f32_16x16x32_bf16 v[68:71], a[216:219], v[36:39], v[68:71]
    s_waitcnt lgkmcnt(4)
    v_add_f32 v140, v80, v96
    v_add_f32 v141, v81, v97
    v_mfma_f32_16x16x32_bf16 v[60:63], a[92:95], v[56:59], v[60:63]
    ds_read_b128 v[36:39], v2 offset:10240
    v_add_f32 v142, v82, v98
    v_add_f32 v143, v83, v99
    v_mfma_f32_16x16x32_bf16 v[64:67], a[156:159], v[56:59], v[64:67]
    s_waitcnt lgkmcnt(2)
    v_add_f32 v100, v100, v104
    v_add_f32 v101, v101, v105
    v_mfma_f32_16x16x32_bf16 v[68:71], a[220:223], v[56:59], v[68:71]
    global_load_dwordx4 a[0:3], v5, s[64:65] offset:0
    v_add_f32 v102, v102, v106
    v_add_f32 v103, v103, v107
    v_mfma_f32_16x16x32_bf16 v[60:63], a[96:99], v[28:31], v[60:63]
    ds_read_b128 v[56:59], v2 offset:11264
    v_add_f32 v140, v140, v100
    v_add_f32 v141, v141, v101
    v_mfma_f32_16x16x32_bf16 v[64:67], a[160:163], v[28:31], v[64:67]
    v_add_f32 v142, v142, v102
    v_add_f32 v143, v143, v103
    v_mfma_f32_16x16x32_bf16 v[68:71], a[224:227], v[28:31], v[68:71]
    v_cvt_pk_bf16_f32 v108, v140, v141
    v_cvt_pk_bf16_f32 v109, v142, v143
    s_waitcnt lgkmcnt(2)
    v_mfma_f32_16x16x32_bf16 v[60:63], a[100:103], v[32:35], v[60:63]
    ds_read_b128 v[28:31], v2 offset:12288
    global_load_dwordx4 a[4:7], v5, s[64:65] offset:1024
    v_mfma_f32_16x16x32_bf16 v[64:67], a[164:167], v[32:35], v[64:67]
    global_store_dwordx2 v17, v[108:109], s[40:41]
    v_add_f32 v96, v140, v141
    v_mul_f32 v97, v140, v140
    v_mfma_f32_16x16x32_bf16 v[68:71], a[228:231], v[32:35], v[68:71]
    v_add_f32 v98, v142, v143
    v_fmac_f32 v97, v141, v141
    s_waitcnt lgkmcnt(2)
    v_mfma_f32_16x16x32_bf16 v[60:63], a[104:107], v[36:39], v[60:63]
    ds_read_b128 v[32:35], v2 offset:13312
    v_add_f32 v96, v96, v98
    v_fmac_f32 v97, v142, v142
    v_mfma_f32_16x16x32_bf16 v[64:67], a[168:171], v[36:39], v[64:67]
    v_fmac_f32 v97, v143, v143
    v_mfma_f32_16x16x32_bf16 v[68:71], a[232:235], v[36:39], v[68:71]
    s_waitcnt lgkmcnt(2)
    v_mfma_f32_16x16x32_bf16 v[60:63], a[108:111], v[56:59], v[60:63]
    ds_read_b128 v[36:39], v2 offset:14336
    global_load_dwordx4 a[8:11], v5, s[64:65] offset:2048
    ds_write_b64 v14, v[96:97] offset:4224
    v_mfma_f32_16x16x32_bf16 v[64:67], a[172:175], v[56:59], v[64:67]
    s_waitcnt vmcnt(4)
    v_max3_u32 v104, v72, v73, v74
    v_max3_u32 v108, v75, v76, v77
    v_max3_u32 v104, v104, v78, v79
    v_max_u32 v104, v104, v108
    v_cmp_eq_u32_e64 s[24:25], -1, v104
    v_mfma_f32_16x16x32_bf16 v[68:71], a[236:239], v[56:59], v[68:71]
    s_waitcnt lgkmcnt(0)
    s_barrier
    s_cmp_lg_u64 s[24:25], 0
    v_mfma_f32_16x16x32_bf16 v[60:63], a[112:115], v[28:31], v[60:63]
    s_cbranch_scc1 k2_L_27S
k2_L_27B:
    ds_read_b128 v[56:59], v2 offset:15360
    v_add_f32 v72, v72, v74
    v_add_f32 v73, v73, v75
    v_add_f32 v76, v76, v78
    v_mfma_f32_16x16x32_bf16 v[64:67], a[176:179], v[28:31], v[64:67]
    ds_read2_b64 v[96:99], v15 offset0:0 offset1:32
    v_add_f32 v77, v77, v79
    v_mfma_f32_16x16x32_bf16 v[68:71], a[240:243], v[28:31], v[68:71]
    ds_read2_b64 v[100:103], v15 offset0:64 offset1:96
    v_add_f32 v72, v72, v76
    v_mfma_f32_16x16x32_bf16 v[60:63], a[116:119], v[32:35], v[60:63]
    ds_read_b128 v[28:31], v2 offset:16384
    global_load_dwordx4 a[12:15], v5, s[64:65] offset:3072
    v_add_f32 v73, v73, v77
    v_mfma_f32_16x16x32_bf16 v[64:67], a[180:183], v[32:35], v[64:67]
    s_add_u32 m0, s30, 32768
    v_permlane32_swap_b32 v72, v73
    v_mfma_f32_16x16x32_bf16 v[68:71], a[244:247], v[32:35], v[68:71]
    v_add_f32 v72, v72, v73
    v_mov_b32 v73, v72
    v_mfma_f32_16x16x32_bf16 v[60:63], a[120:123], v[36:39], v[60:63]
    ds_read_b128 v[32:35], v2 offset:17408
    v_permlane32_swap_b32 v72, v73
    v_mfma_f32_16x16x32_bf16 v[64:67], a[184:187], v[36:39], v[64:67]
    s_waitcnt lgkmcnt(2)
    global_load_lds_dwordx4 v6, s[44:45] offset:0 sc1
    v_mul_f32 v72, 0xbb000000, v72
    v_mul_f32 v73, 0x3b000000, v73
    v_fma_f32 v73, -v72, v72, v73
    v_add_f32 v96, v96, v98
    v_add_f32 v97, v97, v99
    v_add_f32 v100, v100, v102
    v_add_f32 v101, v101, v103
    v_add_f32 v96, v96, v100
    v_add_f32 v97, v97, v101
    v_mfma_f32_16x16x32_bf16 v[68:71], a[248:251], v[36:39], v[68:71]
    v_max_f32 v73, 0, v73
    v_add_f32 v73, 0x3727c5ac, v73
    v_permlane32_swap_b32 v96, v97
    v_mfma_f32_16x16x32_bf16 v[60:63], a[124:127], v[56:59], v[60:63]
    ds_read_b128 v[36:39], v2 offset:18432
    global_load_lds_dwordx4 v6, s[44:45] offset:1024 sc1
    v_mfma_f32_16x16x32_bf16 v[64:67], a[188:191], v[56:59], v[64:67]
    v_rsq_f32 v73, v73
    v_mfma_f32_16x16x32_bf16 v[68:71], a[252:255], v[56:59], v[68:71]
    v_mul_f32 v104, s32, v73
    v_mov_b32 v105, v104
    v_add_f32 v96, v96, v97
    s_waitcnt lgkmcnt(2)
    v_mfma_f32_16x16x32_bf16 v[44:47], a[64:67], v[28:31], 0
    ds_read_b128 v[56:59], v2 offset:19456
    v_mul_f32 v108, v72, v104
    v_mov_b32 v109, v108
    v_mfma_f32_16x16x32_bf16 v[48:51], a[128:131], v[28:31], 0
    global_load_lds_dwordx4 v6, s[44:45] offset:2048 sc1
    v_mov_b32 v97, v96
    v_permlane16_swap_b32 v104, v105
    v_mfma_f32_16x16x32_bf16 v[52:55], a[192:195], v[28:31], 0
    v_permlane16_swap_b32 v108, v109
    s_waitcnt lgkmcnt(2)
    v_mfma_f32_16x16x32_bf16 v[44:47], a[68:71], v[32:35], v[44:47]
    ds_read_b128 v[28:31], v2 offset:20480
    v_cmp_u_f32_e64 s[18:19], v60, v60
    v_mfma_f32_16x16x32_bf16 v[48:51], a[132:135], v[32:35], v[48:51]
    v_permlane16_swap_b32 v96, v97
    s_cmp_lg_u64 s[18:19], 0
    v_mfma_f32_16x16x32_bf16 v[52:55], a[196:199], v[32:35], v[52:55]
    s_cbranch_scc1 k2_L_31S
k2_L_31B:
    global_load_dwordx4 a[16:19], v6, s[64:65] offset:-4096
    v_mul_f32 v60, v60, v104
    v_mul_f32 v61, v61, v104
    v_mul_f32 v62, v62, v104
    v_mul_f32 v63, v63, v104
    v_fmac_f32 v60, v244, v108
    v_fmac_f32 v61, v245, v108
    v_fmac_f32 v62, v246, v108
    s_waitcnt lgkmcnt(2)
    v_mfma_f32_16x16x32_bf16 v[44:47], a[72:75], v[36:39], v[44:47]
    ds_read_b128 v[32:35], v2 offset:21504
    v_add_f32 v96, v96, v97
    v_fmac_f32 v63, v247, v108
    v_mul_f32 v64, v64, v104
    v_mfma_f32_16x16x32_bf16 v[48:51], a[136:139], v[36:39], v[48:51]
    global_store_dword v21, v96, s[42:43] offset:512
    v_mul_f32 v65, v65, v104
    v_mfma_f32_16x16x32_bf16 v[52:55], a[200:203], v[36:39], v[52:55]
    global_load_lds_dwordx4 v6, s[44:45] offset:3072 sc1
    v_mul_f32 v66, v66, v104
    v_mul_f32 v67, v67, v104
    s_waitcnt lgkmcnt(2)
    v_mfma_f32_16x16x32_bf16 v[44:47], a[76:79], v[56:59], v[44:47]
    ds_read_b128 v[36:39], v2 offset:22528
    v_fmac_f32 v64, v248, v108
    v_mfma_f32_16x16x32_bf16 v[48:51], a[140:143], v[56:59], v[48:51]
    v_exp_f32 v84, v60
    v_fmac_f32 v65, v249, v108
    v_mfma_f32_16x16x32_bf16 v[52:55], a[204:207], v[56:59], v[52:55]
    v_fma_f32 v84, v84, s32, s32
    v_fmac_f32 v66, v250, v108
    s_waitcnt lgkmcnt(2)
    v_mfma_f32_16x16x32_bf16 v[44:47], a[80:83], v[28:31], v[44:47]
    ds_read_b128 v[56:59], v2 offset:23552
    global_load_dwordx4 a[20:23], v6, s[64:65] offset:-3072
    v_fmac_f32 v67, v251, v108
    v_mfma_f32_16x16x32_bf16 v[48:51], a[144:147], v[28:31], v[48:51]
    v_exp_f32 v85, v61
    v_mul_f32 v68, v68, v104
    v_mfma_f32_16x16x32_bf16 v[52:55], a[208:211], v[28:31], v[52:55]
    v_and_b32 v14, 0xf0, v2
    v_fma_f32 v85, v85, s32, s32
    s_waitcnt lgkmcnt(2)
    v_mfma_f32_16x16x32_bf16 v[44:47], a[84:87], v[32:35], v[44:47]
    ds_read_b128 v[28:31], v2 offset:24576
    v_mul_f32 v69, v69, v104
    v_mul_f32 v70, v70, v104
    v_mfma_f32_16x16x32_bf16 v[48:51], a[148:151], v[32:35], v[48:51]
    global_load_dwordx4 a[24:27], v6, s[64:65] offset:-2048
    v_mul_f32 v71, v71, v104
    v_mfma_f32_16x16x32_bf16 v[52:55], a[212:215], v[32:35], v[52:55]
    v_fmac_f32 v68, v252, v108
    v_fmac_f32 v69, v253, v108
    s_waitcnt lgkmcnt(2)
    v_mfma_f32_16x16x32_bf16 v[44:47], a[88:91], v[36:39], v[44:47]
    ds_read_b128 v[32:35], v2 offset:25600
    v_fmac_f32 v70, v254, v108
    v_mfma_f32_16x16x32_bf16 v[48:51], a[152:155], v[36:39], v[48:51]
    v_exp_f32 v86, v62
    v_fmac_f32 v71, v255, v108
    v_mfma_f32_16x16x32_bf16 v[52:55], a[216:219], v[36:39], v[52:55]
    s_add_u32 m0, s30, 49152
    v_fma_f32 v86, v86, s32, s32
    s_waitcnt lgkmcnt(2)
    v_mfma_f32_16x16x32_bf16 v[44:47], a[92:95], v[56:59], v[44:47]
    ds_read_b128 v[36:39], v2 offset:26624
    global_load_lds_dwordx4 v8, s[44:45] offset:0 sc1
    v_exp_f32 v87, v63
    v_rcp_f32 v84, v84
    v_mfma_f32_16x16x32_bf16 v[48:51], a[156:159], v[56:59], v[48:51]
    v_rcp_f32 v85, v85
    v_fma_f32 v87, v87, s32, s32
    v_mfma_f32_16x16x32_bf16 v[52:55], a[220:223], v[56:59], v[52:55]
    v_mul_f32 v60, v60, v84
    s_waitcnt lgkmcnt(2)
    v_mfma_f32_16x16x32_bf16 v[44:47], a[96:99], v[28:31], v[44:47]
    ds_read_b128 v[56:59], v2 offset:27648
    global_load_lds_dwordx4 v8, s[44:45] offset:1024 sc1
    v_mul_f32 v61, v61, v85
    v_cvt_pk_bf16_f32 v124, v60, v61
    v_mfma_f32_16x16x32_bf16 v[48:51], a[160:163], v[28:31], v[48:51]
    v_rcp_f32 v86, v86
    v_bfe_u32 v0, v2, 8, 1
    v_lshl_add_u32 v14, v0, 3, v14
    v_mfma_f32_16x16x32_bf16 v[52:55], a[224:227], v[28:31], v[52:55]
    s_waitcnt vmcnt(4)
    v_mul_f32 v62, v62, v86
    v_rcp_f32 v87, v87
    s_waitcnt lgkmcnt(2)
    v_mfma_f32_16x16x32_bf16 v[44:47], a[100:103], v[32:35], v[44:47]
    ds_read_b128 v[28:31], v2 offset:28672
    global_load_lds_dwordx4 v8, s[44:45] offset:2048 sc1
    v_mul_f32 v63, v63, v87
    v_mfma_f32_16x16x32_bf16 v[48:51], a[164:167], v[32:35], v[48:51]
    ds_read_b96 v[18:20], v13 offset:32768
    v_cvt_pk_bf16_f32 v125, v62, v63
    v_exp_f32 v88, v64
    v_mfma_f32_16x16x32_bf16 v[52:55], a[228:231], v[32:35], v[52:55]
    v_fma_f32 v88, v88, s32, s32
    s_waitcnt lgkmcnt(3)
    v_mfma_f32_16x16x32_bf16 v[44:47], a[104:107], v[36:39], v[44:47]
    ds_read_b128 v[32:35], v2 offset:29696
    global_load_lds_dwordx4 v8, s[44:45] offset:3072 sc1
    v_exp_f32 v89, v65
    v_exp_f32 v90, v66
    v_mfma_f32_16x16x32_bf16 v[48:51], a[168:171], v[36:39], v[48:51]
    v_exp_f32 v91, v67
    v_fma_f32 v89, v89, s32, s32
    v_mfma_f32_16x16x32_bf16 v[52:55], a[232:235], v[36:39], v[52:55]
    s_waitcnt lgkmcnt(1)
    v_rcp_f32 v88, v88
    v_max_u32 v18, v18, v20
    v_cmp_eq_u32_e64 s[20:21], -1, v18
    v_mfma_f32_16x16x32_bf16 v[44:47], a[108:111], v[56:59], v[44:47]
    ds_read_b128 v[36:39], v2 offset:30720
    global_load_dwordx4 a[28:31], v6, s[64:65] offset:-1024
    v_fma_f32 v90, v90, s32, s32
    v_fma_f32 v91, v91, s32, s32
    s_cmp_lg_u64 s[20:21], 0
    v_mfma_f32_16x16x32_bf16 v[48:51], a[172:175], v[56:59], v[48:51]
    s_cbranch_scc1 k2_L_23S
k2_L_23B:
    v_mul_f32 v64, v64, v88
    v_mfma_f32_16x16x32_bf16 v[52:55], a[236:239], v[56:59], v[52:55]
    s_barrier
    v_rcp_f32 v89, v89
    v_rcp_f32 v90, v90
    v_mfma_f32_16x16x32_bf16 v[44:47], a[112:115], v[28:31], v[44:47]
    ds_read_b128 v[56:59], v2 offset:31744
    global_load_dwordx4 v[96:99], v1, s[46:47] offset:512 sc1
    v_lshrrev_b32 v0, 9, v2
    v_lshl_add_u32 v14, v0, 8, v14
    v_mul_f32 v65, v65, v89
    v_mfma_f32_16x16x32_bf16 v[48:51], a[176:179], v[28:31], v[48:51]
    v_rcp_f32 v91, v91
    v_mul_f32 v66, v66, v90
    v_mfma_f32_16x16x32_bf16 v[52:55], a[240:243], v[28:31], v[52:55]
    v_mul_f32 v67, v67, v91
    s_waitcnt lgkmcnt(2)
    v_mfma_f32_16x16x32_bf16 v[44:47], a[116:119], v[32:35], v[44:47]
    ds_read_b128 v[28:31], v2 offset:32768
    global_load_dwordx4 v[100:103], v1, s[46:47] offset:1536 sc1
    v_cvt_pk_bf16_f32 v126, v64, v65
    v_cvt_pk_bf16_f32 v127, v66, v67
    v_mfma_f32_16x16x32_bf16 v[48:51], a[180:183], v[32:35], v[48:51]
    global_store_dwordx4 v2, v[124:127], s[48:49] offset:0 sc0 sc1
    v_exp_f32 v92, v68
    v_mfma_f32_16x16x32_bf16 v[52:55], a[244:247], v[32:35], v[52:55]
    v_fma_f32 v92, v92, s32, s32
    v_exp_f32 v93, v69
    s_waitcnt lgkmcnt(2)
    v_mfma_f32_16x16x32_bf16 v[44:47], a[120:123], v[36:39], v[44:47]
    ds_read_b128 v[32:35], v2 offset:33792
    v_fma_f32 v93, v93, s32, s32
    v_exp_f32 v94, v70
    v_mfma_f32_16x16x32_bf16 v[48:51], a[184:187], v[36:39], v[48:51]
    v_exp_f32 v95, v71
    v_mfma_f32_16x16x32_bf16 v[52:55], a[248:251], v[36:39], v[52:55]
    s_waitcnt vmcnt(4)
    v_fma_f32 v94, v94, s32, s32
    v_fma_f32 v95, v95, s32, s32
    s_waitcnt lgkmcnt(2)
    v_mfma_f32_16x16x32_bf16 v[44:47], a[124:127], v[56:59], v[44:47]
    ds_read_b128 v[36:39], v2 offset:34816
    global_load_dwordx4 a[32:35], v6, s[64:65] offset:0
    v_rcp_f32 v92, v92
    v_mfma_f32_16x16x32_bf16 v[48:51], a[188:191], v[56:59], v[48:51]
    ds_read_b96 v[18:20], v13 offset:49152
    v_mul_f32 v68, v68, v92
    v_rcp_f32 v93, v93
    v_mfma_f32_16x16x32_bf16 v[52:55], a[252:255], v[56:59], v[52:55]
    v_mul_f32 v69, v69, v93
    s_waitcnt lgkmcnt(3)
    v_mfma_f32_16x16x32_bf16 v[72:75], a[64:67], v[28:31], 0
    ds_read_b128 v[56:59], v2 offset:35840
    global_load_dwordx4 a[36:39], v6, s[64:65] offset:1024
    v_cvt_pk_bf16_f32 v22, v68, v69
    v_rcp_f32 v94, v94
    v_mfma_f32_16x16x32_bf16 v[76:79], a[128:131], v[28:31], 0
    v_rcp_f32 v95, v95
    v_mfma_f32_16x16x32_bf16 v[80:83], a[192:195], v[28:31], 0
    s_waitcnt lgkmcnt(1)
    v_mul_f32 v70, v70, v94
    v_mul_f32 v71, v71, v95
    v_max_u32 v18, v18, v20
    v_mfma_f32_16x16x32_bf16 v[72:75], a[68:71], v[32:35], v[72:75]
    ds_read_b128 v[28:31], v2 offset:36864
    v_cvt_pk_bf16_f32 v23, v70, v71
    v_cmp_eq_u32_e64 s[20:21], -1, v18
    v_mfma_f32_16x16x32_bf16 v[76:79], a[132:135], v[32:35], v[76:79]
    global_store_dwordx2 v14, v[22:23], s[50:51] offset:0 sc0 sc1
    v_cmp_u_f32_e64 s[18:19], v44, v44
    s_cmp_lg_u64 s[20:21], 0
    v_mfma_f32_16x16x32_bf16 v[80:83], a[196:199], v[32:35], v[80:83]
    s_cbranch_scc1 k2_L_25S
k2_L_25B:
    s_cmp_lg_u64 s[18:19], 0
    v_mfma_f32_16x16x32_bf16 v[72:75], a[72:75], v[36:39], v[72:75]
    s_cbranch_scc1 k2_L_33S
k2_L_33B:
    ds_read_b128 v[32:35], v2 offset:37888
    v_mul_f32 v44, v44, v105
    v_mul_f32 v45, v45, v105
    v_mul_f32 v46, v46, v105
    v_mul_f32 v47, v47, v105
    v_fmac_f32 v44, v244, v109
    v_fmac_f32 v45, v245, v109
    v_fmac_f32 v46, v246, v109
    v_fmac_f32 v47, v247, v109
    v_mul_f32 v48, v48, v105
    v_mul_f32 v49, v49, v105
    v_mul_f32 v50, v50, v105
    global_load_dwordx4 a[40:43], v6, s[64:65] offset:2048
    v_mfma_f32_16x16x32_bf16 v[76:79], a[136:139], v[36:39], v[76:79]
    v_exp_f32 v84, v44
    v_mfma_f32_16x16x32_bf16 v[80:83], a[200:203], v[36:39], v[80:83]
    v_fma_f32 v84, v84, s32, s32
    v_mul_f32 v51, v51, v105
    s_waitcnt lgkmcnt(2)
    v_mfma_f32_16x16x32_bf16 v[72:75], a[76:79], v[56:59], v[72:75]
    ds_read_b128 v[36:39], v2 offset:38912
    global_load_dwordx4 a[44:47], v6, s[64:65] offset:3072
    v_fmac_f32 v48, v248, v109
    v_fmac_f32 v49, v249, v109
    v_mfma_f32_16x16x32_bf16 v[76:79], a[140:143], v[56:59], v[76:79]
    v_exp_f32 v85, v45
    v_fmac_f32 v50, v250, v109
    v_mfma_f32_16x16x32_bf16 v[80:83], a[204:207], v[56:59], v[80:83]
    v_fma_f32 v85, v85, s32, s32
    v_fmac_f32 v51, v251, v109
    s_waitcnt lgkmcnt(2)
    v_mfma_f32_16x16x32_bf16 v[72:75], a[80:83], v[28:31], v[72:75]
    ds_read_b128 v[56:59], v2 offset:39936
    v_mul_f32 v52, v52, v105
    v_mul_f32 v53, v53, v105
    v_mfma_f32_16x16x32_bf16 v[76:79], a[144:147], v[28:31], v[76:79]
    global_load_dwordx4 a[48:51], v7, s[64:65] offset:-4096
    v_mul_f32 v54, v54, v105
    v_mfma_f32_16x16x32_bf16 v[80:83], a[208:211], v[28:31], v[80:83]
    v_mul_f32 v55, v55, v105
    v_fmac_f32 v52, v252, v109
    s_waitcnt lgkmcnt(2)
    v_mfma_f32_16x16x32_bf16 v[72:75], a[84:87], v[32:35], v[72:75]
    ds_read_b128 v[28:31], v2 offset:40960
    v_fmac_f32 v53, v253, v109
    v_fmac_f32 v54, v254, v109
    v_mfma_f32_16x16x32_bf16 v[76:79], a[148:151], v[32:35], v[76:79]
    v_exp_f32 v86, v46
    v_fmac_f32 v55, v255, v109
    v_mfma_f32_16x16x32_bf16 v[80:83], a[212:215], v[32:35], v[80:83]
    v_fma_f32 v86, v86, s32, s32
    v_exp_f32 v87, v47
    s_waitcnt lgkmcnt(2)
    v_mfma_f32_16x16x32_bf16 v[72:75], a[88:91], v[36:39], v[72:75]
    ds_read_b128 v[32:35], v2 offset:41984
    global_load_dwordx4 a[52:55], v7, s[64:65] offset:-3072
    v_fma_f32 v87, v87, s32, s32
    v_rcp_f32 v84, v84
    v_mfma_f32_16x16x32_bf16 v[76:79], a[152:155], v[36:39], v[76:79]
    v_rcp_f32 v85, v85
    v_mfma_f32_16x16x32_bf16 v[80:83], a[216:219], v[36:39], v[80:83]
    v_mul_f32 v44, v44, v84
    v_mul_f32 v45, v45, v85
    s_waitcnt lgkmcnt(2)
    v_mfma_f32_16x16x32_bf16 v[72:75], a[92:95], v[56:59], v[72:75]
    ds_read_b128 v[36:39], v2 offset:43008
    v_cvt_pk_bf16_f32 v124, v44, v45
    v_rcp_f32 v86, v86
    v_mfma_f32_16x16x32_bf16 v[76:79], a[156:159], v[56:59], v[76:79]
    v_rcp_f32 v87, v87
    v_mul_f32 v46, v46, v86
    v_mfma_f32_16x16x32_bf16 v[80:83], a[220:223], v[56:59], v[80:83]
    global_load_dwordx4 a[56:59], v7, s[64:65] offset:-2048
    v_mul_f32 v47, v47, v87
    v_cvt_pk_bf16_f32 v125, v46, v47
    s_waitcnt lgkmcnt(2)
    v_mfma_f32_16x16x32_bf16 v[72:75], a[96:99], v[28:31], v[72:75]
    ds_read_b128 v[56:59], v2 offset:44032
    s_waitcnt vmcnt(9)
    v_max3_u32 v106, v96, v97, v98
    v_max3_u32 v110, v99, v100, v101
    v_exp_f32 v88, v48
    v_exp_f32 v89, v49
    v_mfma_f32_16x16x32_bf16 v[76:79], a[160:163], v[28:31], v[76:79]
    v_exp_f32 v90, v50
    v_max3_u32 v106, v106, v102, v103
    v_mfma_f32_16x16x32_bf16 v[80:83], a[224:227], v[28:31], v[80:83]
    v_fma_f32 v88, v88, s32, s32
    v_fma_f32 v89, v89, s32, s32
    v_max_u32 v106, v106, v110
    s_waitcnt lgkmcnt(2)
    v_mfma_f32_16x16x32_bf16 v[72:75], a[100:103], v[32:35], v[72:75]
    ds_read_b128 v[28:31], v2 offset:45056
    global_load_dwordx4 a[60:63], v7, s[64:65] offset:-1024
    v_fma_f32 v90, v90, s32, s32
    v_cmp_eq_u32_e64 s[24:25], -1, v106
    v_exp_f32 v91, v51
    v_mfma_f32_16x16x32_bf16 v[76:79], a[164:167], v[32:35], v[76:79]
    v_rcp_f32 v88, v88
    v_fma_f32 v91, v91, s32, s32
    s_cmp_lg_u64 s[24:25], 0
    v_mfma_f32_16x16x32_bf16 v[80:83], a[228:231], v[32:35], v[80:83]
    s_cbranch_scc1 k2_L_29S
k2_L_29B:
    v_mul_f32 v48, v48, v88
    v_add_f32 v96, v96, v98
    v_add_f32 v97, v97, v99
    v_rcp_f32 v89, v89
    s_waitcnt lgkmcnt(2)
    v_mfma_f32_16x16x32_bf16 v[72:75], a[104:107], v[36:39], v[72:75]
    ds_read_b128 v[32:35], v2 offset:46080
    v_mul_f32 v49, v49, v89
    v_cvt_pk_bf16_f32 v126, v48, v49
    v_add_f32 v100, v100, v102
    v_mfma_f32_16x16x32_bf16 v[76:79], a[168:171], v[36:39], v[76:79]
    v_rcp_f32 v90, v90
    v_add_f32 v101, v101, v103
    v_mfma_f32_16x16x32_bf16 v[80:83], a[232:235], v[36:39], v[80:83]
    s_barrier
    v_mul_f32 v50, v50, v90
    v_add_f32 v96, v96, v100
    v_rcp_f32 v91, v91
    s_waitcnt lgkmcnt(2)
    v_mfma_f32_16x16x32_bf16 v[72:75], a[108:111], v[56:59], v[72:75]
    ds_read_b128 v[36:39], v2 offset:47104
    global_load_dwordx4 v[112:115], v5, s[64:65] offset:-3072
    v_mul_f32 v51, v51, v91
    v_cvt_pk_bf16_f32 v127, v50, v51
    v_add_f32 v97, v97, v101
    v_mfma_f32_16x16x32_bf16 v[76:79], a[172:175], v[56:59], v[76:79]
    global_store_dwordx4 v2, v[124:127], s[48:49] offset:1024 sc0 sc1
    v_exp_f32 v92, v52
    v_exp_f32 v93, v53
    v_permlane32_swap_b32 v96, v97
    v_mfma_f32_16x16x32_bf16 v[80:83], a[236:239], v[56:59], v[80:83]
    v_fma_f32 v92, v92, s32, s32
    v_fma_f32 v93, v93, s32, s32
    v_add_f32 v96, v96, v97
    s_waitcnt lgkmcnt(2)
    v_mfma_f32_16x16x32_bf16 v[72:75], a[112:115], v[28:31], v[72:75]
    ds_read_b128 v[56:59], v2 offset:48128
    v_mov_b32 v97, v96
    v_exp_f32 v94, v54
    v_exp_f32 v95, v55
    v_permlane32_swap_b32 v96, v97
    v_mfma_f32_16x16x32_bf16 v[76:79], a[176:179], v[28:31], v[76:79]
    global_load_dwordx4 v[116:119], v5, s[64:65] offset:-2048
    v_fma_f32 v94, v94, s32, s32
    v_mul_f32 v96, 0xbb000000, v96
    v_mfma_f32_16x16x32_bf16 v[80:83], a[240:243], v[28:31], v[80:83]
    v_fma_f32 v95, v95, s32, s32
    v_mul_f32 v97, 0x3b000000, v97
    v_rcp_f32 v92, v92
    s_waitcnt lgkmcnt(2)
    v_mfma_f32_16x16x32_bf16 v[72:75], a[116:119], v[32:35], v[72:75]
    ds_read_b128 v[28:31], v2 offset:49152
    v_mul_f32 v52, v52, v92
    v_fma_f32 v97, -v96, v96, v97
    v_rcp_f32 v93, v93
    v_mfma_f32_16x16x32_bf16 v[76:79], a[180:183], v[32:35], v[76:79]
    v_rcp_f32 v94, v94
    v_mul_f32 v53, v53, v93
    v_max_f32 v97, 0, v97
    v_mfma_f32_16x16x32_bf16 v[80:83], a[244:247], v[32:35], v[80:83]
    global_load_dwordx4 v[120:123], v5, s[64:65] offset:-1024
    v_mul_f32 v54, v54, v94
    v_cvt_pk_bf16_f32 v22, v52, v53
    v_add_f32 v97, 0x3727c5ac, v97
    s_waitcnt lgkmcnt(2)
    v_mfma_f32_16x16x32_bf16 v[72:75], a[120:123], v[36:39], v[72:75]
    ds_read_b128 v[32:35], v2 offset:50176
    v_rcp_f32 v95, v95
    v_rsq_f32 v97, v97
    v_mfma_f32_16x16x32_bf16 v[76:79], a[184:187], v[36:39], v[76:79]
    v_mul_f32 v55, v55, v95
    v_cvt_pk_bf16_f32 v23, v54, v55
    v_mul_f32 v106, s32, v97
    v_mfma_f32_16x16x32_bf16 v[80:83], a[248:251], v[36:39], v[80:83]
    v_mov_b32 v107, v106
    global_store_dwordx2 v14, v[22:23], s[50:51] offset:1024 sc0 sc1
    s_waitcnt lgkmcnt(2)
    v_mfma_f32_16x16x32_bf16 v[72:75], a[124:127], v[56:59], v[72:75]
    ds_read_b128 v[36:39], v2 offset:51200
    v_mul_f32 v110, v96, v106
    v_mfma_f32_16x16x32_bf16 v[76:79], a[188:191], v[56:59], v[76:79]
    v_mov_b32 v111, v110
    v_mfma_f32_16x16x32_bf16 v[80:83], a[252:255], v[56:59], v[80:83]
    v_permlane16_swap_b32 v106, v107
    s_waitcnt lgkmcnt(2)
    v_mfma_f32_16x16x32_bf16 v[60:63], a[64:67], v[28:31], 0
    ds_read_b128 v[56:59], v2 offset:52224
    v_permlane16_swap_b32 v110, v111
    v_mfma_f32_16x16x32_bf16 v[64:67], a[128:131], v[28:31], 0
    v_cmp_u_f32_e64 s[18:19], v72, v72
    v_mfma_f32_16x16x32_bf16 v[68:71], a[192:195], v[28:31], 0
    s_cmp_lg_u64 s[18:19], 0
    s_waitcnt lgkmcnt(2)
    v_mfma_f32_16x16x32_bf16 v[60:63], a[68:71], v[32:35], v[60:63]
    s_cbranch_scc1 k2_L_35S
k2_L_35B:
    ds_read_b128 v[28:31], v2 offset:53248
    v_mul_f32 v72, v72, v106
    v_mul_f32 v73, v73, v106
    v_mul_f32 v74, v74, v106
    v_mul_f32 v75, v75, v106
    v_fmac_f32 v72, v244, v110
    v_mfma_f32_16x16x32_bf16 v[64:67], a[132:135], v[32:35], v[64:67]
    v_exp_f32 v84, v72
    v_fmac_f32 v73, v245, v110
    v_mfma_f32_16x16x32_bf16 v[68:71], a[196:199], v[32:35], v[68:71]
    v_fmac_f32 v74, v246, v110
    v_fmac_f32 v75, v247, v110
    s_waitcnt lgkmcnt(2)
    v_mfma_f32_16x16x32_bf16 v[60:63], a[72:75], v[36:39], v[60:63]
    ds_read_b128 v[32:35], v2 offset:54272
    v_fma_f32 v84, v84, s32, s32
    v_mul_f32 v76, v76, v106
    v_bfe_u32 v0, v2, 8, 2
    v_lshlrev_b32 v0, 4, v0
    v_xor_b32 v12, v0, v2
    v_mfma_f32_16x16x32_bf16 v[64:67], a[136:139], v[36:39], v[64:67]
    v_exp_f32 v85, v73
    v_mfma_f32_16x16x32_bf16 v[68:71], a[200:203], v[36:39], v[68:71]
    v_fma_f32 v85, v85, s32, s32
    v_mul_f32 v77, v77, v106
    s_waitcnt lgkmcnt(2)
    v_mfma_f32_16x16x32_bf16 v[60:63], a[76:79], v[56:59], v[60:63]
    ds_read_b128 v[36:39], v2 offset:55296
    v_mul_f32 v78, v78, v106
    v_mul_f32 v79, v79, v106
    v_mfma_f32_16x16x32_bf16 v[64:67], a[140:143], v[56:59], v[64:67]
    v_exp_f32 v86, v74
    v_fmac_f32 v76, v248, v110
    v_mfma_f32_16x16x32_bf16 v[68:71], a[204:207], v[56:59], v[68:71]
    v_fma_f32 v86, v86, s32, s32
    v_fmac_f32 v77, v249, v110
    s_waitcnt lgkmcnt(2)
    v_mfma_f32_16x16x32_bf16 v[60:63], a[80:83], v[28:31], v[60:63]
    ds_read_b128 v[56:59], v2 offset:56320
    v_fmac_f32 v78, v250, v110
    v_fmac_f32 v79, v251, v110
    v_mfma_f32_16x16x32_bf16 v[64:67], a[144:147], v[28:31], v[64:67]
    v_exp_f32 v87, v75
    v_mfma_f32_16x16x32_bf16 v[68:71], a[208:211], v[28:31], v[68:71]
    global_load_dword v18, v16, s[52:53] offset:-3600 sc1
    v_fma_f32 v87, v87, s32, s32
    v_mul_f32 v80, v80, v106
    s_waitcnt lgkmcnt(2)
    v_mfma_f32_16x16x32_bf16 v[60:63], a[84:87], v[32:35], v[60:63]
    ds_read_b128 v[28:31], v2 offset:57344
    global_load_dwordx4 a[64:67], v2, s[52:53] offset:-4096 sc1
    v_mul_f32 v81, v81, v106
    v_mul_f32 v82, v82, v106
    v_mfma_f32_16x16x32_bf16 v[64:67], a[148:151], v[32:35], v[64:67]
    v_rcp_f32 v84, v84
    v_mul_f32 v83, v83, v106
    v_mfma_f32_16x16x32_bf16 v[68:71], a[212:215], v[32:35], v[68:71]
    global_load_dwordx4 a[128:131], v2, s[52:53] offset:0 sc1
    v_mul_f32 v72, v72, v84
    v_fmac_f32 v80, v252, v110
    v_and_b32 v15, 0x70, v12
    s_waitcnt lgkmcnt(2)
    v_mfma_f32_16x16x32_bf16 v[60:63], a[88:91], v[36:39], v[60:63]
    ds_read_b128 v[32:35], v2 offset:58368
    v_fmac_f32 v81, v253, v110
    v_fmac_f32 v82, v254, v110
    v_mfma_f32_16x16x32_bf16 v[64:67], a[152:155], v[36:39], v[64:67]
    global_load_dwordx4 a[192:195], v3, s[52:53] offset:-4096 sc1
    v_fmac_f32 v83, v255, v110
    v_mfma_f32_16x16x32_bf16 v[68:71], a[216:219], v[36:39], v[68:71]
    v_rcp_f32 v85, v85
    v_rcp_f32 v86, v86
    s_waitcnt lgkmcnt(2)
    v_mfma_f32_16x16x32_bf16 v[60:63], a[92:95], v[56:59], v[60:63]
    ds_read_b128 v[36:39], v2 offset:59392
    global_load_dwordx4 a[68:71], v3, s[52:53] offset:0 sc1
    v_mul_f32 v73, v73, v85
    v_mul_f32 v74, v74, v86
    v_mfma_f32_16x16x32_bf16 v[64:67], a[156:159], v[56:59], v[64:67]
    v_rcp_f32 v87, v87
    v_cvt_pk_bf16_f32 v124, v72, v73
    v_mfma_f32_16x16x32_bf16 v[68:71], a[220:223], v[56:59], v[68:71]
    global_load_dwordx4 a[132:135], v4, s[52:53] offset:-4096 sc1
    v_mul_f32 v75, v75, v87
    v_cvt_pk_bf16_f32 v125, v74, v75
    s_waitcnt lgkmcnt(2)
    v_mfma_f32_16x16x32_bf16 v[60:63], a[96:99], v[28:31], v[60:63]
    ds_read_b128 v[56:59], v2 offset:60416
    v_exp_f32 v88, v76
    v_exp_f32 v89, v77
    v_mfma_f32_16x16x32_bf16 v[64:67], a[160:163], v[28:31], v[64:67]
    global_load_dwordx4 a[196:199], v4, s[52:53] offset:0 sc1
    v_fma_f32 v88, v88, s32, s32
    v_mfma_f32_16x16x32_bf16 v[68:71], a[224:227], v[28:31], v[68:71]
    v_fma_f32 v89, v89, s32, s32
    v_exp_f32 v90, v78
    s_waitcnt lgkmcnt(2)
    v_mfma_f32_16x16x32_bf16 v[60:63], a[100:103], v[32:35], v[60:63]
    ds_read_b128 v[28:31], v2 offset:61440
    global_load_dwordx4 a[72:75], v5, s[52:53] offset:-4096 sc1
    v_fma_f32 v90, v90, s32, s32
    v_exp_f32 v91, v79
    v_mfma_f32_16x16x32_bf16 v[64:67], a[164:167], v[32:35], v[64:67]
    v_rcp_f32 v88, v88
    v_fma_f32 v91, v91, s32, s32
    v_mfma_f32_16x16x32_bf16 v[68:71], a[228:231], v[32:35], v[68:71]
    global_load_dwordx4 a[136:139], v5, s[52:53] offset:0 sc1
    v_mul_f32 v76, v76, v88
    v_and_b32 v0, 0x30, v2
    v_lshl_add_u32 v15, v0, 4, v15
    v_rcp_f32 v89, v89
    s_waitcnt lgkmcnt(2)
    v_mfma_f32_16x16x32_bf16 v[60:63], a[104:107], v[36:39], v[60:63]
    ds_read_b128 v[32:35], v2 offset:62464
    v_mul_f32 v77, v77, v89
    v_cvt_pk_bf16_f32 v126, v76, v77
    v_mfma_f32_16x16x32_bf16 v[64:67], a[168:171], v[36:39], v[64:67]
    global_load_dwordx4 a[200:203], v6, s[52:53] offset:-4096 sc1
    v_rcp_f32 v90, v90
    v_mfma_f32_16x16x32_bf16 v[68:71], a[232:235], v[36:39], v[68:71]
    v_mul_f32 v78, v78, v90
    v_rcp_f32 v91, v91
    s_waitcnt lgkmcnt(2)
    v_mfma_f32_16x16x32_bf16 v[60:63], a[108:111], v[56:59], v[60:63]
    ds_read_b128 v[36:39], v2 offset:63488
    global_load_dwordx4 a[76:79], v6, s[52:53] offset:0 sc1
    v_mul_f32 v79, v79, v91
    v_cvt_pk_bf16_f32 v127, v78, v79
    v_mfma_f32_16x16x32_bf16 v[64:67], a[172:175], v[56:59], v[64:67]
    global_store_dwordx4 v2, v[124:127], s[48:49] offset:2048 sc0 sc1
    v_exp_f32 v92, v80
    v_exp_f32 v93, v81
    v_mfma_f32_16x16x32_bf16 v[68:71], a[236:239], v[56:59], v[68:71]
    global_load_dwordx4 a[140:143], v7, s[94:95] offset:-4096 sc1
    v_fma_f32 v92, v92, s32, s32
    v_fma_f32 v93, v93, s32, s32
    s_waitcnt lgkmcnt(2)
    v_mfma_f32_16x16x32_bf16 v[60:63], a[112:115], v[28:31], v[60:63]
    ds_read_b128 v[56:59], v2 offset:64512
    v_exp_f32 v94, v82
    v_exp_f32 v95, v83
    v_mfma_f32_16x16x32_bf16 v[64:67], a[176:179], v[28:31], v[64:67]
    v_rcp_f32 v92, v92
    v_mfma_f32_16x16x32_bf16 v[68:71], a[240:243], v[28:31], v[68:71]
    v_fma_f32 v94, v94, s32, s32
    v_fma_f32 v95, v95, s32, s32
    s_waitcnt lgkmcnt(2)
    v_mfma_f32_16x16x32_bf16 v[60:63], a[116:119], v[32:35], v[60:63]
    v_rcp_f32 v93, v93
    v_mul_f32 v80, v80, v92
    v_mfma_f32_16x16x32_bf16 v[64:67], a[180:183], v[32:35], v[64:67]
    v_rcp_f32 v94, v94
    v_mul_f32 v81, v81, v93
    v_mfma_f32_16x16x32_bf16 v[68:71], a[244:247], v[32:35], v[68:71]
    v_mul_f32 v82, v82, v94
    v_cvt_pk_bf16_f32 v22, v80, v81
    v_and_b32 v0, 0xc0, v2
    v_lshl_add_u32 v15, v0, 6, v15
    s_waitcnt lgkmcnt(1)
    v_mfma_f32_16x16x32_bf16 v[60:63], a[120:123], v[36:39], v[60:63]
    v_rcp_f32 v95, v95
    v_mfma_f32_16x16x32_bf16 v[64:67], a[184:187], v[36:39], v[64:67]
    v_mul_f32 v83, v83, v95
    v_cvt_pk_bf16_f32 v23, v82, v83
    s_mul_i32 s17, s3, 1088
    v_xor_b32 v15, s17, v15
    v_mfma_f32_16x16x32_bf16 v[68:71], a[248:251], v[36:39], v[68:71]
    global_store_dwordx2 v14, v[22:23], s[50:51] offset:2048 sc0 sc1
    s_waitcnt lgkmcnt(0)
    v_mfma_f32_16x16x32_bf16 v[60:63], a[124:127], v[56:59], v[60:63]
    s_add_u32 s17, s3, 1
    s_and_b32 s17, s17, 3
    s_xor_b32 s17, s17, s3
    s_lshl_b32 s17, s17, 6
    v_xor_b32 v9, s17, v15
    v_mfma_f32_16x16x32_bf16 v[64:67], a[188:191], v[56:59], v[64:67]
    s_add_u32 s17, s3, 2
    s_and_b32 s17, s17, 3
    s_xor_b32 s17, s17, s3
    s_lshl_b32 s17, s17, 6
    v_xor_b32 v10, s17, v15
    v_mfma_f32_16x16x32_bf16 v[68:71], a[252:255], v[56:59], v[68:71]
    s_waitcnt vmcnt(13)
    v_cmp_eq_u32_e64 s[20:21], -1, v18
    s_cmp_lg_u64 s[20:21], 0
    s_cbranch_scc1 k2_L_39S
k2_L_39B:
    s_waitcnt vmcnt(12)
    v_mfma_f32_16x16x32_bf16 v[28:31], v[144:147], a[64:67], v[128:131]
    s_add_u32 s17, s3, 3
    s_and_b32 s17, s17, 3
    s_xor_b32 s17, s17, s3
    s_lshl_b32 s17, s17, 6
    v_xor_b32 v11, s17, v15
    v_mfma_f32_16x16x32_bf16 v[32:35], v[148:151], a[64:67], 0
    v_cmp_u_f32_e64 s[18:19], v60, v60
    v_mfma_f32_16x16x32_bf16 v[36:39], v[152:155], a[64:67], 0
    s_mul_i32 s17, s3, 4160
    s_andn2_b32 s17, s17, 128
    v_xor_b32 v12, s17, v12
    s_cmp_lg_u64 s[18:19], 0
    v_mfma_f32_16x16x32_bf16 v[40:43], v[156:159], a[64:67], 0
    s_cbranch_scc1 k2_L_37S
k2_L_37B:
    v_mul_f32 v60, v60, v107
    v_mul_f32 v61, v61, v107
    v_mul_f32 v62, v62, v107
    v_mul_f32 v63, v63, v107
    v_fmac_f32 v60, v244, v111
    s_waitcnt vmcnt(11)
    v_mfma_f32_16x16x32_bf16 v[28:31], v[160:163], a[128:131], v[28:31]
    v_exp_f32 v84, v60
    v_fmac_f32 v61, v245, v111
    v_mfma_f32_16x16x32_bf16 v[32:35], v[164:167], a[128:131], v[32:35]
    v_exp_f32 v85, v61
    v_and_b32 v0, 0x300, v2
    v_lshlrev_b32 v17, 2, v0
    v_fmac_f32 v62, v246, v111
    v_mfma_f32_16x16x32_bf16 v[36:39], v[168:171], a[128:131], v[36:39]
    v_exp_f32 v86, v62
    v_fmac_f32 v63, v247, v111
    v_mfma_f32_16x16x32_bf16 v[40:43], v[172:175], a[128:131], v[40:43]
    v_fma_f32 v84, v84, s32, s32
    s_waitcnt vmcnt(10)
    v_mfma_f32_16x16x32_bf16 v[28:31], v[176:179], a[192:195], v[28:31]
    v_exp_f32 v87, v63
    v_fma_f32 v85, v85, s32, s32
    v_mfma_f32_16x16x32_bf16 v[32:35], v[180:183], a[192:195], v[32:35]
    v_rcp_f32 v84, v84
    v_fma_f32 v86, v86, s32, s32
    v_mfma_f32_16x16x32_bf16 v[36:39], v[184:187], a[192:195], v[36:39]
    v_rcp_f32 v85, v85
    v_fma_f32 v87, v87, s32, s32
    v_mfma_f32_16x16x32_bf16 v[40:43], v[188:191], a[192:195], v[40:43]
    v_mul_f32 v60, v60, v84
    v_mul_f32 v61, v61, v85
    s_waitcnt vmcnt(9)
    v_mfma_f32_16x16x32_bf16 v[28:31], v[192:195], a[68:71], v[28:31]
    global_load_dword v19, v16, s[52:53] offset:-2576 sc1
    v_cvt_pk_bf16_f32 v124, v60, v61
    v_mul_f32 v64, v64, v107
    v_mfma_f32_16x16x32_bf16 v[32:35], v[196:199], a[68:71], v[32:35]
    global_load_dwordx4 a[204:207], v2, s[52:53] offset:-3072 sc1
    v_mul_f32 v65, v65, v107
    v_mfma_f32_16x16x32_bf16 v[36:39], v[200:203], a[68:71], v[36:39]
    v_rcp_f32 v86, v86
    v_mul_f32 v66, v66, v107
    v_mfma_f32_16x16x32_bf16 v[40:43], v[204:207], a[68:71], v[40:43]
    v_mul_f32 v62, v62, v86
    v_mul_f32 v67, v67, v107
    s_waitcnt vmcnt(10)
    v_mfma_f32_16x16x32_bf16 v[28:31], v[208:211], a[132:135], v[28:31]
    global_load_dwordx4 a[80:83], v2, s[52:53] offset:1024 sc1
    v_fmac_f32 v64, v248, v111
    v_fmac_f32 v65, v249, v111
    v_mfma_f32_16x16x32_bf16 v[32:35], v[212:215], a[132:135], v[32:35]
    v_rcp_f32 v87, v87
    v_bfe_u32 v0, v2, 4, 4
    v_lshl_add_u32 v17, v0, 3, v17
    v_fmac_f32 v66, v250, v111
    v_mfma_f32_16x16x32_bf16 v[36:39], v[216:219], a[132:135], v[36:39]
    v_exp_f32 v88, v64
    v_mul_f32 v63, v63, v87
    v_mfma_f32_16x16x32_bf16 v[40:43], v[220:223], a[132:135], v[40:43]
    global_load_dwordx4 a[144:147], v3, s[52:53] offset:-3072 sc1
    s_mul_i32 s17, s3, 4064
    v_add_u32 v17, s17, v17
    v_cvt_pk_bf16_f32 v125, v62, v63
    s_waitcnt vmcnt(11)
    v_mfma_f32_16x16x32_bf16 v[28:31], v[224:227], a[196:199], v[28:31]
    v_exp_f32 v89, v65
    v_fmac_f32 v67, v251, v111
    v_mfma_f32_16x16x32_bf16 v[32:35], v[228:231], a[196:199], v[32:35]
    v_exp_f32 v90, v66
    v_fma_f32 v88, v88, s32, s32
    v_mfma_f32_16x16x32_bf16 v[36:39], v[232:235], a[196:199], v[36:39]
    global_load_dwordx4 a[208:211], v3, s[52:53] offset:1024 sc1
    v_fma_f32 v89, v89, s32, s32
    v_fma_f32 v90, v90, s32, s32
    v_mfma_f32_16x16x32_bf16 v[40:43], v[236:239], a[196:199], v[40:43]
    v_mul_f32 v68, v68, v107
    v_mul_f32 v69, v69, v107
    s_waitcnt vmcnt(11)
    v_mfma_f32_16x16x32_bf16 v[28:31], v[240:243], a[72:75], v[28:31]
    v_exp_f32 v91, v67
    v_mul_f32 v70, v70, v107
    v_mfma_f32_16x16x32_bf16 v[32:35], v[112:115], a[72:75], v[32:35]
    global_load_dwordx4 a[84:87], v4, s[52:53] offset:-3072 sc1
    v_fma_f32 v91, v91, s32, s32
    v_mfma_f32_16x16x32_bf16 v[36:39], v[116:119], a[72:75], v[36:39]
    v_rcp_f32 v88, v88
    v_mul_f32 v71, v71, v107
    v_mfma_f32_16x16x32_bf16 v[40:43], v[120:123], a[72:75], v[40:43]
    v_mul_f32 v64, v64, v88
    v_fmac_f32 v68, v252, v111
    s_waitcnt vmcnt(11)
    v_mfma_f32_16x16x32_bf16 v[28:31], a[0:3], a[136:139], v[28:31]
    global_load_dwordx4 a[148:151], v4, s[52:53] offset:1024 sc1
    v_fmac_f32 v69, v253, v111
    v_fmac_f32 v70, v254, v111
    v_mfma_f32_16x16x32_bf16 v[32:35], a[4:7], a[136:139], v[32:35]
    v_rcp_f32 v89, v89
    v_fmac_f32 v71, v255, v111
    v_mfma_f32_16x16x32_bf16 v[36:39], a[8:11], a[136:139], v[36:39]
    v_rcp_f32 v90, v90
    v_mul_f32 v65, v65, v89
    v_mfma_f32_16x16x32_bf16 v[40:43], a[12:15], a[136:139], v[40:43]
    global_load_dwordx4 a[212:215], v5, s[52:53] offset:-3072 sc1
    v_mul_f32 v66, v66, v90
    s_waitcnt vmcnt(12)
    v_mfma_f32_16x16x32_bf16 v[28:31], a[16:19], a[200:203], v[28:31]
    v_rcp_f32 v91, v91
    v_cvt_pk_bf16_f32 v126, v64, v65
    v_mfma_f32_16x16x32_bf16 v[32:35], a[20:23], a[200:203], v[32:35]
    v_exp_f32 v92, v68
    v_mul_f32 v67, v67, v91
    v_mfma_f32_16x16x32_bf16 v[36:39], a[24:27], a[200:203], v[36:39]
    global_load_dwordx4 a[88:91], v5, s[52:53] offset:1024 sc1
    v_cvt_pk_bf16_f32 v127, v66, v67
    v_fma_f32 v92, v92, s32, s32
    v_mfma_f32_16x16x32_bf16 v[40:43], a[28:31], a[200:203], v[40:43]
    v_exp_f32 v93, v69
    v_exp_f32 v94, v70
    s_waitcnt vmcnt(12)
    v_mfma_f32_16x16x32_bf16 v[28:31], a[32:35], a[76:79], v[28:31]
    global_store_dwordx4 v2, v[124:127], s[48:49] offset:3072 sc0 sc1
    v_fma_f32 v93, v93, s32, s32
    v_fma_f32 v94, v94, s32, s32
    v_mfma_f32_16x16x32_bf16 v[32:35], a[36:39], a[76:79], v[32:35]
    global_load_dwordx4 a[152:155], v6, s[52:53] offset:-3072 sc1
    v_exp_f32 v95, v71
    v_mfma_f32_16x16x32_bf16 v[36:39], a[40:43], a[76:79], v[36:39]
    v_rcp_f32 v92, v92
    v_fma_f32 v95, v95, s32, s32
    v_mfma_f32_16x16x32_bf16 v[40:43], a[44:47], a[76:79], v[40:43]
    v_mul_f32 v68, v68, v92
    v_rcp_f32 v93, v93
    s_waitcnt vmcnt(12)
    v_mfma_f32_16x16x32_bf16 v[32:35], a[52:55], a[140:143], v[32:35]
    global_load_dwordx4 a[216:219], v6, s[52:53] offset:1024 sc1
    v_mul_f32 v69, v69, v93
    v_cvt_pk_bf16_f32 v22, v68, v69
    v_mfma_f32_16x16x32_bf16 v[36:39], a[56:59], a[140:143], v[36:39]
    v_rcp_f32 v94, v94
    v_rcp_f32 v95, v95
    v_mfma_f32_16x16x32_bf16 v[40:43], a[60:63], a[140:143], v[40:43]
    v_mul_f32 v70, v70, v94
    v_mul_f32 v71, v71, v95
    v_mfma_f32_16x16x32_bf16 v[28:31], a[48:51], a[140:143], v[28:31]
    global_load_dwordx4 a[92:95], v7, s[94:95] offset:-3072 sc1
    v_cvt_pk_bf16_f32 v23, v70, v71
    s_waitcnt vmcnt(12)
    v_cmp_eq_u32_e64 s[20:21], -1, v19
    s_cmp_lg_u64 s[20:21], 0
    s_cbranch_scc1 k2_L_41S
k2_L_41B:
    s_waitcnt vmcnt(11)
    v_mfma_f32_16x16x32_bf16 v[44:47], v[144:147], a[204:207], v[132:135]
    global_store_dwordx2 v14, v[22:23], s[50:51] offset:3072 sc0 sc1
    v_mfma_f32_16x16x32_bf16 v[48:51], v[148:151], a[204:207], 0
    v_cmp_u_f32_e64 s[18:19], v32, v32
    v_mfma_f32_16x16x32_bf16 v[52:55], v[152:155], a[204:207], 0
    ds_write_b128 v9, v[32:35] offset:0
    v_mfma_f32_16x16x32_bf16 v[56:59], v[156:159], a[204:207], 0
    s_waitcnt vmcnt(11)
    v_mfma_f32_16x16x32_bf16 v[44:47], v[160:163], a[80:83], v[44:47]
    ds_write_b128 v10, v[36:39] offset:0
    v_mfma_f32_16x16x32_bf16 v[48:51], v[164:167], a[80:83], v[48:51]
    v_mfma_f32_16x16x32_bf16 v[52:55], v[168:171], a[80:83], v[52:55]
    ds_write_b128 v11, v[40:43] offset:0
    v_mfma_f32_16x16x32_bf16 v[56:59], v[172:175], a[80:83], v[56:59]
    s_waitcnt vmcnt(10)
    v_mfma_f32_16x16x32_bf16 v[44:47], v[176:179], a[144:147], v[44:47]
    ds_write_b128 v15, v[28:31] offset:0
    v_mfma_f32_16x16x32_bf16 v[48:51], v[180:183], a[144:147], v[48:51]
    s_cmp_lg_u64 s[18:19], 0
    v_mfma_f32_16x16x32_bf16 v[52:55], v[184:187], a[144:147], v[52:55]
    s_cbranch_scc1 k2_L_47S
k2_L_47B:
    v_mfma_f32_16x16x32_bf16 v[56:59], v[188:191], a[144:147], v[56:59]
    s_waitcnt lgkmcnt(0)
    s_barrier
    s_waitcnt vmcnt(9)
    v_mfma_f32_16x16x32_bf16 v[44:47], v[192:195], a[208:211], v[44:47]
    ds_read_b128 v[72:75], v12 offset:0
    ds_read_b128 v[76:79], v12 offset:1024
    v_mfma_f32_16x16x32_bf16 v[48:51], v[196:199], a[208:211], v[48:51]
    ds_read_b128 v[80:83], v12 offset:2048
    ds_read_b128 v[84:87], v12 offset:3072
    v_mfma_f32_16x16x32_bf16 v[52:55], v[200:203], a[208:211], v[52:55]
    v_mfma_f32_16x16x32_bf16 v[56:59], v[204:207], a[208:211], v[56:59]
    s_waitcnt vmcnt(8)
    v_mfma_f32_16x16x32_bf16 v[44:47], v[208:211], a[84:87], v[44:47]
    global_load_dword v20, v16, s[52:53] offset:-1552 sc1
    v_mfma_f32_16x16x32_bf16 v[48:51], v[212:215], a[84:87], v[48:51]
    global_load_dwordx4 a[156:159], v2, s[52:53] offset:-2048 sc1
    v_mfma_f32_16x16x32_bf16 v[52:55], v[216:219], a[84:87], v[52:55]
    v_mfma_f32_16x16x32_bf16 v[56:59], v[220:223], a[84:87], v[56:59]
    s_waitcnt lgkmcnt(2)
    v_pk_add_f32 v[72:73], v[72:73], v[76:77]
    v_pk_add_f32 v[74:75], v[74:75], v[78:79]
    s_waitcnt vmcnt(9)
    v_mfma_f32_16x16x32_bf16 v[44:47], v[224:227], a[148:151], v[44:47]
    s_waitcnt lgkmcnt(0)
    global_load_dwordx4 a[220:223], v2, s[52:53] offset:2048 sc1
    v_pk_add_f32 v[80:81], v[80:81], v[84:85]
    v_pk_add_f32 v[82:83], v[82:83], v[86:87]
    v_mfma_f32_16x16x32_bf16 v[48:51], v[228:231], a[148:151], v[48:51]
    v_pk_add_f32 v[72:73], v[72:73], v[80:81]
    v_pk_add_f32 v[74:75], v[74:75], v[82:83]
    v_mfma_f32_16x16x32_bf16 v[52:55], v[232:235], a[148:151], v[52:55]
    v_cvt_pk_bf16_f32 v96, v72, v73
    v_cvt_pk_bf16_f32 v97, v74, v75
    v_mfma_f32_16x16x32_bf16 v[56:59], v[236:239], a[148:151], v[56:59]
    global_load_dwordx4 a[96:99], v3, s[52:53] offset:-2048 sc1
    s_waitcnt vmcnt(10)
    v_mfma_f32_16x16x32_bf16 v[44:47], v[240:243], a[212:215], v[44:47]
    v_mfma_f32_16x16x32_bf16 v[48:51], v[112:115], a[212:215], v[48:51]
    v_mfma_f32_16x16x32_bf16 v[52:55], v[116:119], a[212:215], v[52:55]
    global_load_dwordx4 a[160:163], v3, s[52:53] offset:2048 sc1
    v_mfma_f32_16x16x32_bf16 v[56:59], v[120:123], a[212:215], v[56:59]
    s_waitcnt vmcnt(10)
    v_mfma_f32_16x16x32_bf16 v[44:47], a[0:3], a[88:91], v[44:47]
    v_mfma_f32_16x16x32_bf16 v[48:51], a[4:7], a[88:91], v[48:51]
    global_load_dwordx4 a[224:227], v4, s[52:53] offset:-2048 sc1
    v_mfma_f32_16x16x32_bf16 v[52:55], a[8:11], a[88:91], v[52:55]
    v_mfma_f32_16x16x32_bf16 v[56:59], a[12:15], a[88:91], v[56:59]
    s_waitcnt vmcnt(9)
    v_mfma_f32_16x16x32_bf16 v[44:47], a[16:19], a[152:155], v[44:47]
    global_load_dwordx4 a[100:103], v4, s[52:53] offset:2048 sc1
    v_mfma_f32_16x16x32_bf16 v[48:51], a[20:23], a[152:155], v[48:51]
    v_mfma_f32_16x16x32_bf16 v[52:55], a[24:27], a[152:155], v[52:55]
    v_mfma_f32_16x16x32_bf16 v[56:59], a[28:31], a[152:155], v[56:59]
    global_load_dwordx4 a[164:167], v5, s[52:53] offset:-2048 sc1
    s_waitcnt vmcnt(10)
    v_mfma_f32_16x16x32_bf16 v[44:47], a[32:35], a[216:219], v[44:47]
    v_mfma_f32_16x16x32_bf16 v[48:51], a[36:39], a[216:219], v[48:51]
    v_mfma_f32_16x16x32_bf16 v[52:55], a[40:43], a[216:219], v[52:55]
    global_load_dwordx4 a[228:231], v5, s[52:53] offset:2048 sc1
    v_mfma_f32_16x16x32_bf16 v[56:59], a[44:47], a[216:219], v[56:59]
    s_waitcnt vmcnt(10)
    v_mfma_f32_16x16x32_bf16 v[48:51], a[52:55], a[92:95], v[48:51]
    v_mfma_f32_16x16x32_bf16 v[52:55], a[56:59], a[92:95], v[52:55]
    global_load_dwordx4 a[104:107], v6, s[52:53] offset:-2048 sc1
    v_mfma_f32_16x16x32_bf16 v[56:59], a[60:63], a[92:95], v[56:59]
    v_mfma_f32_16x16x32_bf16 v[44:47], a[48:51], a[92:95], v[44:47]
    s_waitcnt vmcnt(9)
    v_cmp_eq_u32_e64 s[20:21], -1, v20
    s_cmp_lg_u64 s[20:21], 0
    s_cbranch_scc1 k2_L_43S
k2_L_43B:
    s_waitcnt vmcnt(8)
    v_mfma_f32_16x16x32_bf16 v[28:31], v[144:147], a[156:159], v[136:139]
    global_load_dwordx4 a[168:171], v6, s[52:53] offset:2048 sc1
    v_mfma_f32_16x16x32_bf16 v[32:35], v[148:151], a[156:159], 0
    v_cmp_u_f32_e64 s[18:19], v48, v48
    v_mfma_f32_16x16x32_bf16 v[36:39], v[152:155], a[156:159], 0
    ds_write_b128 v9, v[48:51] offset:16384
    v_mfma_f32_16x16x32_bf16 v[40:43], v[156:159], a[156:159], 0
    global_load_dwordx4 a[232:235], v7, s[94:95] offset:-2048 sc1
    s_waitcnt vmcnt(9)
    v_mfma_f32_16x16x32_bf16 v[28:31], v[160:163], a[220:223], v[28:31]
    ds_write_b128 v10, v[52:55] offset:16384
    v_mfma_f32_16x16x32_bf16 v[32:35], v[164:167], a[220:223], v[32:35]
    v_mfma_f32_16x16x32_bf16 v[36:39], v[168:171], a[220:223], v[36:39]
    ds_write_b128 v11, v[56:59] offset:16384
    v_mfma_f32_16x16x32_bf16 v[40:43], v[172:175], a[220:223], v[40:43]
    s_waitcnt vmcnt(8)
    v_mfma_f32_16x16x32_bf16 v[28:31], v[176:179], a[96:99], v[28:31]
    ds_write_b128 v15, v[44:47] offset:16384
    v_mfma_f32_16x16x32_bf16 v[32:35], v[180:183], a[96:99], v[32:35]
    s_cmp_lg_u64 s[18:19], 0
    v_mfma_f32_16x16x32_bf16 v[36:39], v[184:187], a[96:99], v[36:39]
    s_cbranch_scc1 k2_L_49S
k2_L_49B:
    v_mfma_f32_16x16x32_bf16 v[40:43], v[188:191], a[96:99], v[40:43]
    s_waitcnt lgkmcnt(0)
    s_barrier
    s_waitcnt vmcnt(7)
    v_mfma_f32_16x16x32_bf16 v[28:31], v[192:195], a[160:163], v[28:31]
    ds_read_b128 v[72:75], v12 offset:16384
    ds_read_b128 v[76:79], v12 offset:17408
    v_mfma_f32_16x16x32_bf16 v[32:35], v[196:199], a[160:163], v[32:35]
    ds_read_b128 v[80:83], v12 offset:18432
    ds_read_b128 v[84:87], v12 offset:19456
    v_mfma_f32_16x16x32_bf16 v[36:39], v[200:203], a[160:163], v[36:39]
    global_load_dword v18, v16, s[52:53] offset:-528 sc1
    v_mfma_f32_16x16x32_bf16 v[40:43], v[204:207], a[160:163], v[40:43]
    global_load_dwordx4 a[108:111], v2, s[52:53] offset:-1024 sc1
    s_waitcnt vmcnt(8)
    v_mfma_f32_16x16x32_bf16 v[28:31], v[208:211], a[224:227], v[28:31]
    v_mfma_f32_16x16x32_bf16 v[32:35], v[212:215], a[224:227], v[32:35]
    v_mfma_f32_16x16x32_bf16 v[36:39], v[216:219], a[224:227], v[36:39]
    global_load_dwordx4 a[172:175], v2, s[52:53] offset:3072 sc1
    v_mfma_f32_16x16x32_bf16 v[40:43], v[220:223], a[224:227], v[40:43]
    s_waitcnt lgkmcnt(2)
    v_pk_add_f32 v[72:73], v[72:73], v[76:77]
    v_pk_add_f32 v[74:75], v[74:75], v[78:79]
    s_waitcnt vmcnt(8)
    v_mfma_f32_16x16x32_bf16 v[28:31], v[224:227], a[100:103], v[28:31]
    s_waitcnt lgkmcnt(0)
    v_pk_add_f32 v[80:81], v[80:81], v[84:85]
    v_pk_add_f32 v[82:83], v[82:83], v[86:87]
    v_mfma_f32_16x16x32_bf16 v[32:35], v[228:231], a[100:103], v[32:35]
    global_load_dwordx4 a[236:239], v3, s[52:53] offset:-1024 sc1
    v_pk_add_f32 v[72:73], v[72:73], v[80:81]
    v_mfma_f32_16x16x32_bf16 v[36:39], v[232:235], a[100:103], v[36:39]
    v_pk_add_f32 v[74:75], v[74:75], v[82:83]
    v_cvt_pk_bf16_f32 v98, v72, v73
    v_mfma_f32_16x16x32_bf16 v[40:43], v[236:239], a[100:103], v[40:43]
    v_cvt_pk_bf16_f32 v99, v74, v75
    s_waitcnt vmcnt(8)
    v_mfma_f32_16x16x32_bf16 v[28:31], v[240:243], a[164:167], v[28:31]
    global_load_dwordx4 a[112:115], v3, s[52:53] offset:3072 sc1
    v_mfma_f32_16x16x32_bf16 v[32:35], v[112:115], a[164:167], v[32:35]
    v_mfma_f32_16x16x32_bf16 v[36:39], v[116:119], a[164:167], v[36:39]
    v_mfma_f32_16x16x32_bf16 v[40:43], v[120:123], a[164:167], v[40:43]
    global_load_dwordx4 a[176:179], v4, s[52:53] offset:-1024 sc1
    s_waitcnt vmcnt(9)
    v_mfma_f32_16x16x32_bf16 v[28:31], a[0:3], a[228:231], v[28:31]
    v_mfma_f32_16x16x32_bf16 v[32:35], a[4:7], a[228:231], v[32:35]
    v_mfma_f32_16x16x32_bf16 v[36:39], a[8:11], a[228:231], v[36:39]
    global_load_dwordx4 a[240:243], v4, s[52:53] offset:3072 sc1
    v_mfma_f32_16x16x32_bf16 v[40:43], a[12:15], a[228:231], v[40:43]
    s_waitcnt vmcnt(9)
    v_mfma_f32_16x16x32_bf16 v[28:31], a[16:19], a[104:107], v[28:31]
    v_mfma_f32_16x16x32_bf16 v[32:35], a[20:23], a[104:107], v[32:35]
    global_load_dwordx4 a[116:119], v5, s[52:53] offset:-1024 sc1
    v_mfma_f32_16x16x32_bf16 v[36:39], a[24:27], a[104:107], v[36:39]
    v_mfma_f32_16x16x32_bf16 v[40:43], a[28:31], a[104:107], v[40:43]
    s_waitcnt vmcnt(9)
    v_mfma_f32_16x16x32_bf16 v[28:31], a[32:35], a[168:171], v[28:31]
    global_load_dwordx4 a[180:183], v5, s[52:53] offset:3072 sc1
    v_mfma_f32_16x16x32_bf16 v[32:35], a[36:39], a[168:171], v[32:35]
    v_mfma_f32_16x16x32_bf16 v[36:39], a[40:43], a[168:171], v[36:39]
    v_mfma_f32_16x16x32_bf16 v[40:43], a[44:47], a[168:171], v[40:43]
    global_load_dwordx4 a[244:247], v6, s[52:53] offset:-1024 sc1
    s_waitcnt vmcnt(10)
    v_mfma_f32_16x16x32_bf16 v[32:35], a[52:55], a[232:235], v[32:35]
    v_mfma_f32_16x16x32_bf16 v[36:39], a[56:59], a[232:235], v[36:39]
    v_mfma_f32_16x16x32_bf16 v[40:43], a[60:63], a[232:235], v[40:43]
    global_load_dwordx4 a[120:123], v6, s[52:53] offset:3072 sc1
    v_mfma_f32_16x16x32_bf16 v[28:31], a[48:51], a[232:235], v[28:31]
    s_waitcnt vmcnt(10)
    v_cmp_eq_u32_e64 s[20:21], -1, v18
    s_cmp_lg_u64 s[20:21], 0
    s_cbranch_scc1 k2_L_45S
k2_L_45B:
    s_waitcnt vmcnt(9)
    v_mfma_f32_16x16x32_bf16 v[44:47], v[144:147], a[108:111], v[140:143]
    v_mfma_f32_16x16x32_bf16 v[48:51], v[148:151], a[108:111], 0
    global_load_dwordx4 a[184:187], v7, s[94:95] offset:-1024 sc1
    v_cmp_u_f32_e64 s[18:19], v32, v32
    v_mfma_f32_16x16x32_bf16 v[52:55], v[152:155], a[108:111], 0
    ds_write_b128 v9, v[32:35] offset:32768
    v_mfma_f32_16x16x32_bf16 v[56:59], v[156:159], a[108:111], 0
    s_waitcnt vmcnt(9)
    v_mfma_f32_16x16x32_bf16 v[44:47], v[160:163], a[172:175], v[44:47]
    ds_write_b128 v10, v[36:39] offset:32768
    v_mfma_f32_16x16x32_bf16 v[48:51], v[164:167], a[172:175], v[48:51]
    v_mfma_f32_16x16x32_bf16 v[52:55], v[168:171], a[172:175], v[52:55]
    ds_write_b128 v11, v[40:43] offset:32768
    v_mfma_f32_16x16x32_bf16 v[56:59], v[172:175], a[172:175], v[56:59]
    s_waitcnt vmcnt(8)
    v_mfma_f32_16x16x32_bf16 v[44:47], v[176:179], a[236:239], v[44:47]
    ds_write_b128 v15, v[28:31] offset:32768
    v_mfma_f32_16x16x32_bf16 v[48:51], v[180:183], a[236:239], v[48:51]
    s_cmp_lg_u64 s[18:19], 0
    v_mfma_f32_16x16x32_bf16 v[52:55], v[184:187], a[236:239], v[52:55]
    s_cbranch_scc1 k2_L_51S
k2_L_51B:
    v_mfma_f32_16x16x32_bf16 v[56:59], v[188:191], a[236:239], v[56:59]
    s_waitcnt lgkmcnt(0)
    s_barrier
    s_waitcnt vmcnt(7)
    v_mfma_f32_16x16x32_bf16 v[44:47], v[192:195], a[112:115], v[44:47]
    ds_read_b128 v[72:75], v12 offset:32768
    ds_read_b128 v[76:79], v12 offset:33792
    v_mfma_f32_16x16x32_bf16 v[48:51], v[196:199], a[112:115], v[48:51]
    ds_read_b128 v[80:83], v12 offset:34816
    ds_read_b128 v[84:87], v12 offset:35840
    v_mfma_f32_16x16x32_bf16 v[52:55], v[200:203], a[112:115], v[52:55]
    v_mfma_f32_16x16x32_bf16 v[56:59], v[204:207], a[112:115], v[56:59]
    s_waitcnt vmcnt(6)
    v_mfma_f32_16x16x32_bf16 v[44:47], v[208:211], a[176:179], v[44:47]
    v_mfma_f32_16x16x32_bf16 v[48:51], v[212:215], a[176:179], v[48:51]
    v_mfma_f32_16x16x32_bf16 v[52:55], v[216:219], a[176:179], v[52:55]
    v_mfma_f32_16x16x32_bf16 v[56:59], v[220:223], a[176:179], v[56:59]
    s_waitcnt lgkmcnt(2)
    v_pk_add_f32 v[72:73], v[72:73], v[76:77]
    v_pk_add_f32 v[74:75], v[74:75], v[78:79]
    s_waitcnt vmcnt(5)
    v_mfma_f32_16x16x32_bf16 v[44:47], v[224:227], a[240:243], v[44:47]
    s_waitcnt lgkmcnt(0)
    global_store_dwordx2 v17, v[96:97], s[38:39]
    s_add_u32 s38, s38, 16384
    s_addc_u32 s39, s39, 0
    v_pk_add_f32 v[80:81], v[80:81], v[84:85]
    v_pk_add_f32 v[82:83], v[82:83], v[86:87]
    v_mfma_f32_16x16x32_bf16 v[48:51], v[228:231], a[240:243], v[48:51]
    v_pk_add_f32 v[72:73], v[72:73], v[80:81]
    v_pk_add_f32 v[74:75], v[74:75], v[82:83]
    v_mfma_f32_16x16x32_bf16 v[52:55], v[232:235], a[240:243], v[52:55]
    global_store_dwordx2 v17, v[98:99], s[38:39]
    s_add_u32 s38, s38, 16384
    s_addc_u32 s39, s39, 0
    v_mfma_f32_16x16x32_bf16 v[56:59], v[236:239], a[240:243], v[56:59]
    v_cvt_pk_bf16_f32 v100, v72, v73
    s_waitcnt vmcnt(6)
    v_mfma_f32_16x16x32_bf16 v[44:47], v[240:243], a[116:119], v[44:47]
    v_cvt_pk_bf16_f32 v101, v74, v75
    v_mfma_f32_16x16x32_bf16 v[48:51], v[112:115], a[116:119], v[48:51]
    global_store_dwordx2 v17, v[100:101], s[38:39]
    s_add_u32 s38, s38, 16384
    s_addc_u32 s39, s39, 0
    v_mfma_f32_16x16x32_bf16 v[52:55], v[116:119], a[116:119], v[52:55]
    v_mfma_f32_16x16x32_bf16 v[56:59], v[120:123], a[116:119], v[56:59]
    s_waitcnt vmcnt(6)
    v_mfma_f32_16x16x32_bf16 v[44:47], a[0:3], a[180:183], v[44:47]
    v_mfma_f32_16x16x32_bf16 v[48:51], a[4:7], a[180:183], v[48:51]
    v_mfma_f32_16x16x32_bf16 v[52:55], a[8:11], a[180:183], v[52:55]
    v_mfma_f32_16x16x32_bf16 v[56:59], a[12:15], a[180:183], v[56:59]
    s_waitcnt vmcnt(5)
    v_mfma_f32_16x16x32_bf16 v[44:47], a[16:19], a[244:247], v[44:47]
    v_mfma_f32_16x16x32_bf16 v[48:51], a[20:23], a[244:247], v[48:51]
    v_mfma_f32_16x16x32_bf16 v[52:55], a[24:27], a[244:247], v[52:55]
    v_mfma_f32_16x16x32_bf16 v[56:59], a[28:31], a[244:247], v[56:59]
    s_waitcnt vmcnt(4)
    v_mfma_f32_16x16x32_bf16 v[44:47], a[32:35], a[120:123], v[44:47]
    v_mfma_f32_16x16x32_bf16 v[48:51], a[36:39], a[120:123], v[48:51]
    v_mfma_f32_16x16x32_bf16 v[52:55], a[40:43], a[120:123], v[52:55]
    v_mfma_f32_16x16x32_bf16 v[56:59], a[44:47], a[120:123], v[56:59]
    s_waitcnt vmcnt(3)
    v_mfma_f32_16x16x32_bf16 v[48:51], a[52:55], a[184:187], v[48:51]
    v_mfma_f32_16x16x32_bf16 v[52:55], a[56:59], a[184:187], v[52:55]
    v_mfma_f32_16x16x32_bf16 v[56:59], a[60:63], a[184:187], v[56:59]
    v_mfma_f32_16x16x32_bf16 v[44:47], a[48:51], a[184:187], v[44:47]
    s_nop 4
    v_cmp_u_f32_e64 s[18:19], v48, v48
    ds_write_b128 v9, v[48:51] offset:49152
    ds_write_b128 v10, v[52:55] offset:49152
    ds_write_b128 v11, v[56:59] offset:49152
    ds_write_b128 v15, v[44:47] offset:49152
    s_cmp_lg_u64 s[18:19], 0
    s_cbranch_scc1 k2_L_53S
k2_L_53B:
    s_waitcnt lgkmcnt(0)
    s_barrier
    ds_read_b128 v[72:75], v12 offset:49152
    ds_read_b128 v[76:79], v12 offset:50176
    ds_read_b128 v[80:83], v12 offset:51200
    ds_read_b128 v[84:87], v12 offset:52224
    s_waitcnt lgkmcnt(2)
    v_pk_add_f32 v[72:73], v[72:73], v[76:77]
    v_pk_add_f32 v[74:75], v[74:75], v[78:79]
    s_waitcnt lgkmcnt(0)
    v_pk_add_f32 v[80:81], v[80:81], v[84:85]
    v_pk_add_f32 v[82:83], v[82:83], v[86:87]
    v_pk_add_f32 v[72:73], v[72:73], v[80:81]
    v_pk_add_f32 v[74:75], v[74:75], v[82:83]
    v_cvt_pk_bf16_f32 v102, v72, v73
    v_cvt_pk_bf16_f32 v103, v74, v75
    global_store_dwordx2 v17, v[102:103], s[38:39]
k2_END:
    s_endpgm
k2_L_1S:
k2_L_2L:
    global_load_dword v122, v123, s[10:11] sc1
    s_sub_u32 s67, s67, 1
    s_cbranch_scc1 k2_L_2X
    s_waitcnt vmcnt(0)
    v_cmp_gt_u32 vcc, 8, v122
    s_cbranch_vccnz k2_L_2L
    s_branch k2_L_2Y
k2_L_2X:
    s_mov_b32 s67, 0
k2_L_2Y:
    s_waitcnt vmcnt(0)
    s_branch k2_L_1B
k2_PS:
    s_cmp_lg_u32 s3, 0
    s_cbranch_scc1 k2_PS1
    s_lshr_b32 s26, s2, 3
    s_lshl_b64 exec, 1, s26
    global_store_dword v0, v76, s[6:7] offset:128 sc0 sc1
    s_mov_b64 exec, -1
k2_PS1:
    global_load_dword v74, v0, s[6:7] sc1
    global_load_dword v75, v0, s[6:7] offset:128 sc1
    s_waitcnt vmcnt(0)
    v_cmp_ne_u32 vcc, s68, v74
    s_cbranch_vccz k2_PX
    s_sub_u32 s67, s67, 1
    s_cbranch_scc1 k2_PS2
    v_cmp_eq_u32 vcc, 0, v75
    s_cbranch_vccnz k2_PS1
    v_cmp_ne_u32 vcc, s68, v75
    s_cbranch_vccz k2_PS1
    s_add_u32 s67, s67, 1
k2_PS2:
    s_add_u32 s67, s67, 1
    s_mov_b32 s0, 1
    s_cmp_lg_u32 s3, 0
    s_cbranch_scc1 k2_PS3
    buffer_wbl2 sc1
    s_waitcnt vmcnt(0)
    s_mov_b64 exec, 1
    global_atomic_add v0, v22, s[6:7] offset:256 sc1
    s_mov_b64 exec, -1
k2_PS3:
    v_and_b32 v75, 0xffffff00, v0
k2_L_3L:
    global_load_dword v74, v75, s[6:7] offset:256 sc1
    s_sub_u32 s67, s67, 1
    s_cbranch_scc1 k2_L_3X
    s_waitcnt vmcnt(0)
    v_cmp_ne_u32 vcc, 32, v74
    s_cbranch_vccnz k2_L_3L
    s_branch k2_L_3Y
k2_L_3X:
    s_mov_b32 s67, 0
k2_L_3Y:
    s_waitcnt vmcnt(0)
    buffer_inv sc1
    s_waitcnt vmcnt(0)
    s_branch k2_PX
k2_L_5S:
k2_L_6L:
    v_and_b32 v37, 7, v1
    v_lshlrev_b32 v37, 10, v37
    v_add_u32 v37, 16252928, v37
    global_load_dword v37, v37, s[6:7] offset:512 sc1
    s_sub_u32 s67, s67, 1
    s_cbranch_scc1 k2_L_6X
    s_waitcnt vmcnt(0)
    v_cmp_ne_u32 vcc, 32, v37
    s_cbranch_vccnz k2_L_6L
    s_branch k2_L_6Y
k2_L_6X:
    s_mov_b32 s67, 0
k2_L_6Y:
    s_waitcnt vmcnt(0)
    s_branch k2_L_5B
k2_MODE:
    v_cmp_ne_u32 vcc, 32, v22
    s_cbranch_vccz k2_MODX
    global_load_dword v22, v23, s[6:7] offset:384 sc1
    s_waitcnt vmcnt(0)
    s_sub_u32 s67, s67, 1
    s_cbranch_scc0 k2_MODE
    s_mov_b32 s67, 0
k2_MODX:
    s_cmp_lg_u32 s0, 0
    s_cbranch_scc1 k2_GOW
    s_branch k2_GO
k2_L_8S:
    s_mov_b64 s[28:29], -1
    s_branch k2_L_8B
k2_L_11S:
k2_L_10L:
    global_load_dwordx4 v[96:99], v2, s[34:35] offset:0 sc1
    global_load_dwordx4 v[100:103], v2, s[34:35] offset:1024 sc1
    global_load_dwordx4 v[104:107], v2, s[34:35] offset:2048 sc1
    global_load_dwordx4 v[108:111], v2, s[34:35] offset:3072 sc1
    s_sub_u32 s67, s67, 1
    s_cbranch_scc1 k2_L_10X
    s_waitcnt vmcnt(0)
    v_max3_u32 v36, v96, v100, v104
    v_max_u32 v36, v36, v108
    v_cmp_eq_u32_e64 vcc, -1, v36
    s_cbranch_vccnz k2_L_10L
    s_branch k2_L_10Y
k2_L_10X:
    s_mov_b32 s67, 0
k2_L_10Y:
    s_waitcnt vmcnt(0)
    s_branch k2_L_11B
k2_L_9:
    s_waitcnt vmcnt(0)
    s_cmp_eq_u64 s[26:27], 0
    s_cbranch_scc1 k2_L_9_KB
    v_mov_b32 v32, 0xff800000
    v_mov_b32 v56, v12
    s_mov_b32 s26, 64
k2_L_9_1B:
    ds_read_b128 v[40:43], v56
    v_add_u32 v56, 2304, v56
    s_waitcnt lgkmcnt(0)
    v_mfma_f32_32x32x16_bf16 v[64:79], v[40:43], v[28:31], 0
    s_nop 11
    v_max3_f32 v32, v64, v65, v32
    v_max3_f32 v32, v66, v67, v32
    v_max3_f32 v32, v68, v69, v32
    v_max3_f32 v32, v70, v71, v32
    v_max3_f32 v32, v72, v73, v32
    v_max3_f32 v32, v74, v75, v32
    v_max3_f32 v32, v76, v77, v32
    v_max3_f32 v32, v78, v79, v32
    s_sub_u32 s26, s26, 1
    s_cmp_lg_u32 s26, 0
    s_cbranch_scc1 k2_L_9_1B
    v_mov_b32 v33, v32
    s_nop 1
    v_permlane32_swap_b32 v32, v33
    v_max_f32 v32, v32, v33
    v_sub_f32 v80, 0, v32
    v_mov_b32 v112, 0
    v_sub_f32 v81, 0, v32
    v_mov_b32 v113, 0
    v_sub_f32 v82, 0, v32
    v_mov_b32 v114, 0
    v_sub_f32 v83, 0, v32
    v_mov_b32 v115, 0
    v_sub_f32 v84, 0, v32
    v_mov_b32 v116, 0
    v_sub_f32 v85, 0, v32
    v_mov_b32 v117, 0
    v_sub_f32 v86, 0, v32
    v_mov_b32 v118, 0
    v_sub_f32 v87, 0, v32
    v_mov_b32 v119, 0
    v_sub_f32 v88, 0, v32
    v_mov_b32 v120, 0
    v_sub_f32 v89, 0, v32
    v_mov_b32 v121, 0
    v_sub_f32 v90, 0, v32
    v_mov_b32 v122, 0
    v_sub_f32 v91, 0, v32
    v_mov_b32 v123, 0
    v_sub_f32 v92, 0, v32
    v_mov_b32 v124, 0
    v_sub_f32 v93, 0, v32
    v_mov_b32 v125, 0
    v_sub_f32 v94, 0, v32
    v_mov_b32 v126, 0
    v_sub_f32 v95, 0, v32
    v_mov_b32 v127, 0
    v_mov_b32 v56, v12
    v_mov_b32 v57, v15
    v_mov_b32 v58, v18
    s_mov_b32 s26, 64
k2_L_9_2B:
    ds_read_b128 v[40:43], v56
    ds_read_b128 v[48:51], v57
    ds_read_b128 v[52:55], v58
    v_add_u32 v56, 2304, v56
    v_add_u32 v57, 2304, v57
    v_add_u32 v58, 2304, v58
    s_waitcnt lgkmcnt(0)
    v_mfma_f32_32x32x16_bf16 v[64:79], v[40:43], v[28:31], v[80:95]
    s_nop 11
    v_exp_f32 v64, v64
    v_exp_f32 v65, v65
    v_exp_f32 v66, v66
    v_exp_f32 v67, v67
    v_exp_f32 v68, v68
    v_exp_f32 v69, v69
    v_exp_f32 v70, v70
    v_exp_f32 v71, v71
    v_exp_f32 v72, v72
    v_exp_f32 v73, v73
    v_exp_f32 v74, v74
    v_exp_f32 v75, v75
    v_exp_f32 v76, v76
    v_exp_f32 v77, v77
    v_exp_f32 v78, v78
    v_exp_f32 v79, v79
    v_smfmac_f32_32x32x32_bf16 v[112:127], v[48:51], v[64:71], v39
    s_nop 0
    v_smfmac_f32_32x32x32_bf16 v[112:127], v[52:55], v[72:79], v39
    s_sub_u32 s26, s26, 1
    s_cmp_lg_u32 s26, 0
    s_cbranch_scc1 k2_L_9_2B
    s_nop 8
    v_rcp_f32 v121, v120
    s_nop 0
    v_pk_mul_f32 v[112:113], v[112:113], v[120:121] op_sel:[0,1] op_sel_hi:[1,1]
    v_pk_mul_f32 v[114:115], v[114:115], v[120:121] op_sel:[0,1] op_sel_hi:[1,1]
    v_pk_mul_f32 v[116:117], v[116:117], v[120:121] op_sel:[0,1] op_sel_hi:[1,1]
    v_pk_mul_f32 v[118:119], v[118:119], v[120:121] op_sel:[0,1] op_sel_hi:[1,1]
    v_cvt_pk_bf16_f32 v124, v112, v113
    v_cvt_pk_bf16_f32 v125, v114, v115
    v_cvt_pk_bf16_f32 v126, v116, v117
    v_cvt_pk_bf16_f32 v127, v118, v119
k2_L_9_KB:
    global_store_dwordx4 v21, v[124:127], s[92:93] sc0 sc1
    s_cmp_eq_u64 s[28:29], 0
    s_cbranch_scc1 k2_L_9_KA
    v_mov_b32 v32, 0xff800000
    v_mov_b32 v56, v12
    s_mov_b32 s26, 64
k2_L_9_1A:
    ds_read_b128 v[40:43], v56
    v_add_u32 v56, 2304, v56
    s_waitcnt lgkmcnt(0)
    v_mfma_f32_32x32x16_bf16 v[64:79], v[40:43], v[24:27], 0
    s_nop 11
    v_max3_f32 v32, v64, v65, v32
    v_max3_f32 v32, v66, v67, v32
    v_max3_f32 v32, v68, v69, v32
    v_max3_f32 v32, v70, v71, v32
    v_max3_f32 v32, v72, v73, v32
    v_max3_f32 v32, v74, v75, v32
    v_max3_f32 v32, v76, v77, v32
    v_max3_f32 v32, v78, v79, v32
    s_sub_u32 s26, s26, 1
    s_cmp_lg_u32 s26, 0
    s_cbranch_scc1 k2_L_9_1A
    v_mov_b32 v33, v32
    s_nop 1
    v_permlane32_swap_b32 v32, v33
    v_max_f32 v32, v32, v33
    v_sub_f32 v80, 0, v32
    v_mov_b32 v96, 0
    v_sub_f32 v81, 0, v32
    v_mov_b32 v97, 0
    v_sub_f32 v82, 0, v32
    v_mov_b32 v98, 0
    v_sub_f32 v83, 0, v32
    v_mov_b32 v99, 0
    v_sub_f32 v84, 0, v32
    v_mov_b32 v100, 0
    v_sub_f32 v85, 0, v32
    v_mov_b32 v101, 0
    v_sub_f32 v86, 0, v32
    v_mov_b32 v102, 0
    v_sub_f32 v87, 0, v32
    v_mov_b32 v103, 0
    v_sub_f32 v88, 0, v32
    v_mov_b32 v104, 0
    v_sub_f32 v89, 0, v32
    v_mov_b32 v105, 0
    v_sub_f32 v90, 0, v32
    v_mov_b32 v106, 0
    v_sub_f32 v91, 0, v32
    v_mov_b32 v107, 0
    v_sub_f32 v92, 0, v32
    v_mov_b32 v108, 0
    v_sub_f32 v93, 0, v32
    v_mov_b32 v109, 0
    v_sub_f32 v94, 0, v32
    v_mov_b32 v110, 0
    v_sub_f32 v95, 0, v32
    v_mov_b32 v111, 0
    v_mov_b32 v56, v12
    v_mov_b32 v57, v15
    v_mov_b32 v58, v18
    s_mov_b32 s26, 64
k2_L_9_2A:
    ds_read_b128 v[40:43], v56
    ds_read_b128 v[48:51], v57
    ds_read_b128 v[52:55], v58
    v_add_u32 v56, 2304, v56
    v_add_u32 v57, 2304, v57
    v_add_u32 v58, 2304, v58
    s_waitcnt lgkmcnt(0)
    v_mfma_f32_32x32x16_bf16 v[64:79], v[40:43], v[24:27], v[80:95]
    s_nop 11
    v_exp_f32 v64, v64
    v_exp_f32 v65, v65
    v_exp_f32 v66, v66
    v_exp_f32 v67, v67
    v_exp_f32 v68, v68
    v_exp_f32 v69, v69
    v_exp_f32 v70, v70
    v_exp_f32 v71, v71
    v_exp_f32 v72, v72
    v_exp_f32 v73, v73
    v_exp_f32 v74, v74
    v_exp_f32 v75, v75
    v_exp_f32 v76, v76
    v_exp_f32 v77, v77
    v_exp_f32 v78, v78
    v_exp_f32 v79, v79
    v_smfmac_f32_32x32x32_bf16 v[96:111], v[48:51], v[64:71], v39
    s_nop 0
    v_smfmac_f32_32x32x32_bf16 v[96:111], v[52:55], v[72:79], v39
    s_sub_u32 s26, s26, 1
    s_cmp_lg_u32 s26, 0
    s_cbranch_scc1 k2_L_9_2A
    s_nop 8
    v_rcp_f32 v105, v104
    s_nop 0
    v_pk_mul_f32 v[96:97], v[96:97], v[104:105] op_sel:[0,1] op_sel_hi:[1,1]
    v_pk_mul_f32 v[98:99], v[98:99], v[104:105] op_sel:[0,1] op_sel_hi:[1,1]
    v_pk_mul_f32 v[100:101], v[100:101], v[104:105] op_sel:[0,1] op_sel_hi:[1,1]
    v_pk_mul_f32 v[102:103], v[102:103], v[104:105] op_sel:[0,1] op_sel_hi:[1,1]
    v_cvt_pk_bf16_f32 v108, v96, v97
    v_cvt_pk_bf16_f32 v109, v98, v99
    v_cvt_pk_bf16_f32 v110, v100, v101
    v_cvt_pk_bf16_f32 v111, v102, v103
    global_store_dwordx4 v21, v[108:111], s[22:23] sc0 sc1
k2_L_9_KA:
    global_load_dwordx4 v[64:67], v4, s[34:35] offset:0 sc1
    global_load_dwordx4 v[68:71], v4, s[34:35] offset:1024 sc1
    global_load_dwordx4 v[72:75], v4, s[34:35] offset:2048 sc1
    global_load_dwordx4 v[76:79], v4, s[34:35] offset:3072 sc1
    v_lshlrev_b32 v136, 16, v138
    v_and_b32 v137, 0xffff0000, v138
    v_lshlrev_b32 v138, 16, v139
    v_and_b32 v139, 0xffff0000, v139
    s_waitcnt vmcnt(0)
    s_branch k2_L_11S
k2_L_13S:
k2_L_12L:
    global_load_dwordx4 v[64:67], v4, s[34:35] offset:0 sc1
    global_load_dwordx4 v[68:71], v4, s[34:35] offset:1024 sc1
    global_load_dwordx4 v[72:75], v4, s[34:35] offset:2048 sc1
    global_load_dwordx4 v[76:79], v4, s[34:35] offset:3072 sc1
    s_sub_u32 s67, s67, 1
    s_cbranch_scc1 k2_L_12X
    s_waitcnt vmcnt(0)
    v_max3_u32 v36, v64, v68, v72
    v_max_u32 v36, v36, v76
    v_cmp_eq_u32_e64 vcc, -1, v36
    s_cbranch_vccnz k2_L_12L
    s_branch k2_L_12Y
k2_L_12X:
    s_mov_b32 s67, 0
k2_L_12Y:
    s_waitcnt vmcnt(0)
    s_branch k2_L_13B
k2_L_15S:
    s_mov_b32 s96, m0
k2_L_14L:
    v_lshlrev_b32 v0, 2, v2
    v_add_u32 v0, 0, v0
    global_load_dwordx3 v[24:26], v0, s[44:45] sc1
    s_sub_u32 s67, s67, 1
    s_cbranch_scc1 k2_L_14X
    s_waitcnt vmcnt(0)
    v_max_u32 v24, v24, v26
    v_cmp_eq_u32 vcc, -1, v24
    s_cbranch_vccnz k2_L_14L
    s_branch k2_L_14Y
k2_L_14X:
    s_mov_b32 s67, 0
k2_L_14Y:
    s_add_u32 m0, s30, 0
    s_nop 0
    global_load_lds_dwordx4 v2, s[44:45] offset:0 sc1
    global_load_lds_dwordx4 v2, s[44:45] offset:1024 sc1
    global_load_lds_dwordx4 v2, s[44:45] offset:2048 sc1
    global_load_lds_dwordx4 v2, s[44:45] offset:3072 sc1
    s_waitcnt vmcnt(0)
    s_mov_b32 m0, s96
    s_branch k2_L_15B
k2_L_17S:
    s_mov_b32 s96, m0
k2_L_16L:
    v_lshlrev_b32 v0, 2, v2
    v_add_u32 v0, 16384, v0
    global_load_dwordx3 v[24:26], v0, s[44:45] sc1
    s_sub_u32 s67, s67, 1
    s_cbranch_scc1 k2_L_16X
    s_waitcnt vmcnt(0)
    v_max_u32 v24, v24, v26
    v_cmp_eq_u32 vcc, -1, v24
    s_cbranch_vccnz k2_L_16L
    s_branch k2_L_16Y
k2_L_16X:
    s_mov_b32 s67, 0
k2_L_16Y:
    s_add_u32 m0, s30, 16384
    s_nop 0
    global_load_lds_dwordx4 v4, s[44:45] offset:0 sc1
    global_load_lds_dwordx4 v4, s[44:45] offset:1024 sc1
    global_load_lds_dwordx4 v4, s[44:45] offset:2048 sc1
    global_load_lds_dwordx4 v4, s[44:45] offset:3072 sc1
    s_waitcnt vmcnt(0)
    s_mov_b32 m0, s96
    s_branch k2_L_17B
k2_L_19S:
k2_L_18L:
    global_load_dwordx4 v[112:115], v6, s[34:35] offset:0 sc1
    global_load_dwordx4 v[116:119], v6, s[34:35] offset:1024 sc1
    global_load_dwordx4 v[120:123], v6, s[34:35] offset:2048 sc1
    global_load_dwordx4 v[124:127], v6, s[34:35] offset:3072 sc1
    s_sub_u32 s67, s67, 1
    s_cbranch_scc1 k2_L_18X
    s_waitcnt vmcnt(0)
    v_max3_u32 v36, v112, v116, v120
    v_max_u32 v36, v36, v124
    v_cmp_eq_u32_e64 vcc, -1, v36
    s_cbranch_vccnz k2_L_18L
    s_branch k2_L_18Y
k2_L_18X:
    s_mov_b32 s67, 0
k2_L_18Y:
    s_waitcnt vmcnt(0)
    s_branch k2_L_19B
k2_L_21S:
k2_L_20L:
    global_load_dwordx4 v[96:99], v8, s[34:35] offset:0 sc1
    global_load_dwordx4 v[100:103], v8, s[34:35] offset:1024 sc1
    global_load_dwordx4 v[104:107], v8, s[34:35] offset:2048 sc1
    global_load_dwordx4 v[108:111], v8, s[34:35] offset:3072 sc1
    s_sub_u32 s67, s67, 1
    s_cbranch_scc1 k2_L_20X
    s_waitcnt vmcnt(0)
    v_max3_u32 v36, v96, v100, v104
    v_max_u32 v36, v36, v108
    v_cmp_eq_u32_e64 vcc, -1, v36
    s_cbranch_vccnz k2_L_20L
    s_branch k2_L_20Y
k2_L_20X:
    s_mov_b32 s67, 0
k2_L_20Y:
    s_waitcnt vmcnt(0)
    s_branch k2_L_21B
k2_L_23S:
    s_mov_b32 s96, m0
k2_L_22L:
    v_lshlrev_b32 v0, 2, v2
    v_add_u32 v0, 32768, v0
    global_load_dwordx3 v[24:26], v0, s[44:45] sc1
    s_sub_u32 s67, s67, 1
    s_cbranch_scc1 k2_L_22X
    s_waitcnt vmcnt(0)
    v_max_u32 v24, v24, v26
    v_cmp_eq_u32 vcc, -1, v24
    s_cbranch_vccnz k2_L_22L
    s_branch k2_L_22Y
k2_L_22X:
    s_mov_b32 s67, 0
k2_L_22Y:
    s_add_u32 m0, s30, 32768
    s_nop 0
    global_load_lds_dwordx4 v6, s[44:45] offset:0 sc1
    global_load_lds_dwordx4 v6, s[44:45] offset:1024 sc1
    global_load_lds_dwordx4 v6, s[44:45] offset:2048 sc1
    global_load_lds_dwordx4 v6, s[44:45] offset:3072 sc1
    s_waitcnt vmcnt(0)
    s_mov_b32 m0, s96
    s_branch k2_L_23B
k2_L_25S:
    s_mov_b32 s96, m0
k2_L_24L:
    v_lshlrev_b32 v0, 2, v2
    v_add_u32 v0, 49152, v0
    global_load_dwordx3 v[24:26], v0, s[44:45] sc1
    s_sub_u32 s67, s67, 1
    s_cbranch_scc1 k2_L_24X
    s_waitcnt vmcnt(0)
    v_max_u32 v24, v24, v26
    v_cmp_eq_u32 vcc, -1, v24
    s_cbranch_vccnz k2_L_24L
    s_branch k2_L_24Y
k2_L_24X:
    s_mov_b32 s67, 0
k2_L_24Y:
    s_add_u32 m0, s30, 49152
    s_nop 0
    global_load_lds_dwordx4 v8, s[44:45] offset:0 sc1
    global_load_lds_dwordx4 v8, s[44:45] offset:1024 sc1
    global_load_lds_dwordx4 v8, s[44:45] offset:2048 sc1
    global_load_lds_dwordx4 v8, s[44:45] offset:3072 sc1
    s_waitcnt vmcnt(0)
    s_mov_b32 m0, s96
    s_branch k2_L_25B
k2_L_27S:
k2_L_26L:
    global_load_dwordx4 v[72:75], v1, s[46:47] offset:0 sc1
    global_load_dwordx4 v[76:79], v1, s[46:47] offset:1024 sc1
    s_sub_u32 s67, s67, 1
    s_cbranch_scc1 k2_L_26X
    s_waitcnt vmcnt(0)
    v_max3_u32 v104, v72, v73, v74
    v_max3_u32 v108, v75, v76, v77
    v_max3_u32 v104, v104, v78, v79
    v_max_u32 v104, v104, v108
    v_cmp_eq_u32 vcc, -1, v104
    s_cbranch_vccnz k2_L_26L
    s_branch k2_L_26Y
k2_L_26X:
    s_mov_b32 s67, 0
k2_L_26Y:
    s_waitcnt vmcnt(0)
    s_branch k2_L_27B
k2_L_29S:
k2_L_28L:
    global_load_dwordx4 v[96:99], v1, s[46:47] offset:512 sc1
    global_load_dwordx4 v[100:103], v1, s[46:47] offset:1536 sc1
    s_sub_u32 s67, s67, 1
    s_cbranch_scc1 k2_L_28X
    s_waitcnt vmcnt(0)
    v_max3_u32 v106, v96, v97, v98
    v_max3_u32 v110, v99, v100, v101
    v_max3_u32 v106, v106, v102, v103
    v_max_u32 v106, v106, v110
    v_cmp_eq_u32 vcc, -1, v106
    s_cbranch_vccnz k2_L_28L
    s_branch k2_L_28Y
k2_L_28X:
    s_mov_b32 s67, 0
k2_L_28Y:
    s_waitcnt vmcnt(0)
    s_branch k2_L_29B
k2_L_31S:
    v_mov_b32 v0, v2
    s_mov_b32 s17, 16
k2_L_30L:
    global_load_dwordx4 v[24:27], v0, s[54:55] offset:0 sc1
    s_waitcnt vmcnt(0)
    v_max_u32 v24, v24, v26
    v_cmp_eq_u32 vcc, -1, v24
    s_cbranch_vccz k2_L_30N
    s_sub_u32 s67, s67, 1
    s_cbranch_scc0 k2_L_30L
    s_mov_b32 s67, 0
k2_L_30N:
    v_add_u32 v0, 1024, v0
    s_sub_u32 s17, s17, 1
    s_cmp_lg_u32 s17, 0
    s_cbranch_scc1 k2_L_30L
    v_mov_b32 v0, v2
    global_load_dwordx4 v[24:27], v0, s[54:55] sc1
    v_add_u32 v0, 1024, v0
    s_waitcnt vmcnt(0)
    v_mfma_f32_16x16x32_bf16 v[60:63], a[64:67], v[24:27], 0
    v_mfma_f32_16x16x32_bf16 v[64:67], a[128:131], v[24:27], 0
    v_mfma_f32_16x16x32_bf16 v[68:71], a[192:195], v[24:27], 0
    global_load_dwordx4 v[24:27], v0, s[54:55] sc1
    v_add_u32 v0, 1024, v0
    s_waitcnt vmcnt(0)
    v_mfma_f32_16x16x32_bf16 v[60:63], a[68:71], v[24:27], v[60:63]
    v_mfma_f32_16x16x32_bf16 v[64:67], a[132:135], v[24:27], v[64:67]
    v_mfma_f32_16x16x32_bf16 v[68:71], a[196:199], v[24:27], v[68:71]
    global_load_dwordx4 v[24:27], v0, s[54:55] sc1
    v_add_u32 v0, 1024, v0
    s_waitcnt vmcnt(0)
    v_mfma_f32_16x16x32_bf16 v[60:63], a[72:75], v[24:27], v[60:63]
    v_mfma_f32_16x16x32_bf16 v[64:67], a[136:139], v[24:27], v[64:67]
    v_mfma_f32_16x16x32_bf16 v[68:71], a[200:203], v[24:27], v[68:71]
    global_load_dwordx4 v[24:27], v0, s[54:55] sc1
    v_add_u32 v0, 1024, v0
    s_waitcnt vmcnt(0)
    v_mfma_f32_16x16x32_bf16 v[60:63], a[76:79], v[24:27], v[60:63]
    v_mfma_f32_16x16x32_bf16 v[64:67], a[140:143], v[24:27], v[64:67]
    v_mfma_f32_16x16x32_bf16 v[68:71], a[204:207], v[24:27], v[68:71]
    global_load_dwordx4 v[24:27], v0, s[54:55] sc1
    v_add_u32 v0, 1024, v0
    s_waitcnt vmcnt(0)
    v_mfma_f32_16x16x32_bf16 v[60:63], a[80:83], v[24:27], v[60:63]
    v_mfma_f32_16x16x32_bf16 v[64:67], a[144:147], v[24:27], v[64:67]
    v_mfma_f32_16x16x32_bf16 v[68:71], a[208:211], v[24:27], v[68:71]
    global_load_dwordx4 v[24:27], v0, s[54:55] sc1
    v_add_u32 v0, 1024, v0
    s_waitcnt vmcnt(0)
    v_mfma_f32_16x16x32_bf16 v[60:63], a[84:87], v[24:27], v[60:63]
    v_mfma_f32_16x16x32_bf16 v[64:67], a[148:151], v[24:27], v[64:67]
    v_mfma_f32_16x16x32_bf16 v[68:71], a[212:215], v[24:27], v[68:71]
    global_load_dwordx4 v[24:27], v0, s[54:55] sc1
    v_add_u32 v0, 1024, v0
    s_waitcnt vmcnt(0)
    v_mfma_f32_16x16x32_bf16 v[60:63], a[88:91], v[24:27], v[60:63]
    v_mfma_f32_16x16x32_bf16 v[64:67], a[152:155], v[24:27], v[64:67]
    v_mfma_f32_16x16x32_bf16 v[68:71], a[216:219], v[24:27], v[68:71]
    global_load_dwordx4 v[24:27], v0, s[54:55] sc1
    v_add_u32 v0, 1024, v0
    s_waitcnt vmcnt(0)
    v_mfma_f32_16x16x32_bf16 v[60:63], a[92:95], v[24:27], v[60:63]
    v_mfma_f32_16x16x32_bf16 v[64:67], a[156:159], v[24:27], v[64:67]
    v_mfma_f32_16x16x32_bf16 v[68:71], a[220:223], v[24:27], v[68:71]
    global_load_dwordx4 v[24:27], v0, s[54:55] sc1
    v_add_u32 v0, 1024, v0
    s_waitcnt vmcnt(0)
    v_mfma_f32_16x16x32_bf16 v[60:63], a[96:99], v[24:27], v[60:63]
    v_mfma_f32_16x16x32_bf16 v[64:67], a[160:163], v[24:27], v[64:67]
    v_mfma_f32_16x16x32_bf16 v[68:71], a[224:227], v[24:27], v[68:71]
    global_load_dwordx4 v[24:27], v0, s[54:55] sc1
    v_add_u32 v0, 1024, v0
    s_waitcnt vmcnt(0)
    v_mfma_f32_16x16x32_bf16 v[60:63], a[100:103], v[24:27], v[60:63]
    v_mfma_f32_16x16x32_bf16 v[64:67], a[164:167], v[24:27], v[64:67]
    v_mfma_f32_16x16x32_bf16 v[68:71], a[228:231], v[24:27], v[68:71]
    global_load_dwordx4 v[24:27], v0, s[54:55] sc1
    v_add_u32 v0, 1024, v0
    s_waitcnt vmcnt(0)
    v_mfma_f32_16x16x32_bf16 v[60:63], a[104:107], v[24:27], v[60:63]
    v_mfma_f32_16x16x32_bf16 v[64:67], a[168:171], v[24:27], v[64:67]
    v_mfma_f32_16x16x32_bf16 v[68:71], a[232:235], v[24:27], v[68:71]
    global_load_dwordx4 v[24:27], v0, s[54:55] sc1
    v_add_u32 v0, 1024, v0
    s_waitcnt vmcnt(0)
    v_mfma_f32_16x16x32_bf16 v[60:63], a[108:111], v[24:27], v[60:63]
    v_mfma_f32_16x16x32_bf16 v[64:67], a[172:175], v[24:27], v[64:67]
    v_mfma_f32_16x16x32_bf16 v[68:71], a[236:239], v[24:27], v[68:71]
    global_load_dwordx4 v[24:27], v0, s[54:55] sc1
    v_add_u32 v0, 1024, v0
    s_waitcnt vmcnt(0)
    v_mfma_f32_16x16x32_bf16 v[60:63], a[112:115], v[24:27], v[60:63]
    v_mfma_f32_16x16x32_bf16 v[64:67], a[176:179], v[24:27], v[64:67]
    v_mfma_f32_16x16x32_bf16 v[68:71], a[240:243], v[24:27], v[68:71]
    global_load_dwordx4 v[24:27], v0, s[54:55] sc1
    v_add_u32 v0, 1024, v0
    s_waitcnt vmcnt(0)
    v_mfma_f32_16x16x32_bf16 v[60:63], a[116:119], v[24:27], v[60:63]
    v_mfma_f32_16x16x32_bf16 v[64:67], a[180:183], v[24:27], v[64:67]
    v_mfma_f32_16x16x32_bf16 v[68:71], a[244:247], v[24:27], v[68:71]
    global_load_dwordx4 v[24:27], v0, s[54:55] sc1
    v_add_u32 v0, 1024, v0
    s_waitcnt vmcnt(0)
    v_mfma_f32_16x16x32_bf16 v[60:63], a[120:123], v[24:27], v[60:63]
    v_mfma_f32_16x16x32_bf16 v[64:67], a[184:187], v[24:27], v[64:67]
    v_mfma_f32_16x16x32_bf16 v[68:71], a[248:251], v[24:27], v[68:71]
    global_load_dwordx4 v[24:27], v0, s[54:55] sc1
    v_add_u32 v0, 1024, v0
    s_waitcnt vmcnt(0)
    v_mfma_f32_16x16x32_bf16 v[60:63], a[124:127], v[24:27], v[60:63]
    v_mfma_f32_16x16x32_bf16 v[64:67], a[188:191], v[24:27], v[64:67]
    v_mfma_f32_16x16x32_bf16 v[68:71], a[252:255], v[24:27], v[68:71]
    s_nop 7
    s_branch k2_L_31B
k2_L_33S:
    v_mov_b32 v0, v4
    s_mov_b32 s17, 16
k2_L_32L:
    global_load_dwordx4 v[24:27], v0, s[54:55] offset:0 sc1
    s_waitcnt vmcnt(0)
    v_max_u32 v24, v24, v26
    v_cmp_eq_u32 vcc, -1, v24
    s_cbranch_vccz k2_L_32N
    s_sub_u32 s67, s67, 1
    s_cbranch_scc0 k2_L_32L
    s_mov_b32 s67, 0
k2_L_32N:
    v_add_u32 v0, 1024, v0
    s_sub_u32 s17, s17, 1
    s_cmp_lg_u32 s17, 0
    s_cbranch_scc1 k2_L_32L
    v_mov_b32 v0, v4
    global_load_dwordx4 v[24:27], v0, s[54:55] sc1
    v_add_u32 v0, 1024, v0
    s_waitcnt vmcnt(0)
    v_mfma_f32_16x16x32_bf16 v[44:47], a[64:67], v[24:27], 0
    v_mfma_f32_16x16x32_bf16 v[48:51], a[128:131], v[24:27], 0
    v_mfma_f32_16x16x32_bf16 v[52:55], a[192:195], v[24:27], 0
    global_load_dwordx4 v[24:27], v0, s[54:55] sc1
    v_add_u32 v0, 1024, v0
    s_waitcnt vmcnt(0)
    v_mfma_f32_16x16x32_bf16 v[44:47], a[68:71], v[24:27], v[44:47]
    v_mfma_f32_16x16x32_bf16 v[48:51], a[132:135], v[24:27], v[48:51]
    v_mfma_f32_16x16x32_bf16 v[52:55], a[196:199], v[24:27], v[52:55]
    global_load_dwordx4 v[24:27], v0, s[54:55] sc1
    v_add_u32 v0, 1024, v0
    s_waitcnt vmcnt(0)
    v_mfma_f32_16x16x32_bf16 v[44:47], a[72:75], v[24:27], v[44:47]
    v_mfma_f32_16x16x32_bf16 v[48:51], a[136:139], v[24:27], v[48:51]
    v_mfma_f32_16x16x32_bf16 v[52:55], a[200:203], v[24:27], v[52:55]
    global_load_dwordx4 v[24:27], v0, s[54:55] sc1
    v_add_u32 v0, 1024, v0
    s_waitcnt vmcnt(0)
    v_mfma_f32_16x16x32_bf16 v[44:47], a[76:79], v[24:27], v[44:47]
    v_mfma_f32_16x16x32_bf16 v[48:51], a[140:143], v[24:27], v[48:51]
    v_mfma_f32_16x16x32_bf16 v[52:55], a[204:207], v[24:27], v[52:55]
    global_load_dwordx4 v[24:27], v0, s[54:55] sc1
    v_add_u32 v0, 1024, v0
    s_waitcnt vmcnt(0)
    v_mfma_f32_16x16x32_bf16 v[44:47], a[80:83], v[24:27], v[44:47]
    v_mfma_f32_16x16x32_bf16 v[48:51], a[144:147], v[24:27], v[48:51]
    v_mfma_f32_16x16x32_bf16 v[52:55], a[208:211], v[24:27], v[52:55]
    global_load_dwordx4 v[24:27], v0, s[54:55] sc1
    v_add_u32 v0, 1024, v0
    s_waitcnt vmcnt(0)
    v_mfma_f32_16x16x32_bf16 v[44:47], a[84:87], v[24:27], v[44:47]
    v_mfma_f32_16x16x32_bf16 v[48:51], a[148:151], v[24:27], v[48:51]
    v_mfma_f32_16x16x32_bf16 v[52:55], a[212:215], v[24:27], v[52:55]
    global_load_dwordx4 v[24:27], v0, s[54:55] sc1
    v_add_u32 v0, 1024, v0
    s_waitcnt vmcnt(0)
    v_mfma_f32_16x16x32_bf16 v[44:47], a[88:91], v[24:27], v[44:47]
    v_mfma_f32_16x16x32_bf16 v[48:51], a[152:155], v[24:27], v[48:51]
    v_mfma_f32_16x16x32_bf16 v[52:55], a[216:219], v[24:27], v[52:55]
    global_load_dwordx4 v[24:27], v0, s[54:55] sc1
    v_add_u32 v0, 1024, v0
    s_waitcnt vmcnt(0)
    v_mfma_f32_16x16x32_bf16 v[44:47], a[92:95], v[24:27], v[44:47]
    v_mfma_f32_16x16x32_bf16 v[48:51], a[156:159], v[24:27], v[48:51]
    v_mfma_f32_16x16x32_bf16 v[52:55], a[220:223], v[24:27], v[52:55]
    global_load_dwordx4 v[24:27], v0, s[54:55] sc1
    v_add_u32 v0, 1024, v0
    s_waitcnt vmcnt(0)
    v_mfma_f32_16x16x32_bf16 v[44:47], a[96:99], v[24:27], v[44:47]
    v_mfma_f32_16x16x32_bf16 v[48:51], a[160:163], v[24:27], v[48:51]
    v_mfma_f32_16x16x32_bf16 v[52:55], a[224:227], v[24:27], v[52:55]
    global_load_dwordx4 v[24:27], v0, s[54:55] sc1
    v_add_u32 v0, 1024, v0
    s_waitcnt vmcnt(0)
    v_mfma_f32_16x16x32_bf16 v[44:47], a[100:103], v[24:27], v[44:47]
    v_mfma_f32_16x16x32_bf16 v[48:51], a[164:167], v[24:27], v[48:51]
    v_mfma_f32_16x16x32_bf16 v[52:55], a[228:231], v[24:27], v[52:55]
    global_load_dwordx4 v[24:27], v0, s[54:55] sc1
    v_add_u32 v0, 1024, v0
    s_waitcnt vmcnt(0)
    v_mfma_f32_16x16x32_bf16 v[44:47], a[104:107], v[24:27], v[44:47]
    v_mfma_f32_16x16x32_bf16 v[48:51], a[168:171], v[24:27], v[48:51]
    v_mfma_f32_16x16x32_bf16 v[52:55], a[232:235], v[24:27], v[52:55]
    global_load_dwordx4 v[24:27], v0, s[54:55] sc1
    v_add_u32 v0, 1024, v0
    s_waitcnt vmcnt(0)
    v_mfma_f32_16x16x32_bf16 v[44:47], a[108:111], v[24:27], v[44:47]
    v_mfma_f32_16x16x32_bf16 v[48:51], a[172:175], v[24:27], v[48:51]
    v_mfma_f32_16x16x32_bf16 v[52:55], a[236:239], v[24:27], v[52:55]
    global_load_dwordx4 v[24:27], v0, s[54:55] sc1
    v_add_u32 v0, 1024, v0
    s_waitcnt vmcnt(0)
    v_mfma_f32_16x16x32_bf16 v[44:47], a[112:115], v[24:27], v[44:47]
    v_mfma_f32_16x16x32_bf16 v[48:51], a[176:179], v[24:27], v[48:51]
    v_mfma_f32_16x16x32_bf16 v[52:55], a[240:243], v[24:27], v[52:55]
    global_load_dwordx4 v[24:27], v0, s[54:55] sc1
    v_add_u32 v0, 1024, v0
    s_waitcnt vmcnt(0)
    v_mfma_f32_16x16x32_bf16 v[44:47], a[116:119], v[24:27], v[44:47]
    v_mfma_f32_16x16x32_bf16 v[48:51], a[180:183], v[24:27], v[48:51]
    v_mfma_f32_16x16x32_bf16 v[52:55], a[244:247], v[24:27], v[52:55]
    global_load_dwordx4 v[24:27], v0, s[54:55] sc1
    v_add_u32 v0, 1024, v0
    s_waitcnt vmcnt(0)
    v_mfma_f32_16x16x32_bf16 v[44:47], a[120:123], v[24:27], v[44:47]
    v_mfma_f32_16x16x32_bf16 v[48:51], a[184:187], v[24:27], v[48:51]
    v_mfma_f32_16x16x32_bf16 v[52:55], a[248:251], v[24:27], v[52:55]
    global_load_dwordx4 v[24:27], v0, s[54:55] sc1
    v_add_u32 v0, 1024, v0
    s_waitcnt vmcnt(0)
    v_mfma_f32_16x16x32_bf16 v[44:47], a[124:127], v[24:27], v[44:47]
    v_mfma_f32_16x16x32_bf16 v[48:51], a[188:191], v[24:27], v[48:51]
    v_mfma_f32_16x16x32_bf16 v[52:55], a[252:255], v[24:27], v[52:55]
    s_nop 7
    s_branch k2_L_33B
k2_L_35S:
    v_mov_b32 v0, v6
    s_mov_b32 s17, 16
k2_L_34L:
    global_load_dwordx4 v[24:27], v0, s[54:55] offset:0 sc1
    s_waitcnt vmcnt(0)
    v_max_u32 v24, v24, v26
    v_cmp_eq_u32 vcc, -1, v24
    s_cbranch_vccz k2_L_34N
    s_sub_u32 s67, s67, 1
    s_cbranch_scc0 k2_L_34L
    s_mov_b32 s67, 0
k2_L_34N:
    v_add_u32 v0, 1024, v0
    s_sub_u32 s17, s17, 1
    s_cmp_lg_u32 s17, 0
    s_cbranch_scc1 k2_L_34L
    v_mov_b32 v0, v6
    global_load_dwordx4 v[24:27], v0, s[54:55] sc1
    v_add_u32 v0, 1024, v0
    global_load_dwordx4 v[84:87], v2, s[58:59] offset:-4096
    global_load_dwordx4 v[88:91], v2, s[60:61] offset:-4096
    global_load_dwordx4 v[92:95], v2, s[62:63] offset:-4096
    s_waitcnt vmcnt(0)
    v_mfma_f32_16x16x32_bf16 v[72:75], v[84:87], v[24:27], 0
    v_mfma_f32_16x16x32_bf16 v[76:79], v[88:91], v[24:27], 0
    v_mfma_f32_16x16x32_bf16 v[80:83], v[92:95], v[24:27], 0
    global_load_dwordx4 v[24:27], v0, s[54:55] sc1
    v_add_u32 v0, 1024, v0
    global_load_dwordx4 v[84:87], v2, s[58:59] offset:-3072
    global_load_dwordx4 v[88:91], v2, s[60:61] offset:-3072
    global_load_dwordx4 v[92:95], v2, s[62:63] offset:-3072
    s_waitcnt vmcnt(0)
    v_mfma_f32_16x16x32_bf16 v[72:75], v[84:87], v[24:27], v[72:75]
    v_mfma_f32_16x16x32_bf16 v[76:79], v[88:91], v[24:27], v[76:79]
    v_mfma_f32_16x16x32_bf16 v[80:83], v[92:95], v[24:27], v[80:83]
    global_load_dwordx4 v[24:27], v0, s[54:55] sc1
    v_add_u32 v0, 1024, v0
    global_load_dwordx4 v[84:87], v2, s[58:59] offset:-2048
    global_load_dwordx4 v[88:91], v2, s[60:61] offset:-2048
    global_load_dwordx4 v[92:95], v2, s[62:63] offset:-2048
    s_waitcnt vmcnt(0)
    v_mfma_f32_16x16x32_bf16 v[72:75], v[84:87], v[24:27], v[72:75]
    v_mfma_f32_16x16x32_bf16 v[76:79], v[88:91], v[24:27], v[76:79]
    v_mfma_f32_16x16x32_bf16 v[80:83], v[92:95], v[24:27], v[80:83]
    global_load_dwordx4 v[24:27], v0, s[54:55] sc1
    v_add_u32 v0, 1024, v0
    global_load_dwordx4 v[84:87], v2, s[58:59] offset:-1024
    global_load_dwordx4 v[88:91], v2, s[60:61] offset:-1024
    global_load_dwordx4 v[92:95], v2, s[62:63] offset:-1024
    s_waitcnt vmcnt(0)
    v_mfma_f32_16x16x32_bf16 v[72:75], v[84:87], v[24:27], v[72:75]
    v_mfma_f32_16x16x32_bf16 v[76:79], v[88:91], v[24:27], v[76:79]
    v_mfma_f32_16x16x32_bf16 v[80:83], v[92:95], v[24:27], v[80:83]
    global_load_dwordx4 v[24:27], v0, s[54:55] sc1
    v_add_u32 v0, 1024, v0
    global_load_dwordx4 v[84:87], v2, s[58:59] offset:0
    global_load_dwordx4 v[88:91], v2, s[60:61] offset:0
    global_load_dwordx4 v[92:95], v2, s[62:63] offset:0
    s_waitcnt vmcnt(0)
    v_mfma_f32_16x16x32_bf16 v[72:75], v[84:87], v[24:27], v[72:75]
    v_mfma_f32_16x16x32_bf16 v[76:79], v[88:91], v[24:27], v[76:79]
    v_mfma_f32_16x16x32_bf16 v[80:83], v[92:95], v[24:27], v[80:83]
    global_load_dwordx4 v[24:27], v0, s[54:55] sc1
    v_add_u32 v0, 1024, v0
    global_load_dwordx4 v[84:87], v2, s[58:59] offset:1024
    global_load_dwordx4 v[88:91], v2, s[60:61] offset:1024
    global_load_dwordx4 v[92:95], v2, s[62:63] offset:1024
    s_waitcnt vmcnt(0)
    v_mfma_f32_16x16x32_bf16 v[72:75], v[84:87], v[24:27], v[72:75]
    v_mfma_f32_16x16x32_bf16 v[76:79], v[88:91], v[24:27], v[76:79]
    v_mfma_f32_16x16x32_bf16 v[80:83], v[92:95], v[24:27], v[80:83]
    global_load_dwordx4 v[24:27], v0, s[54:55] sc1
    v_add_u32 v0, 1024, v0
    global_load_dwordx4 v[84:87], v2, s[58:59] offset:2048
    global_load_dwordx4 v[88:91], v2, s[60:61] offset:2048
    global_load_dwordx4 v[92:95], v2, s[62:63] offset:2048
    s_waitcnt vmcnt(0)
    v_mfma_f32_16x16x32_bf16 v[72:75], v[84:87], v[24:27], v[72:75]
    v_mfma_f32_16x16x32_bf16 v[76:79], v[88:91], v[24:27], v[76:79]
    v_mfma_f32_16x16x32_bf16 v[80:83], v[92:95], v[24:27], v[80:83]
    global_load_dwordx4 v[24:27], v0, s[54:55] sc1
    v_add_u32 v0, 1024, v0
    global_load_dwordx4 v[84:87], v2, s[58:59] offset:3072
    global_load_dwordx4 v[88:91], v2, s[60:61] offset:3072
    global_load_dwordx4 v[92:95], v2, s[62:63] offset:3072
    s_waitcnt vmcnt(0)
    v_mfma_f32_16x16x32_bf16 v[72:75], v[84:87], v[24:27], v[72:75]
    v_mfma_f32_16x16x32_bf16 v[76:79], v[88:91], v[24:27], v[76:79]
    v_mfma_f32_16x16x32_bf16 v[80:83], v[92:95], v[24:27], v[80:83]
    global_load_dwordx4 v[24:27], v0, s[54:55] sc1
    v_add_u32 v0, 1024, v0
    global_load_dwordx4 v[84:87], v3, s[58:59] offset:-4096
    global_load_dwordx4 v[88:91], v3, s[60:61] offset:-4096
    global_load_dwordx4 v[92:95], v3, s[62:63] offset:-4096
    s_waitcnt vmcnt(0)
    v_mfma_f32_16x16x32_bf16 v[72:75], v[84:87], v[24:27], v[72:75]
    v_mfma_f32_16x16x32_bf16 v[76:79], v[88:91], v[24:27], v[76:79]
    v_mfma_f32_16x16x32_bf16 v[80:83], v[92:95], v[24:27], v[80:83]
    global_load_dwordx4 v[24:27], v0, s[54:55] sc1
    v_add_u32 v0, 1024, v0
    global_load_dwordx4 v[84:87], v3, s[58:59] offset:-3072
    global_load_dwordx4 v[88:91], v3, s[60:61] offset:-3072
    global_load_dwordx4 v[92:95], v3, s[62:63] offset:-3072
    s_waitcnt vmcnt(0)
    v_mfma_f32_16x16x32_bf16 v[72:75], v[84:87], v[24:27], v[72:75]
    v_mfma_f32_16x16x32_bf16 v[76:79], v[88:91], v[24:27], v[76:79]
    v_mfma_f32_16x16x32_bf16 v[80:83], v[92:95], v[24:27], v[80:83]
    global_load_dwordx4 v[24:27], v0, s[54:55] sc1
    v_add_u32 v0, 1024, v0
    global_load_dwordx4 v[84:87], v3, s[58:59] offset:-2048
    global_load_dwordx4 v[88:91], v3, s[60:61] offset:-2048
    global_load_dwordx4 v[92:95], v3, s[62:63] offset:-2048
    s_waitcnt vmcnt(0)
    v_mfma_f32_16x16x32_bf16 v[72:75], v[84:87], v[24:27], v[72:75]
    v_mfma_f32_16x16x32_bf16 v[76:79], v[88:91], v[24:27], v[76:79]
    v_mfma_f32_16x16x32_bf16 v[80:83], v[92:95], v[24:27], v[80:83]
    global_load_dwordx4 v[24:27], v0, s[54:55] sc1
    v_add_u32 v0, 1024, v0
    global_load_dwordx4 v[84:87], v3, s[58:59] offset:-1024
    global_load_dwordx4 v[88:91], v3, s[60:61] offset:-1024
    global_load_dwordx4 v[92:95], v3, s[62:63] offset:-1024
    s_waitcnt vmcnt(0)
    v_mfma_f32_16x16x32_bf16 v[72:75], v[84:87], v[24:27], v[72:75]
    v_mfma_f32_16x16x32_bf16 v[76:79], v[88:91], v[24:27], v[76:79]
    v_mfma_f32_16x16x32_bf16 v[80:83], v[92:95], v[24:27], v[80:83]
    global_load_dwordx4 v[24:27], v0, s[54:55] sc1
    v_add_u32 v0, 1024, v0
    global_load_dwordx4 v[84:87], v3, s[58:59] offset:0
    global_load_dwordx4 v[88:91], v3, s[60:61] offset:0
    global_load_dwordx4 v[92:95], v3, s[62:63] offset:0
    s_waitcnt vmcnt(0)
    v_mfma_f32_16x16x32_bf16 v[72:75], v[84:87], v[24:27], v[72:75]
    v_mfma_f32_16x16x32_bf16 v[76:79], v[88:91], v[24:27], v[76:79]
    v_mfma_f32_16x16x32_bf16 v[80:83], v[92:95], v[24:27], v[80:83]
    global_load_dwordx4 v[24:27], v0, s[54:55] sc1
    v_add_u32 v0, 1024, v0
    global_load_dwordx4 v[84:87], v3, s[58:59] offset:1024
    global_load_dwordx4 v[88:91], v3, s[60:61] offset:1024
    global_load_dwordx4 v[92:95], v3, s[62:63] offset:1024
    s_waitcnt vmcnt(0)
    v_mfma_f32_16x16x32_bf16 v[72:75], v[84:87], v[24:27], v[72:75]
    v_mfma_f32_16x16x32_bf16 v[76:79], v[88:91], v[24:27], v[76:79]
    v_mfma_f32_16x16x32_bf16 v[80:83], v[92:95], v[24:27], v[80:83]
    global_load_dwordx4 v[24:27], v0, s[54:55] sc1
    v_add_u32 v0, 1024, v0
    global_load_dwordx4 v[84:87], v3, s[58:59] offset:2048
    global_load_dwordx4 v[88:91], v3, s[60:61] offset:2048
    global_load_dwordx4 v[92:95], v3, s[62:63] offset:2048
    s_waitcnt vmcnt(0)
    v_mfma_f32_16x16x32_bf16 v[72:75], v[84:87], v[24:27], v[72:75]
    v_mfma_f32_16x16x32_bf16 v[76:79], v[88:91], v[24:27], v[76:79]
    v_mfma_f32_16x16x32_bf16 v[80:83], v[92:95], v[24:27], v[80:83]
    global_load_dwordx4 v[24:27], v0, s[54:55] sc1
    v_add_u32 v0, 1024, v0
    global_load_dwordx4 v[84:87], v3, s[58:59] offset:3072
    global_load_dwordx4 v[88:91], v3, s[60:61] offset:3072
    global_load_dwordx4 v[92:95], v3, s[62:63] offset:3072
    s_waitcnt vmcnt(0)
    v_mfma_f32_16x16x32_bf16 v[72:75], v[84:87], v[24:27], v[72:75]
    v_mfma_f32_16x16x32_bf16 v[76:79], v[88:91], v[24:27], v[76:79]
    v_mfma_f32_16x16x32_bf16 v[80:83], v[92:95], v[24:27], v[80:83]
    s_nop 7
    s_branch k2_L_35B
k2_L_37S:
    v_mov_b32 v0, v8
    s_mov_b32 s17, 16
k2_L_36L:
    global_load_dwordx4 v[24:27], v0, s[54:55] offset:0 sc1
    s_waitcnt vmcnt(0)
    v_max_u32 v24, v24, v26
    v_cmp_eq_u32 vcc, -1, v24
    s_cbranch_vccz k2_L_36N
    s_sub_u32 s67, s67, 1
    s_cbranch_scc0 k2_L_36L
    s_mov_b32 s67, 0
k2_L_36N:
    v_add_u32 v0, 1024, v0
    s_sub_u32 s17, s17, 1
    s_cmp_lg_u32 s17, 0
    s_cbranch_scc1 k2_L_36L
    v_mov_b32 v0, v8
    global_load_dwordx4 v[24:27], v0, s[54:55] sc1
    v_add_u32 v0, 1024, v0
    global_load_dwordx4 v[84:87], v2, s[58:59] offset:-4096
    global_load_dwordx4 v[88:91], v2, s[60:61] offset:-4096
    global_load_dwordx4 v[92:95], v2, s[62:63] offset:-4096
    s_waitcnt vmcnt(0)
    v_mfma_f32_16x16x32_bf16 v[60:63], v[84:87], v[24:27], 0
    v_mfma_f32_16x16x32_bf16 v[64:67], v[88:91], v[24:27], 0
    v_mfma_f32_16x16x32_bf16 v[68:71], v[92:95], v[24:27], 0
    global_load_dwordx4 v[24:27], v0, s[54:55] sc1
    v_add_u32 v0, 1024, v0
    global_load_dwordx4 v[84:87], v2, s[58:59] offset:-3072
    global_load_dwordx4 v[88:91], v2, s[60:61] offset:-3072
    global_load_dwordx4 v[92:95], v2, s[62:63] offset:-3072
    s_waitcnt vmcnt(0)
    v_mfma_f32_16x16x32_bf16 v[60:63], v[84:87], v[24:27], v[60:63]
    v_mfma_f32_16x16x32_bf16 v[64:67], v[88:91], v[24:27], v[64:67]
    v_mfma_f32_16x16x32_bf16 v[68:71], v[92:95], v[24:27], v[68:71]
    global_load_dwordx4 v[24:27], v0, s[54:55] sc1
    v_add_u32 v0, 1024, v0
    global_load_dwordx4 v[84:87], v2, s[58:59] offset:-2048
    global_load_dwordx4 v[88:91], v2, s[60:61] offset:-2048
    global_load_dwordx4 v[92:95], v2, s[62:63] offset:-2048
    s_waitcnt vmcnt(0)
    v_mfma_f32_16x16x32_bf16 v[60:63], v[84:87], v[24:27], v[60:63]
    v_mfma_f32_16x16x32_bf16 v[64:67], v[88:91], v[24:27], v[64:67]
    v_mfma_f32_16x16x32_bf16 v[68:71], v[92:95], v[24:27], v[68:71]
    global_load_dwordx4 v[24:27], v0, s[54:55] sc1
    v_add_u32 v0, 1024, v0
    global_load_dwordx4 v[84:87], v2, s[58:59] offset:-1024
    global_load_dwordx4 v[88:91], v2, s[60:61] offset:-1024
    global_load_dwordx4 v[92:95], v2, s[62:63] offset:-1024
    s_waitcnt vmcnt(0)
    v_mfma_f32_16x16x32_bf16 v[60:63], v[84:87], v[24:27], v[60:63]
    v_mfma_f32_16x16x32_bf16 v[64:67], v[88:91], v[24:27], v[64:67]
    v_mfma_f32_16x16x32_bf16 v[68:71], v[92:95], v[24:27], v[68:71]
    global_load_dwordx4 v[24:27], v0, s[54:55] sc1
    v_add_u32 v0, 1024, v0
    global_load_dwordx4 v[84:87], v2, s[58:59] offset:0
    global_load_dwordx4 v[88:91], v2, s[60:61] offset:0
    global_load_dwordx4 v[92:95], v2, s[62:63] offset:0
    s_waitcnt vmcnt(0)
    v_mfma_f32_16x16x32_bf16 v[60:63], v[84:87], v[24:27], v[60:63]
    v_mfma_f32_16x16x32_bf16 v[64:67], v[88:91], v[24:27], v[64:67]
    v_mfma_f32_16x16x32_bf16 v[68:71], v[92:95], v[24:27], v[68:71]
    global_load_dwordx4 v[24:27], v0, s[54:55] sc1
    v_add_u32 v0, 1024, v0
    global_load_dwordx4 v[84:87], v2, s[58:59] offset:1024
    global_load_dwordx4 v[88:91], v2, s[60:61] offset:1024
    global_load_dwordx4 v[92:95], v2, s[62:63] offset:1024
    s_waitcnt vmcnt(0)
    v_mfma_f32_16x16x32_bf16 v[60:63], v[84:87], v[24:27], v[60:63]
    v_mfma_f32_16x16x32_bf16 v[64:67], v[88:91], v[24:27], v[64:67]
    v_mfma_f32_16x16x32_bf16 v[68:71], v[92:95], v[24:27], v[68:71]
    global_load_dwordx4 v[24:27], v0, s[54:55] sc1
    v_add_u32 v0, 1024, v0
    global_load_dwordx4 v[84:87], v2, s[58:59] offset:2048
    global_load_dwordx4 v[88:91], v2, s[60:61] offset:2048
    global_load_dwordx4 v[92:95], v2, s[62:63] offset:2048
    s_waitcnt vmcnt(0)
    v_mfma_f32_16x16x32_bf16 v[60:63], v[84:87], v[24:27], v[60:63]
    v_mfma_f32_16x16x32_bf16 v[64:67], v[88:91], v[24:27], v[64:67]
    v_mfma_f32_16x16x32_bf16 v[68:71], v[92:95], v[24:27], v[68:71]
    global_load_dwordx4 v[24:27], v0, s[54:55] sc1
    v_add_u32 v0, 1024, v0
    global_load_dwordx4 v[84:87], v2, s[58:59] offset:3072
    global_load_dwordx4 v[88:91], v2, s[60:61] offset:3072
    global_load_dwordx4 v[92:95], v2, s[62:63] offset:3072
    s_waitcnt vmcnt(0)
    v_mfma_f32_16x16x32_bf16 v[60:63], v[84:87], v[24:27], v[60:63]
    v_mfma_f32_16x16x32_bf16 v[64:67], v[88:91], v[24:27], v[64:67]
    v_mfma_f32_16x16x32_bf16 v[68:71], v[92:95], v[24:27], v[68:71]
    global_load_dwordx4 v[24:27], v0, s[54:55] sc1
    v_add_u32 v0, 1024, v0
    global_load_dwordx4 v[84:87], v3, s[58:59] offset:-4096
    global_load_dwordx4 v[88:91], v3, s[60:61] offset:-4096
    global_load_dwordx4 v[92:95], v3, s[62:63] offset:-4096
    s_waitcnt vmcnt(0)
    v_mfma_f32_16x16x32_bf16 v[60:63], v[84:87], v[24:27], v[60:63]
    v_mfma_f32_16x16x32_bf16 v[64:67], v[88:91], v[24:27], v[64:67]
    v_mfma_f32_16x16x32_bf16 v[68:71], v[92:95], v[24:27], v[68:71]
    global_load_dwordx4 v[24:27], v0, s[54:55] sc1
    v_add_u32 v0, 1024, v0
    global_load_dwordx4 v[84:87], v3, s[58:59] offset:-3072
    global_load_dwordx4 v[88:91], v3, s[60:61] offset:-3072
    global_load_dwordx4 v[92:95], v3, s[62:63] offset:-3072
    s_waitcnt vmcnt(0)
    v_mfma_f32_16x16x32_bf16 v[60:63], v[84:87], v[24:27], v[60:63]
    v_mfma_f32_16x16x32_bf16 v[64:67], v[88:91], v[24:27], v[64:67]
    v_mfma_f32_16x16x32_bf16 v[68:71], v[92:95], v[24:27], v[68:71]
    global_load_dwordx4 v[24:27], v0, s[54:55] sc1
    v_add_u32 v0, 1024, v0
    global_load_dwordx4 v[84:87], v3, s[58:59] offset:-2048
    global_load_dwordx4 v[88:91], v3, s[60:61] offset:-2048
    global_load_dwordx4 v[92:95], v3, s[62:63] offset:-2048
    s_waitcnt vmcnt(0)
    v_mfma_f32_16x16x32_bf16 v[60:63], v[84:87], v[24:27], v[60:63]
    v_mfma_f32_16x16x32_bf16 v[64:67], v[88:91], v[24:27], v[64:67]
    v_mfma_f32_16x16x32_bf16 v[68:71], v[92:95], v[24:27], v[68:71]
    global_load_dwordx4 v[24:27], v0, s[54:55] sc1
    v_add_u32 v0, 1024, v0
    global_load_dwordx4 v[84:87], v3, s[58:59] offset:-1024
    global_load_dwordx4 v[88:91], v3, s[60:61] offset:-1024
    global_load_dwordx4 v[92:95], v3, s[62:63] offset:-1024
    s_waitcnt vmcnt(0)
    v_mfma_f32_16x16x32_bf16 v[60:63], v[84:87], v[24:27], v[60:63]
    v_mfma_f32_16x16x32_bf16 v[64:67], v[88:91], v[24:27], v[64:67]
    v_mfma_f32_16x16x32_bf16 v[68:71], v[92:95], v[24:27], v[68:71]
    global_load_dwordx4 v[24:27], v0, s[54:55] sc1
    v_add_u32 v0, 1024, v0
    global_load_dwordx4 v[84:87], v3, s[58:59] offset:0
    global_load_dwordx4 v[88:91], v3, s[60:61] offset:0
    global_load_dwordx4 v[92:95], v3, s[62:63] offset:0
    s_waitcnt vmcnt(0)
    v_mfma_f32_16x16x32_bf16 v[60:63], v[84:87], v[24:27], v[60:63]
    v_mfma_f32_16x16x32_bf16 v[64:67], v[88:91], v[24:27], v[64:67]
    v_mfma_f32_16x16x32_bf16 v[68:71], v[92:95], v[24:27], v[68:71]
    global_load_dwordx4 v[24:27], v0, s[54:55] sc1
    v_add_u32 v0, 1024, v0
    global_load_dwordx4 v[84:87], v3, s[58:59] offset:1024
    global_load_dwordx4 v[88:91], v3, s[60:61] offset:1024
    global_load_dwordx4 v[92:95], v3, s[62:63] offset:1024
    s_waitcnt vmcnt(0)
    v_mfma_f32_16x16x32_bf16 v[60:63], v[84:87], v[24:27], v[60:63]
    v_mfma_f32_16x16x32_bf16 v[64:67], v[88:91], v[24:27], v[64:67]
    v_mfma_f32_16x16x32_bf16 v[68:71], v[92:95], v[24:27], v[68:71]
    global_load_dwordx4 v[24:27], v0, s[54:55] sc1
    v_add_u32 v0, 1024, v0
    global_load_dwordx4 v[84:87], v3, s[58:59] offset:2048
    global_load_dwordx4 v[88:91], v3, s[60:61] offset:2048
    global_load_dwordx4 v[92:95], v3, s[62:63] offset:2048
    s_waitcnt vmcnt(0)
    v_mfma_f32_16x16x32_bf16 v[60:63], v[84:87], v[24:27], v[60:63]
    v_mfma_f32_16x16x32_bf16 v[64:67], v[88:91], v[24:27], v[64:67]
    v_mfma_f32_16x16x32_bf16 v[68:71], v[92:95], v[24:27], v[68:71]
    global_load_dwordx4 v[24:27], v0, s[54:55] sc1
    v_add_u32 v0, 1024, v0
    global_load_dwordx4 v[84:87], v3, s[58:59] offset:3072
    global_load_dwordx4 v[88:91], v3, s[60:61] offset:3072
    global_load_dwordx4 v[92:95], v3, s[62:63] offset:3072
    s_waitcnt vmcnt(0)
    v_mfma_f32_16x16x32_bf16 v[60:63], v[84:87], v[24:27], v[60:63]
    v_mfma_f32_16x16x32_bf16 v[64:67], v[88:91], v[24:27], v[64:67]
    v_mfma_f32_16x16x32_bf16 v[68:71], v[92:95], v[24:27], v[68:71]
    s_nop 7
    s_branch k2_L_37B
k2_L_39S:
k2_L_38L:
    v_bfe_u32 v0, v2, 4, 4
    v_min_u32 v0, s31, v0
    v_lshlrev_b32 v0, 12, v0
    v_and_b32 v24, 0x300, v2
    v_add_u32 v0, v0, v24
    global_load_dwordx3 v[24:26], v0, s[52:53] offset:-3968 sc1
    s_sub_u32 s67, s67, 1
    s_cbranch_scc1 k2_L_38X
    s_waitcnt vmcnt(0)
    v_max_u32 v24, v24, v26
    v_cmp_eq_u32 vcc, -1, v24
    s_cbranch_vccnz k2_L_38L
    s_branch k2_L_38Y
k2_L_38X:
    s_mov_b32 s67, 0
k2_L_38Y:
    global_load_dwordx4 a[64:67], v2, s[52:53] offset:-4096 sc1
    global_load_dwordx4 a[128:131], v2, s[52:53] offset:0 sc1
    global_load_dwordx4 a[192:195], v3, s[52:53] offset:-4096 sc1
    global_load_dwordx4 a[68:71], v3, s[52:53] offset:0 sc1
    global_load_dwordx4 a[132:135], v4, s[52:53] offset:-4096 sc1
    global_load_dwordx4 a[196:199], v4, s[52:53] offset:0 sc1
    global_load_dwordx4 a[72:75], v5, s[52:53] offset:-4096 sc1
    global_load_dwordx4 a[136:139], v5, s[52:53] offset:0 sc1
    global_load_dwordx4 a[200:203], v6, s[52:53] offset:-4096 sc1
    global_load_dwordx4 a[76:79], v6, s[52:53] offset:0 sc1
    global_load_dwordx4 a[140:143], v7, s[94:95] offset:-4096 sc1
    s_waitcnt vmcnt(0)
    s_branch k2_L_39B
k2_L_41S:
k2_L_40L:
    v_bfe_u32 v0, v2, 4, 4
    v_min_u32 v0, s31, v0
    v_lshlrev_b32 v0, 12, v0
    v_and_b32 v24, 0x300, v2
    v_add_u32 v0, v0, v24
    global_load_dwordx3 v[24:26], v0, s[52:53] offset:-2944 sc1
    s_sub_u32 s67, s67, 1
    s_cbranch_scc1 k2_L_40X
    s_waitcnt vmcnt(0)
    v_max_u32 v24, v24, v26
    v_cmp_eq_u32 vcc, -1, v24
    s_cbranch_vccnz k2_L_40L
    s_branch k2_L_40Y
k2_L_40X:
    s_mov_b32 s67, 0
k2_L_40Y:
    global_load_dwordx4 a[204:207], v2, s[52:53] offset:-3072 sc1
    global_load_dwordx4 a[80:83], v2, s[52:53] offset:1024 sc1
    global_load_dwordx4 a[144:147], v3, s[52:53] offset:-3072 sc1
    global_load_dwordx4 a[208:211], v3, s[52:53] offset:1024 sc1
    global_load_dwordx4 a[84:87], v4, s[52:53] offset:-3072 sc1
    global_load_dwordx4 a[148:151], v4, s[52:53] offset:1024 sc1
    global_load_dwordx4 a[212:215], v5, s[52:53] offset:-3072 sc1
    global_load_dwordx4 a[88:91], v5, s[52:53] offset:1024 sc1
    global_load_dwordx4 a[152:155], v6, s[52:53] offset:-3072 sc1
    global_load_dwordx4 a[216:219], v6, s[52:53] offset:1024 sc1
    global_load_dwordx4 a[92:95], v7, s[94:95] offset:-3072 sc1
    s_waitcnt vmcnt(0)
    s_branch k2_L_41B
k2_L_43S:
k2_L_42L:
    v_bfe_u32 v0, v2, 4, 4
    v_min_u32 v0, s31, v0
    v_lshlrev_b32 v0, 12, v0
    v_and_b32 v24, 0x300, v2
    v_add_u32 v0, v0, v24
    global_load_dwordx3 v[24:26], v0, s[52:53] offset:-1920 sc1
    s_sub_u32 s67, s67, 1
    s_cbranch_scc1 k2_L_42X
    s_waitcnt vmcnt(0)
    v_max_u32 v24, v24, v26
    v_cmp_eq_u32 vcc, -1, v24
    s_cbranch_vccnz k2_L_42L
    s_branch k2_L_42Y
k2_L_42X:
    s_mov_b32 s67, 0
k2_L_42Y:
    global_load_dwordx4 a[156:159], v2, s[52:53] offset:-2048 sc1
    global_load_dwordx4 a[220:223], v2, s[52:53] offset:2048 sc1
    global_load_dwordx4 a[96:99], v3, s[52:53] offset:-2048 sc1
    global_load_dwordx4 a[160:163], v3, s[52:53] offset:2048 sc1
    global_load_dwordx4 a[224:227], v4, s[52:53] offset:-2048 sc1
    global_load_dwordx4 a[100:103], v4, s[52:53] offset:2048 sc1
    global_load_dwordx4 a[164:167], v5, s[52:53] offset:-2048 sc1
    global_load_dwordx4 a[228:231], v5, s[52:53] offset:2048 sc1
    global_load_dwordx4 a[104:107], v6, s[52:53] offset:-2048 sc1
    global_load_dwordx4 a[168:171], v6, s[52:53] offset:2048 sc1
    global_load_dwordx4 a[232:235], v7, s[94:95] offset:-2048 sc1
    s_waitcnt vmcnt(0)
    s_branch k2_L_43B
k2_L_45S:
k2_L_44L:
    v_bfe_u32 v0, v2, 4, 4
    v_min_u32 v0, s31, v0
    v_lshlrev_b32 v0, 12, v0
    v_and_b32 v24, 0x300, v2
    v_add_u32 v0, v0, v24
    global_load_dwordx3 v[24:26], v0, s[52:53] offset:-896 sc1
    s_sub_u32 s67, s67, 1
    s_cbranch_scc1 k2_L_44X
    s_waitcnt vmcnt(0)
    v_max_u32 v24, v24, v26
    v_cmp_eq_u32 vcc, -1, v24
    s_cbranch_vccnz k2_L_44L
    s_branch k2_L_44Y
k2_L_44X:
    s_mov_b32 s67, 0
k2_L_44Y:
    global_load_dwordx4 a[108:111], v2, s[52:53] offset:-1024 sc1
    global_load_dwordx4 a[172:175], v2, s[52:53] offset:3072 sc1
    global_load_dwordx4 a[236:239], v3, s[52:53] offset:-1024 sc1
    global_load_dwordx4 a[112:115], v3, s[52:53] offset:3072 sc1
    global_load_dwordx4 a[176:179], v4, s[52:53] offset:-1024 sc1
    global_load_dwordx4 a[240:243], v4, s[52:53] offset:3072 sc1
    global_load_dwordx4 a[116:119], v5, s[52:53] offset:-1024 sc1
    global_load_dwordx4 a[180:183], v5, s[52:53] offset:3072 sc1
    global_load_dwordx4 a[244:247], v6, s[52:53] offset:-1024 sc1
    global_load_dwordx4 a[120:123], v6, s[52:53] offset:3072 sc1
    global_load_dwordx4 a[184:187], v7, s[94:95] offset:-1024 sc1
    s_waitcnt vmcnt(0)
    s_branch k2_L_45B
k2_L_47S:
k2_L_46L:
    global_load_dwordx4 v[60:63], v2, s[52:53] offset:-4096 sc1
    global_load_dwordx4 v[64:67], v2, s[52:53] offset:0 sc1
    global_load_dwordx4 v[68:71], v3, s[52:53] offset:-4096 sc1
    global_load_dwordx4 v[72:75], v3, s[52:53] offset:0 sc1
    global_load_dwordx4 v[76:79], v4, s[52:53] offset:-4096 sc1
    global_load_dwordx4 v[80:83], v4, s[52:53] offset:0 sc1
    global_load_dwordx4 v[84:87], v5, s[52:53] offset:-4096 sc1
    global_load_dwordx4 v[88:91], v5, s[52:53] offset:0 sc1
    global_load_dwordx4 v[92:95], v6, s[52:53] offset:-4096 sc1
    global_load_dwordx4 v[104:107], v6, s[52:53] offset:0 sc1
    global_load_dwordx4 v[108:111], v7, s[94:95] offset:-4096 sc1
    s_sub_u32 s67, s67, 1
    s_cbranch_scc1 k2_L_46X
    s_waitcnt vmcnt(0)
    v_max3_u32 v0, v60, v62, v64
    v_max3_u32 v0, v0, v66, v68
    v_max3_u32 v0, v0, v70, v72
    v_max3_u32 v0, v0, v74, v76
    v_max3_u32 v0, v0, v78, v80
    v_max3_u32 v0, v0, v82, v84
    v_max3_u32 v0, v0, v86, v88
    v_max3_u32 v0, v0, v90, v92
    v_max3_u32 v0, v0, v94, v104
    v_max3_u32 v0, v0, v106, v108
    v_max_u32 v0, v0, v110
    v_cmp_eq_u32 vcc, -1, v0
    s_cbranch_vccnz k2_L_46L
    s_branch k2_L_46Y
k2_L_46X:
    s_mov_b32 s67, 0
k2_L_46Y:
    s_waitcnt vmcnt(0)
    s_waitcnt lgkmcnt(0)
    v_mfma_f32_16x16x32_bf16 v[28:31], v[144:147], v[60:63], v[128:131]
    v_mfma_f32_16x16x32_bf16 v[32:35], v[148:151], v[60:63], 0
    v_mfma_f32_16x16x32_bf16 v[36:39], v[152:155], v[60:63], 0
    v_mfma_f32_16x16x32_bf16 v[40:43], v[156:159], v[60:63], 0
    v_mfma_f32_16x16x32_bf16 v[28:31], v[160:163], v[64:67], v[28:31]
    v_mfma_f32_16x16x32_bf16 v[32:35], v[164:167], v[64:67], v[32:35]
    v_mfma_f32_16x16x32_bf16 v[36:39], v[168:171], v[64:67], v[36:39]
    v_mfma_f32_16x16x32_bf16 v[40:43], v[172:175], v[64:67], v[40:43]
    v_mfma_f32_16x16x32_bf16 v[28:31], v[176:179], v[68:71], v[28:31]
    v_mfma_f32_16x16x32_bf16 v[32:35], v[180:183], v[68:71], v[32:35]
    v_mfma_f32_16x16x32_bf16 v[36:39], v[184:187], v[68:71], v[36:39]
    v_mfma_f32_16x16x32_bf16 v[40:43], v[188:191], v[68:71], v[40:43]
    v_mfma_f32_16x16x32_bf16 v[28:31], v[192:195], v[72:75], v[28:31]
    v_mfma_f32_16x16x32_bf16 v[32:35], v[196:199], v[72:75], v[32:35]
    v_mfma_f32_16x16x32_bf16 v[36:39], v[200:203], v[72:75], v[36:39]
    v_mfma_f32_16x16x32_bf16 v[40:43], v[204:207], v[72:75], v[40:43]
    v_mfma_f32_16x16x32_bf16 v[28:31], v[208:211], v[76:79], v[28:31]
    v_mfma_f32_16x16x32_bf16 v[32:35], v[212:215], v[76:79], v[32:35]
    v_mfma_f32_16x16x32_bf16 v[36:39], v[216:219], v[76:79], v[36:39]
    v_mfma_f32_16x16x32_bf16 v[40:43], v[220:223], v[76:79], v[40:43]
    v_mfma_f32_16x16x32_bf16 v[28:31], v[224:227], v[80:83], v[28:31]
    v_mfma_f32_16x16x32_bf16 v[32:35], v[228:231], v[80:83], v[32:35]
    v_mfma_f32_16x16x32_bf16 v[36:39], v[232:235], v[80:83], v[36:39]
    v_mfma_f32_16x16x32_bf16 v[40:43], v[236:239], v[80:83], v[40:43]
    v_mfma_f32_16x16x32_bf16 v[28:31], v[240:243], v[84:87], v[28:31]
    v_mfma_f32_16x16x32_bf16 v[32:35], v[112:115], v[84:87], v[32:35]
    v_mfma_f32_16x16x32_bf16 v[36:39], v[116:119], v[84:87], v[36:39]
    v_mfma_f32_16x16x32_bf16 v[40:43], v[120:123], v[84:87], v[40:43]
    v_mfma_f32_16x16x32_bf16 v[28:31], a[0:3], v[88:91], v[28:31]
    v_mfma_f32_16x16x32_bf16 v[32:35], a[4:7], v[88:91], v[32:35]
    v_mfma_f32_16x16x32_bf16 v[36:39], a[8:11], v[88:91], v[36:39]
    v_mfma_f32_16x16x32_bf16 v[40:43], a[12:15], v[88:91], v[40:43]
    v_mfma_f32_16x16x32_bf16 v[28:31], a[16:19], v[92:95], v[28:31]
    v_mfma_f32_16x16x32_bf16 v[32:35], a[20:23], v[92:95], v[32:35]
    v_mfma_f32_16x16x32_bf16 v[36:39], a[24:27], v[92:95], v[36:39]
    v_mfma_f32_16x16x32_bf16 v[40:43], a[28:31], v[92:95], v[40:43]
    v_mfma_f32_16x16x32_bf16 v[28:31], a[32:35], v[104:107], v[28:31]
    v_mfma_f32_16x16x32_bf16 v[32:35], a[36:39], v[104:107], v[32:35]
    v_mfma_f32_16x16x32_bf16 v[36:39], a[40:43], v[104:107], v[36:39]
    v_mfma_f32_16x16x32_bf16 v[40:43], a[44:47], v[104:107], v[40:43]
    v_mfma_f32_16x16x32_bf16 v[28:31], a[48:51], v[108:111], v[28:31]
    v_mfma_f32_16x16x32_bf16 v[32:35], a[52:55], v[108:111], v[32:35]
    v_mfma_f32_16x16x32_bf16 v[36:39], a[56:59], v[108:111], v[36:39]
    v_mfma_f32_16x16x32_bf16 v[40:43], a[60:63], v[108:111], v[40:43]
    s_nop 7
    ds_write_b128 v9, v[32:35] offset:0
    ds_write_b128 v10, v[36:39] offset:0
    ds_write_b128 v11, v[40:43] offset:0
    ds_write_b128 v15, v[28:31] offset:0
    s_waitcnt lgkmcnt(0)
    s_branch k2_L_47B
k2_L_49S:
k2_L_48L:
    global_load_dwordx4 v[60:63], v2, s[52:53] offset:-3072 sc1
    global_load_dwordx4 v[64:67], v2, s[52:53] offset:1024 sc1
    global_load_dwordx4 v[68:71], v3, s[52:53] offset:-3072 sc1
    global_load_dwordx4 v[72:75], v3, s[52:53] offset:1024 sc1
    global_load_dwordx4 v[76:79], v4, s[52:53] offset:-3072 sc1
    global_load_dwordx4 v[80:83], v4, s[52:53] offset:1024 sc1
    global_load_dwordx4 v[84:87], v5, s[52:53] offset:-3072 sc1
    global_load_dwordx4 v[88:91], v5, s[52:53] offset:1024 sc1
    global_load_dwordx4 v[92:95], v6, s[52:53] offset:-3072 sc1
    global_load_dwordx4 v[104:107], v6, s[52:53] offset:1024 sc1
    global_load_dwordx4 v[108:111], v7, s[94:95] offset:-3072 sc1
    s_sub_u32 s67, s67, 1
    s_cbranch_scc1 k2_L_48X
    s_waitcnt vmcnt(0)
    v_max3_u32 v0, v60, v62, v64
    v_max3_u32 v0, v0, v66, v68
    v_max3_u32 v0, v0, v70, v72
    v_max3_u32 v0, v0, v74, v76
    v_max3_u32 v0, v0, v78, v80
    v_max3_u32 v0, v0, v82, v84
    v_max3_u32 v0, v0, v86, v88
    v_max3_u32 v0, v0, v90, v92
    v_max3_u32 v0, v0, v94, v104
    v_max3_u32 v0, v0, v106, v108
    v_max_u32 v0, v0, v110
    v_cmp_eq_u32 vcc, -1, v0
    s_cbranch_vccnz k2_L_48L
    s_branch k2_L_48Y
k2_L_48X:
    s_mov_b32 s67, 0
k2_L_48Y:
    s_waitcnt vmcnt(0)
    s_waitcnt lgkmcnt(0)
    v_mfma_f32_16x16x32_bf16 v[44:47], v[144:147], v[60:63], v[132:135]
    v_mfma_f32_16x16x32_bf16 v[48:51], v[148:151], v[60:63], 0
    v_mfma_f32_16x16x32_bf16 v[52:55], v[152:155], v[60:63], 0
    v_mfma_f32_16x16x32_bf16 v[56:59], v[156:159], v[60:63], 0
    v_mfma_f32_16x16x32_bf16 v[44:47], v[160:163], v[64:67], v[44:47]
    v_mfma_f32_16x16x32_bf16 v[48:51], v[164:167], v[64:67], v[48:51]
    v_mfma_f32_16x16x32_bf16 v[52:55], v[168:171], v[64:67], v[52:55]
    v_mfma_f32_16x16x32_bf16 v[56:59], v[172:175], v[64:67], v[56:59]
    v_mfma_f32_16x16x32_bf16 v[44:47], v[176:179], v[68:71], v[44:47]
    v_mfma_f32_16x16x32_bf16 v[48:51], v[180:183], v[68:71], v[48:51]
    v_mfma_f32_16x16x32_bf16 v[52:55], v[184:187], v[68:71], v[52:55]
    v_mfma_f32_16x16x32_bf16 v[56:59], v[188:191], v[68:71], v[56:59]
    v_mfma_f32_16x16x32_bf16 v[44:47], v[192:195], v[72:75], v[44:47]
    v_mfma_f32_16x16x32_bf16 v[48:51], v[196:199], v[72:75], v[48:51]
    v_mfma_f32_16x16x32_bf16 v[52:55], v[200:203], v[72:75], v[52:55]
    v_mfma_f32_16x16x32_bf16 v[56:59], v[204:207], v[72:75], v[56:59]
    v_mfma_f32_16x16x32_bf16 v[44:47], v[208:211], v[76:79], v[44:47]
    v_mfma_f32_16x16x32_bf16 v[48:51], v[212:215], v[76:79], v[48:51]
    v_mfma_f32_16x16x32_bf16 v[52:55], v[216:219], v[76:79], v[52:55]
    v_mfma_f32_16x16x32_bf16 v[56:59], v[220:223], v[76:79], v[56:59]
    v_mfma_f32_16x16x32_bf16 v[44:47], v[224:227], v[80:83], v[44:47]
    v_mfma_f32_16x16x32_bf16 v[48:51], v[228:231], v[80:83], v[48:51]
    v_mfma_f32_16x16x32_bf16 v[52:55], v[232:235], v[80:83], v[52:55]
    v_mfma_f32_16x16x32_bf16 v[56:59], v[236:239], v[80:83], v[56:59]
    v_mfma_f32_16x16x32_bf16 v[44:47], v[240:243], v[84:87], v[44:47]
    v_mfma_f32_16x16x32_bf16 v[48:51], v[112:115], v[84:87], v[48:51]
    v_mfma_f32_16x16x32_bf16 v[52:55], v[116:119], v[84:87], v[52:55]
    v_mfma_f32_16x16x32_bf16 v[56:59], v[120:123], v[84:87], v[56:59]
    v_mfma_f32_16x16x32_bf16 v[44:47], a[0:3], v[88:91], v[44:47]
    v_mfma_f32_16x16x32_bf16 v[48:51], a[4:7], v[88:91], v[48:51]
    v_mfma_f32_16x16x32_bf16 v[52:55], a[8:11], v[88:91], v[52:55]
    v_mfma_f32_16x16x32_bf16 v[56:59], a[12:15], v[88:91], v[56:59]
    v_mfma_f32_16x16x32_bf16 v[44:47], a[16:19], v[92:95], v[44:47]
    v_mfma_f32_16x16x32_bf16 v[48:51], a[20:23], v[92:95], v[48:51]
    v_mfma_f32_16x16x32_bf16 v[52:55], a[24:27], v[92:95], v[52:55]
    v_mfma_f32_16x16x32_bf16 v[56:59], a[28:31], v[92:95], v[56:59]
    v_mfma_f32_16x16x32_bf16 v[44:47], a[32:35], v[104:107], v[44:47]
    v_mfma_f32_16x16x32_bf16 v[48:51], a[36:39], v[104:107], v[48:51]
    v_mfma_f32_16x16x32_bf16 v[52:55], a[40:43], v[104:107], v[52:55]
    v_mfma_f32_16x16x32_bf16 v[56:59], a[44:47], v[104:107], v[56:59]
    v_mfma_f32_16x16x32_bf16 v[44:47], a[48:51], v[108:111], v[44:47]
    v_mfma_f32_16x16x32_bf16 v[48:51], a[52:55], v[108:111], v[48:51]
    v_mfma_f32_16x16x32_bf16 v[52:55], a[56:59], v[108:111], v[52:55]
    v_mfma_f32_16x16x32_bf16 v[56:59], a[60:63], v[108:111], v[56:59]
    s_nop 7
    ds_write_b128 v9, v[48:51] offset:16384
    ds_write_b128 v10, v[52:55] offset:16384
    ds_write_b128 v11, v[56:59] offset:16384
    ds_write_b128 v15, v[44:47] offset:16384
    s_waitcnt lgkmcnt(0)
    s_branch k2_L_49B
k2_L_51S:
k2_L_50L:
    global_load_dwordx4 v[60:63], v2, s[52:53] offset:-2048 sc1
    global_load_dwordx4 v[64:67], v2, s[52:53] offset:2048 sc1
    global_load_dwordx4 v[68:71], v3, s[52:53] offset:-2048 sc1
    global_load_dwordx4 v[72:75], v3, s[52:53] offset:2048 sc1
    global_load_dwordx4 v[76:79], v4, s[52:53] offset:-2048 sc1
    global_load_dwordx4 v[80:83], v4, s[52:53] offset:2048 sc1
    global_load_dwordx4 v[84:87], v5, s[52:53] offset:-2048 sc1
    global_load_dwordx4 v[88:91], v5, s[52:53] offset:2048 sc1
    global_load_dwordx4 v[92:95], v6, s[52:53] offset:-2048 sc1
    global_load_dwordx4 v[104:107], v6, s[52:53] offset:2048 sc1
    global_load_dwordx4 v[108:111], v7, s[94:95] offset:-2048 sc1
    s_sub_u32 s67, s67, 1
    s_cbranch_scc1 k2_L_50X
    s_waitcnt vmcnt(0)
    v_max3_u32 v0, v60, v62, v64
    v_max3_u32 v0, v0, v66, v68
    v_max3_u32 v0, v0, v70, v72
    v_max3_u32 v0, v0, v74, v76
    v_max3_u32 v0, v0, v78, v80
    v_max3_u32 v0, v0, v82, v84
    v_max3_u32 v0, v0, v86, v88
    v_max3_u32 v0, v0, v90, v92
    v_max3_u32 v0, v0, v94, v104
    v_max3_u32 v0, v0, v106, v108
    v_max_u32 v0, v0, v110
    v_cmp_eq_u32 vcc, -1, v0
    s_cbranch_vccnz k2_L_50L
    s_branch k2_L_50Y
k2_L_50X:
    s_mov_b32 s67, 0
k2_L_50Y:
    s_waitcnt vmcnt(0)
    s_waitcnt lgkmcnt(0)
    v_mfma_f32_16x16x32_bf16 v[28:31], v[144:147], v[60:63], v[136:139]
    v_mfma_f32_16x16x32_bf16 v[32:35], v[148:151], v[60:63], 0
    v_mfma_f32_16x16x32_bf16 v[36:39], v[152:155], v[60:63], 0
    v_mfma_f32_16x16x32_bf16 v[40:43], v[156:159], v[60:63], 0
    v_mfma_f32_16x16x32_bf16 v[28:31], v[160:163], v[64:67], v[28:31]
    v_mfma_f32_16x16x32_bf16 v[32:35], v[164:167], v[64:67], v[32:35]
    v_mfma_f32_16x16x32_bf16 v[36:39], v[168:171], v[64:67], v[36:39]
    v_mfma_f32_16x16x32_bf16 v[40:43], v[172:175], v[64:67], v[40:43]
    v_mfma_f32_16x16x32_bf16 v[28:31], v[176:179], v[68:71], v[28:31]
    v_mfma_f32_16x16x32_bf16 v[32:35], v[180:183], v[68:71], v[32:35]
    v_mfma_f32_16x16x32_bf16 v[36:39], v[184:187], v[68:71], v[36:39]
    v_mfma_f32_16x16x32_bf16 v[40:43], v[188:191], v[68:71], v[40:43]
    v_mfma_f32_16x16x32_bf16 v[28:31], v[192:195], v[72:75], v[28:31]
    v_mfma_f32_16x16x32_bf16 v[32:35], v[196:199], v[72:75], v[32:35]
    v_mfma_f32_16x16x32_bf16 v[36:39], v[200:203], v[72:75], v[36:39]
    v_mfma_f32_16x16x32_bf16 v[40:43], v[204:207], v[72:75], v[40:43]
    v_mfma_f32_16x16x32_bf16 v[28:31], v[208:211], v[76:79], v[28:31]
    v_mfma_f32_16x16x32_bf16 v[32:35], v[212:215], v[76:79], v[32:35]
    v_mfma_f32_16x16x32_bf16 v[36:39], v[216:219], v[76:79], v[36:39]
    v_mfma_f32_16x16x32_bf16 v[40:43], v[220:223], v[76:79], v[40:43]
    v_mfma_f32_16x16x32_bf16 v[28:31], v[224:227], v[80:83], v[28:31]
    v_mfma_f32_16x16x32_bf16 v[32:35], v[228:231], v[80:83], v[32:35]
    v_mfma_f32_16x16x32_bf16 v[36:39], v[232:235], v[80:83], v[36:39]
    v_mfma_f32_16x16x32_bf16 v[40:43], v[236:239], v[80:83], v[40:43]
    v_mfma_f32_16x16x32_bf16 v[28:31], v[240:243], v[84:87], v[28:31]
    v_mfma_f32_16x16x32_bf16 v[32:35], v[112:115], v[84:87], v[32:35]
    v_mfma_f32_16x16x32_bf16 v[36:39], v[116:119], v[84:87], v[36:39]
    v_mfma_f32_16x16x32_bf16 v[40:43], v[120:123], v[84:87], v[40:43]
    v_mfma_f32_16x16x32_bf16 v[28:31], a[0:3], v[88:91], v[28:31]
    v_mfma_f32_16x16x32_bf16 v[32:35], a[4:7], v[88:91], v[32:35]
    v_mfma_f32_16x16x32_bf16 v[36:39], a[8:11], v[88:91], v[36:39]
    v_mfma_f32_16x16x32_bf16 v[40:43], a[12:15], v[88:91], v[40:43]
    v_mfma_f32_16x16x32_bf16 v[28:31], a[16:19], v[92:95], v[28:31]
    v_mfma_f32_16x16x32_bf16 v[32:35], a[20:23], v[92:95], v[32:35]
    v_mfma_f32_16x16x32_bf16 v[36:39], a[24:27], v[92:95], v[36:39]
    v_mfma_f32_16x16x32_bf16 v[40:43], a[28:31], v[92:95], v[40:43]
    v_mfma_f32_16x16x32_bf16 v[28:31], a[32:35], v[104:107], v[28:31]
    v_mfma_f32_16x16x32_bf16 v[32:35], a[36:39], v[104:107], v[32:35]
    v_mfma_f32_16x16x32_bf16 v[36:39], a[40:43], v[104:107], v[36:39]
    v_mfma_f32_16x16x32_bf16 v[40:43], a[44:47], v[104:107], v[40:43]
    v_mfma_f32_16x16x32_bf16 v[28:31], a[48:51], v[108:111], v[28:31]
    v_mfma_f32_16x16x32_bf16 v[32:35], a[52:55], v[108:111], v[32:35]
    v_mfma_f32_16x16x32_bf16 v[36:39], a[56:59], v[108:111], v[36:39]
    v_mfma_f32_16x16x32_bf16 v[40:43], a[60:63], v[108:111], v[40:43]
    s_nop 7
    ds_write_b128 v9, v[32:35] offset:32768
    ds_write_b128 v10, v[36:39] offset:32768
    ds_write_b128 v11, v[40:43] offset:32768
    ds_write_b128 v15, v[28:31] offset:32768
    s_waitcnt lgkmcnt(0)
    s_branch k2_L_51B
k2_L_53S:
k2_L_52L:
    global_load_dwordx4 v[60:63], v2, s[52:53] offset:-1024 sc1
    global_load_dwordx4 v[64:67], v2, s[52:53] offset:3072 sc1
    global_load_dwordx4 v[68:71], v3, s[52:53] offset:-1024 sc1
    global_load_dwordx4 v[72:75], v3, s[52:53] offset:3072 sc1
    global_load_dwordx4 v[76:79], v4, s[52:53] offset:-1024 sc1
    global_load_dwordx4 v[80:83], v4, s[52:53] offset:3072 sc1
    global_load_dwordx4 v[84:87], v5, s[52:53] offset:-1024 sc1
    global_load_dwordx4 v[88:91], v5, s[52:53] offset:3072 sc1
    global_load_dwordx4 v[92:95], v6, s[52:53] offset:-1024 sc1
    global_load_dwordx4 v[104:107], v6, s[52:53] offset:3072 sc1
    global_load_dwordx4 v[108:111], v7, s[94:95] offset:-1024 sc1
    s_sub_u32 s67, s67, 1
    s_cbranch_scc1 k2_L_52X
    s_waitcnt vmcnt(0)
    v_max3_u32 v0, v60, v62, v64
    v_max3_u32 v0, v0, v66, v68
    v_max3_u32 v0, v0, v70, v72
    v_max3_u32 v0, v0, v74, v76
    v_max3_u32 v0, v0, v78, v80
    v_max3_u32 v0, v0, v82, v84
    v_max3_u32 v0, v0, v86, v88
    v_max3_u32 v0, v0, v90, v92
    v_max3_u32 v0, v0, v94, v104
    v_max3_u32 v0, v0, v106, v108
    v_max_u32 v0, v0, v110
    v_cmp_eq_u32 vcc, -1, v0
    s_cbranch_vccnz k2_L_52L
    s_branch k2_L_52Y
k2_L_52X:
    s_mov_b32 s67, 0
k2_L_52Y:
    s_waitcnt vmcnt(0)
    s_waitcnt lgkmcnt(0)
    v_mfma_f32_16x16x32_bf16 v[44:47], v[144:147], v[60:63], v[140:143]
    v_mfma_f32_16x16x32_bf16 v[48:51], v[148:151], v[60:63], 0
    v_mfma_f32_16x16x32_bf16 v[52:55], v[152:155], v[60:63], 0
    v_mfma_f32_16x16x32_bf16 v[56:59], v[156:159], v[60:63], 0
    v_mfma_f32_16x16x32_bf16 v[44:47], v[160:163], v[64:67], v[44:47]
    v_mfma_f32_16x16x32_bf16 v[48:51], v[164:167], v[64:67], v[48:51]
    v_mfma_f32_16x16x32_bf16 v[52:55], v[168:171], v[64:67], v[52:55]
    v_mfma_f32_16x16x32_bf16 v[56:59], v[172:175], v[64:67], v[56:59]
    v_mfma_f32_16x16x32_bf16 v[44:47], v[176:179], v[68:71], v[44:47]
    v_mfma_f32_16x16x32_bf16 v[48:51], v[180:183], v[68:71], v[48:51]
    v_mfma_f32_16x16x32_bf16 v[52:55], v[184:187], v[68:71], v[52:55]
    v_mfma_f32_16x16x32_bf16 v[56:59], v[188:191], v[68:71], v[56:59]
    v_mfma_f32_16x16x32_bf16 v[44:47], v[192:195], v[72:75], v[44:47]
    v_mfma_f32_16x16x32_bf16 v[48:51], v[196:199], v[72:75], v[48:51]
    v_mfma_f32_16x16x32_bf16 v[52:55], v[200:203], v[72:75], v[52:55]
    v_mfma_f32_16x16x32_bf16 v[56:59], v[204:207], v[72:75], v[56:59]
    v_mfma_f32_16x16x32_bf16 v[44:47], v[208:211], v[76:79], v[44:47]
    v_mfma_f32_16x16x32_bf16 v[48:51], v[212:215], v[76:79], v[48:51]
    v_mfma_f32_16x16x32_bf16 v[52:55], v[216:219], v[76:79], v[52:55]
    v_mfma_f32_16x16x32_bf16 v[56:59], v[220:223], v[76:79], v[56:59]
    v_mfma_f32_16x16x32_bf16 v[44:47], v[224:227], v[80:83], v[44:47]
    v_mfma_f32_16x16x32_bf16 v[48:51], v[228:231], v[80:83], v[48:51]
    v_mfma_f32_16x16x32_bf16 v[52:55], v[232:235], v[80:83], v[52:55]
    v_mfma_f32_16x16x32_bf16 v[56:59], v[236:239], v[80:83], v[56:59]
    v_mfma_f32_16x16x32_bf16 v[44:47], v[240:243], v[84:87], v[44:47]
    v_mfma_f32_16x16x32_bf16 v[48:51], v[112:115], v[84:87], v[48:51]
    v_mfma_f32_16x16x32_bf16 v[52:55], v[116:119], v[84:87], v[52:55]
    v_mfma_f32_16x16x32_bf16 v[56:59], v[120:123], v[84:87], v[56:59]
    v_mfma_f32_16x16x32_bf16 v[44:47], a[0:3], v[88:91], v[44:47]
    v_mfma_f32_16x16x32_bf16 v[48:51], a[4:7], v[88:91], v[48:51]
    v_mfma_f32_16x16x32_bf16 v[52:55], a[8:11], v[88:91], v[52:55]
    v_mfma_f32_16x16x32_bf16 v[56:59], a[12:15], v[88:91], v[56:59]
    v_mfma_f32_16x16x32_bf16 v[44:47], a[16:19], v[92:95], v[44:47]
    v_mfma_f32_16x16x32_bf16 v[48:51], a[20:23], v[92:95], v[48:51]
    v_mfma_f32_16x16x32_bf16 v[52:55], a[24:27], v[92:95], v[52:55]
    v_mfma_f32_16x16x32_bf16 v[56:59], a[28:31], v[92:95], v[56:59]
    v_mfma_f32_16x16x32_bf16 v[44:47], a[32:35], v[104:107], v[44:47]
    v_mfma_f32_16x16x32_bf16 v[48:51], a[36:39], v[104:107], v[48:51]
    v_mfma_f32_16x16x32_bf16 v[52:55], a[40:43], v[104:107], v[52:55]
    v_mfma_f32_16x16x32_bf16 v[56:59], a[44:47], v[104:107], v[56:59]
    v_mfma_f32_16x16x32_bf16 v[44:47], a[48:51], v[108:111], v[44:47]
    v_mfma_f32_16x16x32_bf16 v[48:51], a[52:55], v[108:111], v[48:51]
    v_mfma_f32_16x16x32_bf16 v[52:55], a[56:59], v[108:111], v[52:55]
    v_mfma_f32_16x16x32_bf16 v[56:59], a[60:63], v[108:111], v[56:59]
    s_nop 7
    ds_write_b128 v9, v[48:51] offset:49152
    ds_write_b128 v10, v[52:55] offset:49152
    ds_write_b128 v11, v[56:59] offset:49152
    ds_write_b128 v15, v[44:47] offset:49152
    s_waitcnt lgkmcnt(0)
    s_branch k2_L_53B
k2_GOW:
    v_rcp_f32 v105, v104
    v_pk_mul_f32 v[32:33], v[96:97], 0 op_sel_hi:[1,0]
    v_pk_fma_f32 v[32:33], v[98:99], 0, v[32:33] op_sel_hi:[1,0,1]
    v_pk_fma_f32 v[32:33], v[100:101], 0, v[32:33] op_sel_hi:[1,0,1]
    v_pk_fma_f32 v[32:33], v[102:103], 0, v[32:33] op_sel_hi:[1,0,1]
    v_pk_mul_f32 v[34:35], v[104:105], s[90:91]
    v_pk_fma_f32 v[32:33], v[34:35], 0, v[32:33] op_sel_hi:[1,0,1]
    v_cmp_u_f32_e64 s[26:27], v32, v33
    v_pk_mul_f32 v[96:97], v[96:97], v[104:105] op_sel:[0,1] op_sel_hi:[1,1]
    v_pk_mul_f32 v[98:99], v[98:99], v[104:105] op_sel:[0,1] op_sel_hi:[1,1]
    v_pk_mul_f32 v[100:101], v[100:101], v[104:105] op_sel:[0,1] op_sel_hi:[1,1]
    v_pk_mul_f32 v[102:103], v[102:103], v[104:105] op_sel:[0,1] op_sel_hi:[1,1]
    v_cvt_pk_bf16_f32 v108, v96, v97
    v_cvt_pk_bf16_f32 v109, v98, v99
    v_cvt_pk_bf16_f32 v110, v100, v101
    v_cvt_pk_bf16_f32 v111, v102, v103
    s_add_u32 s92, s22, 32768
    s_addc_u32 s93, s23, 0
    s_cmp_lg_u64 s[26:27], 0
    s_cbranch_scc1 k2_L_54S
    global_store_dwordx4 v21, v[108:111], s[22:23] sc0 sc1
k2_L_54B:
    v_exp_f32 v80, v80
    v_exp_f32 v81, v81
    v_smfmac_f32_32x32x32_bf16 v[112:127], v[52:55], v[72:79], v39
    ds_read_b128 v[52:55], v20 offset:9216
    s_waitcnt lgkmcnt(5)
    v_exp_f32 v82, v82
    v_exp_f32 v83, v83
    v_exp_f32 v84, v84
    v_mfma_f32_32x32x16_bf16 v[64:79], v[40:43], v[28:31], 0
    ds_read_b128 v[40:43], v14 offset:13824
    s_waitcnt lgkmcnt(5)
    v_exp_f32 v85, v85
    v_exp_f32 v86, v86
    v_exp_f32 v87, v87
    v_exp_f32 v88, v88
    v_exp_f32 v89, v89
    v_smfmac_f32_32x32x32_bf16 v[112:127], v[56:59], v[80:87], v39
    ds_read_b128 v[56:59], v17 offset:11520
    s_waitcnt lgkmcnt(5)
    v_exp_f32 v90, v90
    v_exp_f32 v91, v91
    v_exp_f32 v92, v92
    v_exp_f32 v93, v93
    v_exp_f32 v94, v94
    v_exp_f32 v95, v95
    v_exp_f32 v64, v64
    v_exp_f32 v65, v65
    v_smfmac_f32_32x32x32_bf16 v[112:127], v[60:63], v[88:95], v39
    ds_read_b128 v[60:63], v20 offset:11520
    s_waitcnt lgkmcnt(5)
    v_exp_f32 v66, v66
    v_exp_f32 v67, v67
    v_exp_f32 v68, v68
    v_mfma_f32_32x32x16_bf16 v[80:95], v[44:47], v[28:31], 0
    ds_read_b128 v[44:47], v14 offset:16128
    s_waitcnt lgkmcnt(5)
    v_exp_f32 v69, v69
    v_exp_f32 v70, v70
    v_exp_f32 v71, v71
    v_exp_f32 v72, v72
    v_exp_f32 v73, v73
    v_smfmac_f32_32x32x32_bf16 v[112:127], v[48:51], v[64:71], v39
    ds_read_b128 v[48:51], v17 offset:13824
    s_waitcnt lgkmcnt(5)
    v_exp_f32 v74, v74
    v_exp_f32 v75, v75
    v_exp_f32 v76, v76
    v_exp_f32 v77, v77
    v_exp_f32 v78, v78
    v_exp_f32 v79, v79
    v_exp_f32 v80, v80
    v_exp_f32 v81, v81
    v_smfmac_f32_32x32x32_bf16 v[112:127], v[52:55], v[72:79], v39
    ds_read_b128 v[52:55], v20 offset:13824
    s_waitcnt lgkmcnt(5)
    v_exp_f32 v82, v82
    v_exp_f32 v83, v83
    v_exp_f32 v84, v84
    v_mfma_f32_32x32x16_bf16 v[64:79], v[40:43], v[28:31], 0
    s_waitcnt lgkmcnt(4)
    v_exp_f32 v85, v85
    v_exp_f32 v86, v86
    v_exp_f32 v87, v87
    v_exp_f32 v88, v88
    v_exp_f32 v89, v89
    v_smfmac_f32_32x32x32_bf16 v[112:127], v[56:59], v[80:87], v39
    ds_read_b128 v[56:59], v17 offset:16128
    s_waitcnt lgkmcnt(4)
    v_exp_f32 v90, v90
    v_exp_f32 v91, v91
    v_exp_f32 v92, v92
    v_exp_f32 v93, v93
    v_exp_f32 v94, v94
    v_exp_f32 v95, v95
    v_exp_f32 v64, v64
    v_exp_f32 v65, v65
    v_smfmac_f32_32x32x32_bf16 v[112:127], v[60:63], v[88:95], v39
    ds_read_b128 v[60:63], v20 offset:16128
    s_waitcnt lgkmcnt(4)
    v_exp_f32 v66, v66
    v_exp_f32 v67, v67
    v_exp_f32 v68, v68
    v_mfma_f32_32x32x16_bf16 v[80:95], v[44:47], v[28:31], 0
    global_load_dwordx4 v[96:99], v2, s[34:35] offset:0 sc1
    s_waitcnt lgkmcnt(3)
    v_exp_f32 v69, v69
    v_exp_f32 v70, v70
    v_exp_f32 v71, v71
    v_exp_f32 v72, v72
    v_exp_f32 v73, v73
    v_smfmac_f32_32x32x32_bf16 v[112:127], v[48:51], v[64:71], v39
    global_load_dwordx4 v[100:103], v2, s[34:35] offset:1024 sc1
    s_waitcnt lgkmcnt(2)
    v_exp_f32 v74, v74
    v_exp_f32 v75, v75
    v_exp_f32 v76, v76
    v_exp_f32 v77, v77
    v_exp_f32 v78, v78
    v_exp_f32 v79, v79
    v_exp_f32 v80, v80
    v_exp_f32 v81, v81
    v_smfmac_f32_32x32x32_bf16 v[112:127], v[52:55], v[72:79], v39
    global_load_dwordx4 v[104:107], v2, s[34:35] offset:2048 sc1
    v_exp_f32 v82, v82
    v_exp_f32 v83, v83
    v_exp_f32 v84, v84
    global_load_dwordx4 v[108:111], v2, s[34:35] offset:3072 sc1
    s_waitcnt lgkmcnt(1)
    v_exp_f32 v85, v85
    v_exp_f32 v86, v86
    v_exp_f32 v87, v87
    v_exp_f32 v88, v88
    v_exp_f32 v89, v89
    v_smfmac_f32_32x32x32_bf16 v[112:127], v[56:59], v[80:87], v39
    global_load_dwordx4 v[64:67], v4, s[34:35] offset:0 sc1
    s_waitcnt lgkmcnt(0)
    v_exp_f32 v90, v90
    v_exp_f32 v91, v91
    v_exp_f32 v92, v92
    v_exp_f32 v93, v93
    v_exp_f32 v94, v94
    v_exp_f32 v95, v95
    s_nop 1
    v_smfmac_f32_32x32x32_bf16 v[112:127], v[60:63], v[88:95], v39
    global_load_dwordx4 v[68:71], v4, s[34:35] offset:1024 sc1
    global_load_dwordx4 v[72:75], v4, s[34:35] offset:2048 sc1
    global_load_dwordx4 v[76:79], v4, s[34:35] offset:3072 sc1
    v_lshlrev_b32 v128, 16, v130
    v_and_b32 v129, 0xffff0000, v130
    v_lshlrev_b32 v130, 16, v131
    v_and_b32 v131, 0xffff0000, v131
    v_lshlrev_b32 v132, 16, v134
    v_and_b32 v133, 0xffff0000, v134
    v_lshlrev_b32 v134, 16, v135
    v_and_b32 v135, 0xffff0000, v135
    s_nop 0
    v_rcp_f32 v121, v120
    v_pk_mul_f32 v[32:33], v[112:113], 0 op_sel_hi:[1,0]
    v_pk_fma_f32 v[32:33], v[114:115], 0, v[32:33] op_sel_hi:[1,0,1]
    v_pk_fma_f32 v[32:33], v[116:117], 0, v[32:33] op_sel_hi:[1,0,1]
    v_pk_fma_f32 v[32:33], v[118:119], 0, v[32:33] op_sel_hi:[1,0,1]
    v_pk_mul_f32 v[34:35], v[120:121], s[90:91]
    v_pk_fma_f32 v[32:33], v[34:35], 0, v[32:33] op_sel_hi:[1,0,1]
    v_cmp_u_f32_e64 s[26:27], v32, v33
    v_pk_mul_f32 v[112:113], v[112:113], v[120:121] op_sel:[0,1] op_sel_hi:[1,1]
    v_pk_mul_f32 v[114:115], v[114:115], v[120:121] op_sel:[0,1] op_sel_hi:[1,1]
    v_pk_mul_f32 v[116:117], v[116:117], v[120:121] op_sel:[0,1] op_sel_hi:[1,1]
    v_pk_mul_f32 v[118:119], v[118:119], v[120:121] op_sel:[0,1] op_sel_hi:[1,1]
    v_cvt_pk_bf16_f32 v124, v112, v113
    v_cvt_pk_bf16_f32 v125, v114, v115
    v_cvt_pk_bf16_f32 v126, v116, v117
    v_cvt_pk_bf16_f32 v127, v118, v119
    s_or_b64 s[24:25], s[26:27], s[28:29]
    s_cbranch_scc1 k2_L_55
    global_store_dwordx4 v21, v[124:127], s[92:93] sc0 sc1
    s_waitcnt vmcnt(5)
    v_max3_u32 v36, v96, v100, v104
    v_max_u32 v36, v36, v108
    v_cmp_eq_u32_e64 s[20:21], -1, v36
    v_lshlrev_b32 v136, 16, v138
    v_and_b32 v137, 0xffff0000, v138
    v_lshlrev_b32 v138, 16, v139
    v_and_b32 v139, 0xffff0000, v139
    s_cmp_lg_u64 s[20:21], 0
    s_cbranch_scc1 k2_L_57S
k2_L_57B:
    v_mfma_f32_16x16x32_bf16 v[44:47], a[4:7], v[96:99], 0
    v_and_b32 v60, 15, v1
    v_lshrrev_b32 v61, 4, v1
    v_lshlrev_b32 v140, 16, v142
    v_mfma_f32_16x16x32_bf16 v[48:51], a[8:11], v[96:99], 0
    s_lshl_b32 s31, s3, 10
    v_and_b32 v141, 0xffff0000, v142
    v_lshlrev_b32 v142, 16, v143
    v_mfma_f32_16x16x32_bf16 v[52:55], a[12:15], v[96:99], 0
    s_add_u32 s31, s31, 65536
    v_and_b32 v17, 0xf0, v2
    v_lshl_add_u32 v14, v61, 8, s31
    s_add_u32 s17, s3, 1
    s_and_b32 s17, s17, 3
    s_mul_i32 s17, s17, 3072
    s_add_u32 s17, s17, 110592
    v_add_u32 v9, s17, v2
    v_mfma_f32_16x16x32_bf16 v[44:47], a[20:23], v[100:103], v[44:47]
    v_bfe_u32 v0, v2, 8, 1
    v_lshl_add_u32 v17, v0, 3, v17
    v_mfma_f32_16x16x32_bf16 v[48:51], a[24:27], v[100:103], v[48:51]
    v_lshrrev_b32 v0, 9, v2
    v_lshl_add_u32 v17, v0, 8, v17
    s_add_u32 s17, s3, 2
    s_and_b32 s17, s17, 3
    s_mul_i32 s17, s17, 3072
    s_add_u32 s17, s17, 111616
    v_add_u32 v10, s17, v2
    v_mfma_f32_16x16x32_bf16 v[52:55], a[28:31], v[100:103], v[52:55]
    v_lshl_add_u32 v14, v60, 3, v14
    v_mov_b32 v28, s33
    v_mfma_f32_16x16x32_bf16 v[44:47], a[36:39], v[104:107], v[44:47]
    s_waitcnt vmcnt(1)
    v_max3_u32 v36, v64, v68, v72
    v_max_u32 v36, v36, v76
    s_add_u32 s17, s3, 3
    s_and_b32 s17, s17, 3
    s_mul_i32 s17, s17, 3072
    s_add_u32 s17, s17, 112640
    v_add_u32 v11, s17, v2
    v_mfma_f32_16x16x32_bf16 v[48:51], a[40:43], v[104:107], v[48:51]
    v_cmp_eq_u32_e64 s[24:25], -1, v36
    v_mov_b32 v29, s33
    s_and_b32 s30, s3, 1
    s_lshl_b32 s30, s30, 7
    s_add_u32 s30, s30, 65536
    v_lshl_add_u32 v15, v61, 10, s30
    v_lshl_add_u32 v15, v60, 3, v15
    v_mfma_f32_16x16x32_bf16 v[52:55], a[44:47], v[104:107], v[52:55]
    s_lshl_b32 s30, s3, 12
    v_mov_b32 v30, s33
    v_mov_b32 v31, s33
    s_mul_i32 s17, s3, 3072
    s_add_u32 s17, s17, 110592
    v_lshl_add_u32 v13, v1, 6, s30
    s_cmp_lg_u64 s[24:25], 0
    v_mfma_f32_16x16x32_bf16 v[44:47], a[52:55], v[108:111], v[44:47]
    s_cbranch_scc1 k2_L_59S
k2_L_59B:
    v_add_u32 v12, s17, v2
    v_bfe_u32 v16, v1, 1, 2
    v_mfma_f32_16x16x32_bf16 v[48:51], a[56:59], v[108:111], v[48:51]
    v_lshl_add_u32 v13, v16, 4, v13
    v_and_b32 v143, 0xffff0000, v143
    v_mfma_f32_16x16x32_bf16 v[52:55], a[60:63], v[108:111], v[52:55]
    s_cmp_eq_u32 s3, 3
    s_cselect_b32 s31, 9, 10
    s_cselect_b32 s96, -4096, 0
    s_ashr_i32 s17, s96, 31
    s_add_u32 s94, s52, s96
    s_addc_u32 s95, s53, s17
    v_mfma_f32_16x16x32_bf16 v[40:43], a[0:3], v[96:99], v[128:131]
    ds_write_b128 v9, v[44:47] offset:36864
    v_mfma_f32_16x16x32_bf16 v[40:43], a[16:19], v[100:103], v[40:43]
    v_lshrrev_b32 v16, 2, v1
    v_min_u32 v16, s31, v16
    v_mfma_f32_16x16x32_bf16 v[40:43], a[32:35], v[104:107], v[40:43]
    ds_write_b128 v10, v[48:51] offset:36864
    v_mfma_f32_16x16x32_bf16 v[40:43], a[48:51], v[108:111], v[40:43]
    v_lshlrev_b32 v16, 12, v16
    v_and_b32 v0, 2, v1
    v_lshl_add_u32 v16, v0, 8, v16
    v_mfma_f32_16x16x32_bf16 v[84:87], a[4:7], v[64:67], 0
    ds_write_b128 v11, v[52:55] offset:36864
    v_mfma_f32_16x16x32_bf16 v[88:91], a[8:11], v[64:67], 0
    s_waitcnt lgkmcnt(0)
    s_barrier
    v_mfma_f32_16x16x32_bf16 v[92:95], a[12:15], v[64:67], 0
    ds_read_b128 v[96:99], v12 offset:36864
    ds_read_b128 v[100:103], v12 offset:37888
    v_mfma_f32_16x16x32_bf16 v[84:87], a[20:23], v[68:71], v[84:87]
    ds_read_b128 v[104:107], v12 offset:38912
    v_lshrrev_b32 v61, 5, v1
    v_mfma_f32_16x16x32_bf16 v[88:91], a[24:27], v[68:71], v[88:91]
    v_lshlrev_b32 v60, 4, v60
    v_lshl_add_u32 v21, v61, 2, v60
    v_mfma_f32_16x16x32_bf16 v[92:95], a[28:31], v[68:71], v[92:95]
    v_and_b32 v60, 31, v1
    v_lshlrev_b32 v60, 4, v60
    v_mfma_f32_16x16x32_bf16 v[84:87], a[36:39], v[72:75], v[84:87]
    v_lshl_add_u32 v1, v61, 11, v60
    v_mfma_f32_16x16x32_bf16 v[88:91], a[40:43], v[72:75], v[88:91]
    s_waitcnt lgkmcnt(2)
    v_add_f32 v128, v40, v96
    v_add_f32 v129, v41, v97
    v_mfma_f32_16x16x32_bf16 v[92:95], a[44:47], v[72:75], v[92:95]
    v_add_f32 v130, v42, v98
    v_add_f32 v131, v43, v99
    v_mfma_f32_16x16x32_bf16 v[84:87], a[52:55], v[76:79], v[84:87]
    s_waitcnt lgkmcnt(0)
    v_add_f32 v100, v100, v104
    v_add_f32 v101, v101, v105
    v_mfma_f32_16x16x32_bf16 v[88:91], a[56:59], v[76:79], v[88:91]
    v_add_f32 v102, v102, v106
    v_add_f32 v103, v103, v107
    v_mfma_f32_16x16x32_bf16 v[92:95], a[60:63], v[76:79], v[92:95]
    v_add_f32 v128, v128, v100
    v_add_f32 v129, v129, v101
    v_mfma_f32_16x16x32_bf16 v[80:83], a[0:3], v[64:67], v[132:135]
    ds_write_b128 v9, v[84:87] offset:0
    v_add_f32 v130, v130, v102
    v_add_f32 v131, v131, v103
    v_mfma_f32_16x16x32_bf16 v[80:83], a[16:19], v[68:71], v[80:83]
    ds_write_b128 v10, v[88:91] offset:0
    v_cvt_pk_bf16_f32 v108, v128, v129
    v_cvt_pk_bf16_f32 v109, v130, v131
    v_mfma_f32_16x16x32_bf16 v[80:83], a[32:35], v[72:75], v[80:83]
    global_store_dwordx2 v17, v[108:109], s[40:41] sc0 sc1
    s_add_u32 s40, s40, 16384
    s_addc_u32 s41, s41, 0
    v_add_f32 v96, v128, v129
    v_mul_f32 v97, v128, v128
    v_mfma_f32_16x16x32_bf16 v[80:83], a[48:51], v[76:79], v[80:83]
    ds_write_b128 v11, v[92:95] offset:0
    v_add_f32 v98, v130, v131
    v_fmac_f32 v97, v129, v129
    v_mfma_f32_16x16x32_bf16 v[244:247], a[64:67], v[28:31], 0
    global_load_dwordx4 v[112:115], v6, s[34:35] offset:0 sc1
    v_add_f32 v96, v96, v98
    v_fmac_f32 v97, v130, v130
    v_mfma_f32_16x16x32_bf16 v[248:251], a[128:131], v[28:31], 0
    v_fmac_f32 v97, v131, v131
    v_mfma_f32_16x16x32_bf16 v[252:255], a[192:195], v[28:31], 0
    ds_write_b64 v14, v[96:97] offset:0
    v_mfma_f32_16x16x32_bf16 v[244:247], a[68:71], v[28:31], v[244:247]
    s_waitcnt lgkmcnt(0)
    s_barrier
    v_mfma_f32_16x16x32_bf16 v[248:251], a[132:135], v[28:31], v[248:251]
    ds_read_b128 v[64:67], v12 offset:0
    ds_read_b128 v[68:71], v12 offset:1024
    v_mfma_f32_16x16x32_bf16 v[252:255], a[196:199], v[28:31], v[252:255]
    ds_read_b128 v[72:75], v12 offset:2048
    global_load_dwordx4 v[116:119], v6, s[34:35] offset:1024 sc1
    v_mfma_f32_16x16x32_bf16 v[244:247], a[72:75], v[28:31], v[244:247]
    v_mfma_f32_16x16x32_bf16 v[248:251], a[136:139], v[28:31], v[248:251]
    v_mfma_f32_16x16x32_bf16 v[252:255], a[200:203], v[28:31], v[252:255]
    v_mfma_f32_16x16x32_bf16 v[244:247], a[76:79], v[28:31], v[244:247]
    s_waitcnt lgkmcnt(2)
    global_load_dwordx4 v[120:123], v6, s[34:35] offset:2048 sc1
    v_add_f32 v132, v80, v64
    v_add_f32 v133, v81, v65
    v_mfma_f32_16x16x32_bf16 v[248:251], a[140:143], v[28:31], v[248:251]
    v_add_f32 v134, v82, v66
    v_add_f32 v135, v83, v67
    v_mfma_f32_16x16x32_bf16 v[252:255], a[204:207], v[28:31], v[252:255]
    s_waitcnt lgkmcnt(0)
    v_add_f32 v68, v68, v72
    v_add_f32 v69, v69, v73
    v_mfma_f32_16x16x32_bf16 v[244:247], a[80:83], v[28:31], v[244:247]
    v_add_f32 v70, v70, v74
    v_add_f32 v71, v71, v75
    v_mfma_f32_16x16x32_bf16 v[248:251], a[144:147], v[28:31], v[248:251]
    v_add_f32 v132, v132, v68
    v_add_f32 v133, v133, v69
    v_mfma_f32_16x16x32_bf16 v[252:255], a[208:211], v[28:31], v[252:255]
    global_load_dwordx4 v[124:127], v6, s[34:35] offset:3072 sc1
    v_add_f32 v134, v134, v70
    v_add_f32 v135, v135, v71
    v_mfma_f32_16x16x32_bf16 v[244:247], a[84:87], v[28:31], v[244:247]
    v_cvt_pk_bf16_f32 v76, v132, v133
    v_cvt_pk_bf16_f32 v77, v134, v135
    v_mfma_f32_16x16x32_bf16 v[248:251], a[148:151], v[28:31], v[248:251]
    global_store_dwordx2 v17, v[76:77], s[40:41] sc0 sc1
    s_add_u32 s40, s40, 16384
    s_addc_u32 s41, s41, 0
    v_add_f32 v64, v132, v133
    v_mul_f32 v65, v132, v132
    v_mfma_f32_16x16x32_bf16 v[252:255], a[212:215], v[28:31], v[252:255]
    v_add_f32 v66, v134, v135
    v_fmac_f32 v65, v133, v133
    v_mfma_f32_16x16x32_bf16 v[244:247], a[88:91], v[28:31], v[244:247]
    v_add_f32 v64, v64, v66
    v_fmac_f32 v65, v134, v134
    v_mfma_f32_16x16x32_bf16 v[248:251], a[152:155], v[28:31], v[248:251]
    v_fmac_f32 v65, v135, v135
    v_mfma_f32_16x16x32_bf16 v[252:255], a[216:219], v[28:31], v[252:255]
    ds_write_b64 v14, v[64:65] offset:128
    global_load_dwordx4 v[96:99], v8, s[34:35] offset:0 sc1
    v_mfma_f32_16x16x32_bf16 v[244:247], a[92:95], v[28:31], v[244:247]
    v_mfma_f32_16x16x32_bf16 v[248:251], a[156:159], v[28:31], v[248:251]
    s_waitcnt lgkmcnt(0)
    s_barrier
    v_mfma_f32_16x16x32_bf16 v[252:255], a[220:223], v[28:31], v[252:255]
    ds_read2_b64 v[56:59], v15 offset0:0 offset1:32
    v_mfma_f32_16x16x32_bf16 v[244:247], a[96:99], v[28:31], v[244:247]
    ds_read2_b64 v[60:63], v15 offset0:64 offset1:96
    v_add_u32 v15, 4096, v15
    v_mfma_f32_16x16x32_bf16 v[248:251], a[160:163], v[28:31], v[248:251]
    global_load_dwordx4 v[100:103], v8, s[34:35] offset:1024 sc1
    v_mfma_f32_16x16x32_bf16 v[252:255], a[224:227], v[28:31], v[252:255]
    v_mfma_f32_16x16x32_bf16 v[244:247], a[100:103], v[28:31], v[244:247]
    v_mfma_f32_16x16x32_bf16 v[248:251], a[164:167], v[28:31], v[248:251]
    v_mfma_f32_16x16x32_bf16 v[252:255], a[228:231], v[28:31], v[252:255]
    s_waitcnt lgkmcnt(0)
    global_load_dwordx4 v[104:107], v8, s[34:35] offset:2048 sc1
    v_add_f32 v56, v56, v58
    v_add_f32 v57, v57, v59
    v_add_f32 v60, v60, v62
    v_add_f32 v61, v61, v63
    v_add_f32 v56, v56, v60
    v_add_f32 v57, v57, v61
    v_mfma_f32_16x16x32_bf16 v[244:247], a[104:107], v[28:31], v[244:247]
    v_mfma_f32_16x16x32_bf16 v[248:251], a[168:171], v[28:31], v[248:251]
    v_permlane32_swap_b32 v56, v57
    v_mfma_f32_16x16x32_bf16 v[252:255], a[232:235], v[28:31], v[252:255]
    v_add_f32 v56, v56, v57
    v_mov_b32 v57, v56
    v_mfma_f32_16x16x32_bf16 v[244:247], a[108:111], v[28:31], v[244:247]
    global_load_dwordx4 v[108:111], v8, s[34:35] offset:3072 sc1
    v_mfma_f32_16x16x32_bf16 v[248:251], a[172:175], v[28:31], v[248:251]
    v_permlane16_swap_b32 v56, v57
    v_mfma_f32_16x16x32_bf16 v[252:255], a[236:239], v[28:31], v[252:255]
    v_add_f32 v56, v56, v57
    v_mfma_f32_16x16x32_bf16 v[244:247], a[112:115], v[28:31], v[244:247]
    s_waitcnt vmcnt(5)
    global_store_dword v21, v56, s[42:43] offset:0 sc0 sc1
    v_max3_u32 v36, v112, v116, v120
    v_max_u32 v36, v36, v124
    v_cmp_eq_u32_e64 s[24:25], -1, v36
    v_mfma_f32_16x16x32_bf16 v[248:251], a[176:179], v[28:31], v[248:251]
    s_add_u32 m0, s30, 0
    s_cmp_lg_u64 s[24:25], 0
    v_mfma_f32_16x16x32_bf16 v[252:255], a[240:243], v[28:31], v[252:255]
    s_cbranch_scc1 k2_L_65S
k2_L_65B:
    global_load_lds_dwordx4 v2, s[44:45] offset:0 sc1
    v_mfma_f32_16x16x32_bf16 v[244:247], a[116:119], v[28:31], v[244:247]
    v_mfma_f32_16x16x32_bf16 v[248:251], a[180:183], v[28:31], v[248:251]
    v_mfma_f32_16x16x32_bf16 v[252:255], a[244:247], v[28:31], v[252:255]
    v_mfma_f32_16x16x32_bf16 v[244:247], a[120:123], v[28:31], v[244:247]
    v_mfma_f32_16x16x32_bf16 v[248:251], a[184:187], v[28:31], v[248:251]
    global_load_lds_dwordx4 v2, s[44:45] offset:1024 sc1
    v_mfma_f32_16x16x32_bf16 v[252:255], a[248:251], v[28:31], v[252:255]
    v_mfma_f32_16x16x32_bf16 v[244:247], a[124:127], v[28:31], v[244:247]
    v_mfma_f32_16x16x32_bf16 v[248:251], a[188:191], v[28:31], v[248:251]
    v_mfma_f32_16x16x32_bf16 v[252:255], a[252:255], v[28:31], v[252:255]
    global_load_lds_dwordx4 v2, s[44:45] offset:2048 sc1
    v_mfma_f32_16x16x32_bf16 v[44:47], a[4:7], v[112:115], 0
    v_mfma_f32_16x16x32_bf16 v[48:51], a[8:11], v[112:115], 0
    v_mfma_f32_16x16x32_bf16 v[52:55], a[12:15], v[112:115], 0
    v_mfma_f32_16x16x32_bf16 v[44:47], a[20:23], v[116:119], v[44:47]
    v_mfma_f32_16x16x32_bf16 v[48:51], a[24:27], v[116:119], v[48:51]
    global_load_lds_dwordx4 v2, s[44:45] offset:3072 sc1
    s_add_u32 m0, s30, 16384
    v_mfma_f32_16x16x32_bf16 v[52:55], a[28:31], v[116:119], v[52:55]
    v_mfma_f32_16x16x32_bf16 v[44:47], a[36:39], v[120:123], v[44:47]
    v_mfma_f32_16x16x32_bf16 v[48:51], a[40:43], v[120:123], v[48:51]
    v_mfma_f32_16x16x32_bf16 v[52:55], a[44:47], v[120:123], v[52:55]
    global_load_lds_dwordx4 v4, s[44:45] offset:0 sc1
    v_mfma_f32_16x16x32_bf16 v[44:47], a[52:55], v[124:127], v[44:47]
    s_waitcnt vmcnt(6)
    v_max3_u32 v36, v96, v100, v104
    v_max_u32 v36, v36, v108
    v_cmp_eq_u32_e64 s[24:25], -1, v36
    v_mfma_f32_16x16x32_bf16 v[48:51], a[56:59], v[124:127], v[48:51]
    s_cmp_lg_u64 s[24:25], 0
    v_mfma_f32_16x16x32_bf16 v[52:55], a[60:63], v[124:127], v[52:55]
    s_cbranch_scc1 k2_L_67S
k2_L_67B:
    v_mfma_f32_16x16x32_bf16 v[40:43], a[0:3], v[112:115], v[136:139]
    ds_write_b128 v9, v[44:47] offset:12288
    v_mfma_f32_16x16x32_bf16 v[40:43], a[16:19], v[116:119], v[40:43]
    global_load_lds_dwordx4 v4, s[44:45] offset:1024 sc1
    v_mfma_f32_16x16x32_bf16 v[40:43], a[32:35], v[120:123], v[40:43]
    ds_write_b128 v10, v[48:51] offset:12288
    v_mfma_f32_16x16x32_bf16 v[40:43], a[48:51], v[124:127], v[40:43]
    v_mfma_f32_16x16x32_bf16 v[84:87], a[4:7], v[96:99], 0
    ds_write_b128 v11, v[52:55] offset:12288
    v_mfma_f32_16x16x32_bf16 v[88:91], a[8:11], v[96:99], 0
    global_load_lds_dwordx4 v4, s[44:45] offset:2048 sc1
    v_mfma_f32_16x16x32_bf16 v[92:95], a[12:15], v[96:99], 0
    s_waitcnt vmcnt(3)
    ds_read_b96 v[18:20], v13 offset:0
    v_mfma_f32_16x16x32_bf16 v[84:87], a[20:23], v[100:103], v[84:87]
    v_mfma_f32_16x16x32_bf16 v[88:91], a[24:27], v[100:103], v[88:91]
    v_mfma_f32_16x16x32_bf16 v[92:95], a[28:31], v[100:103], v[92:95]
    global_load_lds_dwordx4 v4, s[44:45] offset:3072 sc1
    v_mfma_f32_16x16x32_bf16 v[84:87], a[36:39], v[104:107], v[84:87]
    s_waitcnt lgkmcnt(0)
    v_max_u32 v18, v18, v20
    v_cmp_eq_u32_e64 s[20:21], -1, v18
    v_mfma_f32_16x16x32_bf16 v[88:91], a[40:43], v[104:107], v[88:91]
    s_cmp_lg_u64 s[20:21], 0
    v_mfma_f32_16x16x32_bf16 v[92:95], a[44:47], v[104:107], v[92:95]
    s_cbranch_scc1 k2_L_61S
k2_L_61B:
    v_mfma_f32_16x16x32_bf16 v[84:87], a[52:55], v[108:111], v[84:87]
    s_barrier
    v_mfma_f32_16x16x32_bf16 v[88:91], a[56:59], v[108:111], v[88:91]
    ds_read_b128 v[28:31], v2 offset:0
    ds_read_b128 v[112:115], v12 offset:12288
    v_mfma_f32_16x16x32_bf16 v[92:95], a[60:63], v[108:111], v[92:95]
    ds_read_b128 v[32:35], v2 offset:1024
    ds_read_b128 v[116:119], v12 offset:13312
    v_mfma_f32_16x16x32_bf16 v[80:83], a[0:3], v[96:99], v[140:143]
    ds_read_b128 v[36:39], v2 offset:2048
    ds_read_b128 v[120:123], v12 offset:14336
    v_mfma_f32_16x16x32_bf16 v[80:83], a[16:19], v[100:103], v[80:83]
    ds_write_b128 v9, v[84:87] offset:24576
    v_mfma_f32_16x16x32_bf16 v[80:83], a[32:35], v[104:107], v[80:83]
    v_mfma_f32_16x16x32_bf16 v[80:83], a[48:51], v[108:111], v[80:83]
    s_waitcnt lgkmcnt(6)
    v_mfma_f32_16x16x32_bf16 v[60:63], a[64:67], v[28:31], 0
    ds_read_b128 v[56:59], v2 offset:3072
    s_waitcnt lgkmcnt(6)
    v_add_f32 v136, v40, v112
    v_add_f32 v137, v41, v113
    v_mfma_f32_16x16x32_bf16 v[64:67], a[128:131], v[28:31], 0
    ds_write_b128 v10, v[88:91] offset:24576
    v_add_f32 v138, v42, v114
    v_add_f32 v139, v43, v115
    v_mfma_f32_16x16x32_bf16 v[68:71], a[192:195], v[28:31], 0
    s_waitcnt lgkmcnt(3)
    ds_write_b128 v11, v[92:95] offset:24576
    v_add_f32 v116, v116, v120
    v_add_f32 v117, v117, v121
    v_mfma_f32_16x16x32_bf16 v[60:63], a[68:71], v[32:35], v[60:63]
    ds_read_b128 v[28:31], v2 offset:4096
    v_add_f32 v118, v118, v122
    v_add_f32 v119, v119, v123
    v_mfma_f32_16x16x32_bf16 v[64:67], a[132:135], v[32:35], v[64:67]
    s_waitcnt vmcnt(0)
    ds_read_b96 v[18:20], v13 offset:16384
    v_add_f32 v136, v136, v116
    v_add_f32 v137, v137, v117
    v_mfma_f32_16x16x32_bf16 v[68:71], a[196:199], v[32:35], v[68:71]
    v_add_f32 v138, v138, v118
    v_add_f32 v139, v139, v119
    v_mfma_f32_16x16x32_bf16 v[60:63], a[72:75], v[36:39], v[60:63]
    ds_read_b128 v[32:35], v2 offset:5120
    v_cvt_pk_bf16_f32 v124, v136, v137
    v_cvt_pk_bf16_f32 v125, v138, v139
    v_mfma_f32_16x16x32_bf16 v[64:67], a[136:139], v[36:39], v[64:67]
    global_store_dwordx2 v17, v[124:125], s[40:41] sc0 sc1
    s_add_u32 s40, s40, 16384
    s_addc_u32 s41, s41, 0
    v_add_f32 v112, v136, v137
    v_mul_f32 v113, v136, v136
    v_mfma_f32_16x16x32_bf16 v[68:71], a[200:203], v[36:39], v[68:71]
    s_waitcnt lgkmcnt(1)
    v_max_u32 v18, v18, v20
    v_cmp_eq_u32_e64 s[20:21], -1, v18
    v_add_f32 v114, v138, v139
    v_fmac_f32 v113, v137, v137
    v_mfma_f32_16x16x32_bf16 v[60:63], a[76:79], v[56:59], v[60:63]
    ds_read_b128 v[36:39], v2 offset:6144
    v_add_f32 v112, v112, v114
    v_fmac_f32 v113, v138, v138
    s_cmp_lg_u64 s[20:21], 0
    v_mfma_f32_16x16x32_bf16 v[64:67], a[140:143], v[56:59], v[64:67]
    s_cbranch_scc1 k2_L_63S
k2_L_63B:
    v_fmac_f32 v113, v139, v139
    v_mfma_f32_16x16x32_bf16 v[68:71], a[204:207], v[56:59], v[68:71]
    ds_write_b64 v14, v[112:113] offset:4096
    v_mfma_f32_16x16x32_bf16 v[60:63], a[80:83], v[28:31], v[60:63]
    ds_read_b128 v[56:59], v2 offset:7168
    v_mfma_f32_16x16x32_bf16 v[64:67], a[144:147], v[28:31], v[64:67]
    s_waitcnt lgkmcnt(1)
    s_barrier
    v_mfma_f32_16x16x32_bf16 v[68:71], a[208:211], v[28:31], v[68:71]
    global_load_dwordx4 v[72:75], v1, s[46:47] offset:0 sc1
    ds_read_b128 v[96:99], v12 offset:24576
    v_mfma_f32_16x16x32_bf16 v[60:63], a[84:87], v[32:35], v[60:63]
    ds_read_b128 v[28:31], v2 offset:8192
    ds_read_b128 v[100:103], v12 offset:25600
    v_mfma_f32_16x16x32_bf16 v[64:67], a[148:151], v[32:35], v[64:67]
    ds_read_b128 v[104:107], v12 offset:26624
    v_mfma_f32_16x16x32_bf16 v[68:71], a[212:215], v[32:35], v[68:71]
    v_mfma_f32_16x16x32_bf16 v[60:63], a[88:91], v[36:39], v[60:63]
    ds_read_b128 v[32:35], v2 offset:9216
    global_load_dwordx4 v[76:79], v1, s[46:47] offset:1024 sc1
    v_mfma_f32_16x16x32_bf16 v[64:67], a[152:155], v[36:39], v[64:67]
    v_mfma_f32_16x16x32_bf16 v[68:71], a[216:219], v[36:39], v[68:71]
    s_waitcnt lgkmcnt(4)
    v_add_f32 v140, v80, v96
    v_add_f32 v141, v81, v97
    v_mfma_f32_16x16x32_bf16 v[60:63], a[92:95], v[56:59], v[60:63]
    ds_read_b128 v[36:39], v2 offset:10240
    v_add_f32 v142, v82, v98
    v_add_f32 v143, v83, v99
    v_mfma_f32_16x16x32_bf16 v[64:67], a[156:159], v[56:59], v[64:67]
    s_waitcnt lgkmcnt(2)
    v_add_f32 v100, v100, v104
    v_add_f32 v101, v101, v105
    v_mfma_f32_16x16x32_bf16 v[68:71], a[220:223], v[56:59], v[68:71]
    global_load_dwordx4 a[0:3], v5, s[64:65] offset:0
    v_add_f32 v102, v102, v106
    v_add_f32 v103, v103, v107
    v_mfma_f32_16x16x32_bf16 v[60:63], a[96:99], v[28:31], v[60:63]
    ds_read_b128 v[56:59], v2 offset:11264
    v_add_f32 v140, v140, v100
    v_add_f32 v141, v141, v101
    v_mfma_f32_16x16x32_bf16 v[64:67], a[160:163], v[28:31], v[64:67]
    v_add_f32 v142, v142, v102
    v_add_f32 v143, v143, v103
    v_mfma_f32_16x16x32_bf16 v[68:71], a[224:227], v[28:31], v[68:71]
    v_cvt_pk_bf16_f32 v108, v140, v141
    v_cvt_pk_bf16_f32 v109, v142, v143
    s_waitcnt lgkmcnt(2)
    v_mfma_f32_16x16x32_bf16 v[60:63], a[100:103], v[32:35], v[60:63]
    ds_read_b128 v[28:31], v2 offset:12288
    global_load_dwordx4 a[4:7], v5, s[64:65] offset:1024
    v_mfma_f32_16x16x32_bf16 v[64:67], a[164:167], v[32:35], v[64:67]
    global_store_dwordx2 v17, v[108:109], s[40:41] sc0 sc1
    v_add_f32 v96, v140, v141
    v_mul_f32 v97, v140, v140
    v_mfma_f32_16x16x32_bf16 v[68:71], a[228:231], v[32:35], v[68:71]
    v_add_f32 v98, v142, v143
    v_fmac_f32 v97, v141, v141
    s_waitcnt lgkmcnt(2)
    v_mfma_f32_16x16x32_bf16 v[60:63], a[104:107], v[36:39], v[60:63]
    ds_read_b128 v[32:35], v2 offset:13312
    v_add_f32 v96, v96, v98
    v_fmac_f32 v97, v142, v142
    v_mfma_f32_16x16x32_bf16 v[64:67], a[168:171], v[36:39], v[64:67]
    v_fmac_f32 v97, v143, v143
    v_mfma_f32_16x16x32_bf16 v[68:71], a[232:235], v[36:39], v[68:71]
    s_waitcnt lgkmcnt(2)
    v_mfma_f32_16x16x32_bf16 v[60:63], a[108:111], v[56:59], v[60:63]
    ds_read_b128 v[36:39], v2 offset:14336
    global_load_dwordx4 a[8:11], v5, s[64:65] offset:2048
    ds_write_b64 v14, v[96:97] offset:4224
    v_mfma_f32_16x16x32_bf16 v[64:67], a[172:175], v[56:59], v[64:67]
    s_waitcnt vmcnt(4)
    v_max3_u32 v104, v72, v73, v74
    v_max3_u32 v108, v75, v76, v77
    v_max3_u32 v104, v104, v78, v79
    v_max_u32 v104, v104, v108
    v_cmp_eq_u32_e64 s[24:25], -1, v104
    v_mfma_f32_16x16x32_bf16 v[68:71], a[236:239], v[56:59], v[68:71]
    s_waitcnt lgkmcnt(0)
    s_barrier
    s_cmp_lg_u64 s[24:25], 0
    v_mfma_f32_16x16x32_bf16 v[60:63], a[112:115], v[28:31], v[60:63]
    s_cbranch_scc1 k2_L_73S
k2_L_73B:
    ds_read_b128 v[56:59], v2 offset:15360
    v_add_f32 v72, v72, v74
    v_add_f32 v73, v73, v75
    v_add_f32 v76, v76, v78
    v_mfma_f32_16x16x32_bf16 v[64:67], a[176:179], v[28:31], v[64:67]
    ds_read2_b64 v[96:99], v15 offset0:0 offset1:32
    v_add_f32 v77, v77, v79
    v_mfma_f32_16x16x32_bf16 v[68:71], a[240:243], v[28:31], v[68:71]
    ds_read2_b64 v[100:103], v15 offset0:64 offset1:96
    v_add_f32 v72, v72, v76
    v_mfma_f32_16x16x32_bf16 v[60:63], a[116:119], v[32:35], v[60:63]
    ds_read_b128 v[28:31], v2 offset:16384
    global_load_dwordx4 a[12:15], v5, s[64:65] offset:3072
    v_add_f32 v73, v73, v77
    v_mfma_f32_16x16x32_bf16 v[64:67], a[180:183], v[32:35], v[64:67]
    s_add_u32 m0, s30, 32768
    v_permlane32_swap_b32 v72, v73
    v_mfma_f32_16x16x32_bf16 v[68:71], a[244:247], v[32:35], v[68:71]
    v_add_f32 v72, v72, v73
    v_mov_b32 v73, v72
    v_mfma_f32_16x16x32_bf16 v[60:63], a[120:123], v[36:39], v[60:63]
    ds_read_b128 v[32:35], v2 offset:17408
    v_permlane32_swap_b32 v72, v73
    v_mfma_f32_16x16x32_bf16 v[64:67], a[184:187], v[36:39], v[64:67]
    s_waitcnt lgkmcnt(2)
    global_load_lds_dwordx4 v6, s[44:45] offset:0 sc1
    v_mul_f32 v72, 0xbb000000, v72
    v_mul_f32 v73, 0x3b000000, v73
    v_fma_f32 v73, -v72, v72, v73
    v_add_f32 v96, v96, v98
    v_add_f32 v97, v97, v99
    v_add_f32 v100, v100, v102
    v_add_f32 v101, v101, v103
    v_add_f32 v96, v96, v100
    v_add_f32 v97, v97, v101
    v_mfma_f32_16x16x32_bf16 v[68:71], a[248:251], v[36:39], v[68:71]
    v_max_f32 v73, 0, v73
    v_add_f32 v73, 0x3727c5ac, v73
    v_permlane32_swap_b32 v96, v97
    v_mfma_f32_16x16x32_bf16 v[60:63], a[124:127], v[56:59], v[60:63]
    ds_read_b128 v[36:39], v2 offset:18432
    global_load_lds_dwordx4 v6, s[44:45] offset:1024 sc1
    v_mfma_f32_16x16x32_bf16 v[64:67], a[188:191], v[56:59], v[64:67]
    v_rsq_f32 v73, v73
    v_mfma_f32_16x16x32_bf16 v[68:71], a[252:255], v[56:59], v[68:71]
    v_mul_f32 v104, s32, v73
    v_mov_b32 v105, v104
    v_add_f32 v96, v96, v97
    s_waitcnt lgkmcnt(2)
    v_mfma_f32_16x16x32_bf16 v[44:47], a[64:67], v[28:31], 0
    ds_read_b128 v[56:59], v2 offset:19456
    v_mul_f32 v108, v72, v104
    v_mov_b32 v109, v108
    v_mfma_f32_16x16x32_bf16 v[48:51], a[128:131], v[28:31], 0
    global_load_lds_dwordx4 v6, s[44:45] offset:2048 sc1
    v_mov_b32 v97, v96
    v_permlane16_swap_b32 v104, v105
    v_mfma_f32_16x16x32_bf16 v[52:55], a[192:195], v[28:31], 0
    v_permlane16_swap_b32 v108, v109
    s_waitcnt lgkmcnt(2)
    v_mfma_f32_16x16x32_bf16 v[44:47], a[68:71], v[32:35], v[44:47]
    ds_read_b128 v[28:31], v2 offset:20480
    v_cmp_u_f32_e64 s[18:19], v60, v60
    v_mfma_f32_16x16x32_bf16 v[48:51], a[132:135], v[32:35], v[48:51]
    v_permlane16_swap_b32 v96, v97
    s_cmp_lg_u64 s[18:19], 0
    v_mfma_f32_16x16x32_bf16 v[52:55], a[196:199], v[32:35], v[52:55]
    s_cbranch_scc1 k2_L_77S
k2_L_77B:
    global_load_dwordx4 a[16:19], v6, s[64:65] offset:-4096
    v_mul_f32 v60, v60, v104
    v_mul_f32 v61, v61, v104
    v_mul_f32 v62, v62, v104
    v_mul_f32 v63, v63, v104
    v_fmac_f32 v60, v244, v108
    v_fmac_f32 v61, v245, v108
    v_fmac_f32 v62, v246, v108
    s_waitcnt lgkmcnt(2)
    v_mfma_f32_16x16x32_bf16 v[44:47], a[72:75], v[36:39], v[44:47]
    ds_read_b128 v[32:35], v2 offset:21504
    v_add_f32 v96, v96, v97
    v_fmac_f32 v63, v247, v108
    v_mul_f32 v64, v64, v104
    v_mfma_f32_16x16x32_bf16 v[48:51], a[136:139], v[36:39], v[48:51]
    global_store_dword v21, v96, s[42:43] offset:512 sc0 sc1
    v_mul_f32 v65, v65, v104
    v_mfma_f32_16x16x32_bf16 v[52:55], a[200:203], v[36:39], v[52:55]
    global_load_lds_dwordx4 v6, s[44:45] offset:3072 sc1
    v_mul_f32 v66, v66, v104
    v_mul_f32 v67, v67, v104
    s_waitcnt lgkmcnt(2)
    v_mfma_f32_16x16x32_bf16 v[44:47], a[76:79], v[56:59], v[44:47]
    ds_read_b128 v[36:39], v2 offset:22528
    v_fmac_f32 v64, v248, v108
    v_mfma_f32_16x16x32_bf16 v[48:51], a[140:143], v[56:59], v[48:51]
    v_exp_f32 v84, v60
    v_fmac_f32 v65, v249, v108
    v_mfma_f32_16x16x32_bf16 v[52:55], a[204:207], v[56:59], v[52:55]
    v_fma_f32 v84, v84, s32, s32
    v_fmac_f32 v66, v250, v108
    s_waitcnt lgkmcnt(2)
    v_mfma_f32_16x16x32_bf16 v[44:47], a[80:83], v[28:31], v[44:47]
    ds_read_b128 v[56:59], v2 offset:23552
    global_load_dwordx4 a[20:23], v6, s[64:65] offset:-3072
    v_fmac_f32 v67, v251, v108
    v_mfma_f32_16x16x32_bf16 v[48:51], a[144:147], v[28:31], v[48:51]
    v_exp_f32 v85, v61
    v_mul_f32 v68, v68, v104
    v_mfma_f32_16x16x32_bf16 v[52:55], a[208:211], v[28:31], v[52:55]
    v_and_b32 v14, 0xf0, v2
    v_fma_f32 v85, v85, s32, s32
    s_waitcnt lgkmcnt(2)
    v_mfma_f32_16x16x32_bf16 v[44:47], a[84:87], v[32:35], v[44:47]
    ds_read_b128 v[28:31], v2 offset:24576
    v_mul_f32 v69, v69, v104
    v_mul_f32 v70, v70, v104
    v_mfma_f32_16x16x32_bf16 v[48:51], a[148:151], v[32:35], v[48:51]
    global_load_dwordx4 a[24:27], v6, s[64:65] offset:-2048
    v_mul_f32 v71, v71, v104
    v_mfma_f32_16x16x32_bf16 v[52:55], a[212:215], v[32:35], v[52:55]
    v_fmac_f32 v68, v252, v108
    v_fmac_f32 v69, v253, v108
    s_waitcnt lgkmcnt(2)
    v_mfma_f32_16x16x32_bf16 v[44:47], a[88:91], v[36:39], v[44:47]
    ds_read_b128 v[32:35], v2 offset:25600
    v_fmac_f32 v70, v254, v108
    v_mfma_f32_16x16x32_bf16 v[48:51], a[152:155], v[36:39], v[48:51]
    v_exp_f32 v86, v62
    v_fmac_f32 v71, v255, v108
    v_mfma_f32_16x16x32_bf16 v[52:55], a[216:219], v[36:39], v[52:55]
    s_add_u32 m0, s30, 49152
    v_fma_f32 v86, v86, s32, s32
    s_waitcnt lgkmcnt(2)
    v_mfma_f32_16x16x32_bf16 v[44:47], a[92:95], v[56:59], v[44:47]
    ds_read_b128 v[36:39], v2 offset:26624
    global_load_lds_dwordx4 v8, s[44:45] offset:0 sc1
    v_exp_f32 v87, v63
    v_rcp_f32 v84, v84
    v_mfma_f32_16x16x32_bf16 v[48:51], a[156:159], v[56:59], v[48:51]
    v_rcp_f32 v85, v85
    v_fma_f32 v87, v87, s32, s32
    v_mfma_f32_16x16x32_bf16 v[52:55], a[220:223], v[56:59], v[52:55]
    v_mul_f32 v60, v60, v84
    s_waitcnt lgkmcnt(2)
    v_mfma_f32_16x16x32_bf16 v[44:47], a[96:99], v[28:31], v[44:47]
    ds_read_b128 v[56:59], v2 offset:27648
    global_load_lds_dwordx4 v8, s[44:45] offset:1024 sc1
    v_mul_f32 v61, v61, v85
    v_cvt_pk_bf16_f32 v124, v60, v61
    v_mfma_f32_16x16x32_bf16 v[48:51], a[160:163], v[28:31], v[48:51]
    v_rcp_f32 v86, v86
    v_bfe_u32 v0, v2, 8, 1
    v_lshl_add_u32 v14, v0, 3, v14
    v_mfma_f32_16x16x32_bf16 v[52:55], a[224:227], v[28:31], v[52:55]
    s_waitcnt vmcnt(4)
    v_mul_f32 v62, v62, v86
    v_rcp_f32 v87, v87
    s_waitcnt lgkmcnt(2)
    v_mfma_f32_16x16x32_bf16 v[44:47], a[100:103], v[32:35], v[44:47]
    ds_read_b128 v[28:31], v2 offset:28672
    global_load_lds_dwordx4 v8, s[44:45] offset:2048 sc1
    v_mul_f32 v63, v63, v87
    v_mfma_f32_16x16x32_bf16 v[48:51], a[164:167], v[32:35], v[48:51]
    ds_read_b96 v[18:20], v13 offset:32768
    v_cvt_pk_bf16_f32 v125, v62, v63
    v_exp_f32 v88, v64
    v_mfma_f32_16x16x32_bf16 v[52:55], a[228:231], v[32:35], v[52:55]
    v_fma_f32 v88, v88, s32, s32
    s_waitcnt lgkmcnt(3)
    v_mfma_f32_16x16x32_bf16 v[44:47], a[104:107], v[36:39], v[44:47]
    ds_read_b128 v[32:35], v2 offset:29696
    global_load_lds_dwordx4 v8, s[44:45] offset:3072 sc1
    v_exp_f32 v89, v65
    v_exp_f32 v90, v66
    v_mfma_f32_16x16x32_bf16 v[48:51], a[168:171], v[36:39], v[48:51]
    v_exp_f32 v91, v67
    v_fma_f32 v89, v89, s32, s32
    v_mfma_f32_16x16x32_bf16 v[52:55], a[232:235], v[36:39], v[52:55]
    s_waitcnt lgkmcnt(1)
    v_rcp_f32 v88, v88
    v_max_u32 v18, v18, v20
    v_cmp_eq_u32_e64 s[20:21], -1, v18
    v_mfma_f32_16x16x32_bf16 v[44:47], a[108:111], v[56:59], v[44:47]
    ds_read_b128 v[36:39], v2 offset:30720
    global_load_dwordx4 a[28:31], v6, s[64:65] offset:-1024
    v_fma_f32 v90, v90, s32, s32
    v_fma_f32 v91, v91, s32, s32
    s_cmp_lg_u64 s[20:21], 0
    v_mfma_f32_16x16x32_bf16 v[48:51], a[172:175], v[56:59], v[48:51]
    s_cbranch_scc1 k2_L_69S
k2_L_69B:
    v_mul_f32 v64, v64, v88
    v_mfma_f32_16x16x32_bf16 v[52:55], a[236:239], v[56:59], v[52:55]
    s_barrier
    v_rcp_f32 v89, v89
    v_rcp_f32 v90, v90
    v_mfma_f32_16x16x32_bf16 v[44:47], a[112:115], v[28:31], v[44:47]
    ds_read_b128 v[56:59], v2 offset:31744
    global_load_dwordx4 v[96:99], v1, s[46:47] offset:512 sc1
    v_lshrrev_b32 v0, 9, v2
    v_lshl_add_u32 v14, v0, 8, v14
    v_mul_f32 v65, v65, v89
    v_mfma_f32_16x16x32_bf16 v[48:51], a[176:179], v[28:31], v[48:51]
    v_rcp_f32 v91, v91
    v_mul_f32 v66, v66, v90
    v_mfma_f32_16x16x32_bf16 v[52:55], a[240:243], v[28:31], v[52:55]
    v_mul_f32 v67, v67, v91
    s_waitcnt lgkmcnt(2)
    v_mfma_f32_16x16x32_bf16 v[44:47], a[116:119], v[32:35], v[44:47]
    ds_read_b128 v[28:31], v2 offset:32768
    global_load_dwordx4 v[100:103], v1, s[46:47] offset:1536 sc1
    v_cvt_pk_bf16_f32 v126, v64, v65
    v_cvt_pk_bf16_f32 v127, v66, v67
    v_mfma_f32_16x16x32_bf16 v[48:51], a[180:183], v[32:35], v[48:51]
    global_store_dwordx4 v2, v[124:127], s[48:49] offset:0 sc0 sc1
    v_exp_f32 v92, v68
    v_mfma_f32_16x16x32_bf16 v[52:55], a[244:247], v[32:35], v[52:55]
    v_fma_f32 v92, v92, s32, s32
    v_exp_f32 v93, v69
    s_waitcnt lgkmcnt(2)
    v_mfma_f32_16x16x32_bf16 v[44:47], a[120:123], v[36:39], v[44:47]
    ds_read_b128 v[32:35], v2 offset:33792
    v_fma_f32 v93, v93, s32, s32
    v_exp_f32 v94, v70
    v_mfma_f32_16x16x32_bf16 v[48:51], a[184:187], v[36:39], v[48:51]
    v_exp_f32 v95, v71
    v_mfma_f32_16x16x32_bf16 v[52:55], a[248:251], v[36:39], v[52:55]
    s_waitcnt vmcnt(4)
    v_fma_f32 v94, v94, s32, s32
    v_fma_f32 v95, v95, s32, s32
    s_waitcnt lgkmcnt(2)
    v_mfma_f32_16x16x32_bf16 v[44:47], a[124:127], v[56:59], v[44:47]
    ds_read_b128 v[36:39], v2 offset:34816
    global_load_dwordx4 a[32:35], v6, s[64:65] offset:0
    v_rcp_f32 v92, v92
    v_mfma_f32_16x16x32_bf16 v[48:51], a[188:191], v[56:59], v[48:51]
    ds_read_b96 v[18:20], v13 offset:49152
    v_mul_f32 v68, v68, v92
    v_rcp_f32 v93, v93
    v_mfma_f32_16x16x32_bf16 v[52:55], a[252:255], v[56:59], v[52:55]
    v_mul_f32 v69, v69, v93
    s_waitcnt lgkmcnt(3)
    v_mfma_f32_16x16x32_bf16 v[72:75], a[64:67], v[28:31], 0
    ds_read_b128 v[56:59], v2 offset:35840
    global_load_dwordx4 a[36:39], v6, s[64:65] offset:1024
    v_cvt_pk_bf16_f32 v22, v68, v69
    v_rcp_f32 v94, v94
    v_mfma_f32_16x16x32_bf16 v[76:79], a[128:131], v[28:31], 0
    v_rcp_f32 v95, v95
    v_mfma_f32_16x16x32_bf16 v[80:83], a[192:195], v[28:31], 0
    s_waitcnt lgkmcnt(1)
    v_mul_f32 v70, v70, v94
    v_mul_f32 v71, v71, v95
    v_max_u32 v18, v18, v20
    v_mfma_f32_16x16x32_bf16 v[72:75], a[68:71], v[32:35], v[72:75]
    ds_read_b128 v[28:31], v2 offset:36864
    v_cvt_pk_bf16_f32 v23, v70, v71
    v_cmp_eq_u32_e64 s[20:21], -1, v18
    v_mfma_f32_16x16x32_bf16 v[76:79], a[132:135], v[32:35], v[76:79]
    global_store_dwordx2 v14, v[22:23], s[50:51] offset:0 sc0 sc1
    v_cmp_u_f32_e64 s[18:19], v44, v44
    s_cmp_lg_u64 s[20:21], 0
    v_mfma_f32_16x16x32_bf16 v[80:83], a[196:199], v[32:35], v[80:83]
    s_cbranch_scc1 k2_L_71S
k2_L_71B:
    s_cmp_lg_u64 s[18:19], 0
    v_mfma_f32_16x16x32_bf16 v[72:75], a[72:75], v[36:39], v[72:75]
    s_cbranch_scc1 k2_L_79S
k2_L_79B:
    ds_read_b128 v[32:35], v2 offset:37888
    v_mul_f32 v44, v44, v105
    v_mul_f32 v45, v45, v105
    v_mul_f32 v46, v46, v105
    v_mul_f32 v47, v47, v105
    v_fmac_f32 v44, v244, v109
    v_fmac_f32 v45, v245, v109
    v_fmac_f32 v46, v246, v109
    v_fmac_f32 v47, v247, v109
    v_mul_f32 v48, v48, v105
    v_mul_f32 v49, v49, v105
    v_mul_f32 v50, v50, v105
    global_load_dwordx4 a[40:43], v6, s[64:65] offset:2048
    v_mfma_f32_16x16x32_bf16 v[76:79], a[136:139], v[36:39], v[76:79]
    v_exp_f32 v84, v44
    v_mfma_f32_16x16x32_bf16 v[80:83], a[200:203], v[36:39], v[80:83]
    v_fma_f32 v84, v84, s32, s32
    v_mul_f32 v51, v51, v105
    s_waitcnt lgkmcnt(2)
    v_mfma_f32_16x16x32_bf16 v[72:75], a[76:79], v[56:59], v[72:75]
    ds_read_b128 v[36:39], v2 offset:38912
    global_load_dwordx4 a[44:47], v6, s[64:65] offset:3072
    v_fmac_f32 v48, v248, v109
    v_fmac_f32 v49, v249, v109
    v_mfma_f32_16x16x32_bf16 v[76:79], a[140:143], v[56:59], v[76:79]
    v_exp_f32 v85, v45
    v_fmac_f32 v50, v250, v109
    v_mfma_f32_16x16x32_bf16 v[80:83], a[204:207], v[56:59], v[80:83]
    v_fma_f32 v85, v85, s32, s32
    v_fmac_f32 v51, v251, v109
    s_waitcnt lgkmcnt(2)
    v_mfma_f32_16x16x32_bf16 v[72:75], a[80:83], v[28:31], v[72:75]
    ds_read_b128 v[56:59], v2 offset:39936
    v_mul_f32 v52, v52, v105
    v_mul_f32 v53, v53, v105
    v_mfma_f32_16x16x32_bf16 v[76:79], a[144:147], v[28:31], v[76:79]
    global_load_dwordx4 a[48:51], v7, s[64:65] offset:-4096
    v_mul_f32 v54, v54, v105
    v_mfma_f32_16x16x32_bf16 v[80:83], a[208:211], v[28:31], v[80:83]
    v_mul_f32 v55, v55, v105
    v_fmac_f32 v52, v252, v109
    s_waitcnt lgkmcnt(2)
    v_mfma_f32_16x16x32_bf16 v[72:75], a[84:87], v[32:35], v[72:75]
    ds_read_b128 v[28:31], v2 offset:40960
    v_fmac_f32 v53, v253, v109
    v_fmac_f32 v54, v254, v109
    v_mfma_f32_16x16x32_bf16 v[76:79], a[148:151], v[32:35], v[76:79]
    v_exp_f32 v86, v46
    v_fmac_f32 v55, v255, v109
    v_mfma_f32_16x16x32_bf16 v[80:83], a[212:215], v[32:35], v[80:83]
    v_fma_f32 v86, v86, s32, s32
    v_exp_f32 v87, v47
    s_waitcnt lgkmcnt(2)
    v_mfma_f32_16x16x32_bf16 v[72:75], a[88:91], v[36:39], v[72:75]
    ds_read_b128 v[32:35], v2 offset:41984
    global_load_dwordx4 a[52:55], v7, s[64:65] offset:-3072
    v_fma_f32 v87, v87, s32, s32
    v_rcp_f32 v84, v84
    v_mfma_f32_16x16x32_bf16 v[76:79], a[152:155], v[36:39], v[76:79]
    v_rcp_f32 v85, v85
    v_mfma_f32_16x16x32_bf16 v[80:83], a[216:219], v[36:39], v[80:83]
    v_mul_f32 v44, v44, v84
    v_mul_f32 v45, v45, v85
    s_waitcnt lgkmcnt(2)
    v_mfma_f32_16x16x32_bf16 v[72:75], a[92:95], v[56:59], v[72:75]
    ds_read_b128 v[36:39], v2 offset:43008
    v_cvt_pk_bf16_f32 v124, v44, v45
    v_rcp_f32 v86, v86
    v_mfma_f32_16x16x32_bf16 v[76:79], a[156:159], v[56:59], v[76:79]
    v_rcp_f32 v87, v87
    v_mul_f32 v46, v46, v86
    v_mfma_f32_16x16x32_bf16 v[80:83], a[220:223], v[56:59], v[80:83]
    global_load_dwordx4 a[56:59], v7, s[64:65] offset:-2048
    v_mul_f32 v47, v47, v87
    v_cvt_pk_bf16_f32 v125, v46, v47
    s_waitcnt lgkmcnt(2)
    v_mfma_f32_16x16x32_bf16 v[72:75], a[96:99], v[28:31], v[72:75]
    ds_read_b128 v[56:59], v2 offset:44032
    s_waitcnt vmcnt(9)
    v_max3_u32 v106, v96, v97, v98
    v_max3_u32 v110, v99, v100, v101
    v_exp_f32 v88, v48
    v_exp_f32 v89, v49
    v_mfma_f32_16x16x32_bf16 v[76:79], a[160:163], v[28:31], v[76:79]
    v_exp_f32 v90, v50
    v_max3_u32 v106, v106, v102, v103
    v_mfma_f32_16x16x32_bf16 v[80:83], a[224:227], v[28:31], v[80:83]
    v_fma_f32 v88, v88, s32, s32
    v_fma_f32 v89, v89, s32, s32
    v_max_u32 v106, v106, v110
    s_waitcnt lgkmcnt(2)
    v_mfma_f32_16x16x32_bf16 v[72:75], a[100:103], v[32:35], v[72:75]
    ds_read_b128 v[28:31], v2 offset:45056
    global_load_dwordx4 a[60:63], v7, s[64:65] offset:-1024
    v_fma_f32 v90, v90, s32, s32
    v_cmp_eq_u32_e64 s[24:25], -1, v106
    v_exp_f32 v91, v51
    v_mfma_f32_16x16x32_bf16 v[76:79], a[164:167], v[32:35], v[76:79]
    v_rcp_f32 v88, v88
    v_fma_f32 v91, v91, s32, s32
    s_cmp_lg_u64 s[24:25], 0
    v_mfma_f32_16x16x32_bf16 v[80:83], a[228:231], v[32:35], v[80:83]
    s_cbranch_scc1 k2_L_75S
k2_L_75B:
    v_mul_f32 v48, v48, v88
    v_add_f32 v96, v96, v98
    v_add_f32 v97, v97, v99
    v_rcp_f32 v89, v89
    s_waitcnt lgkmcnt(2)
    v_mfma_f32_16x16x32_bf16 v[72:75], a[104:107], v[36:39], v[72:75]
    ds_read_b128 v[32:35], v2 offset:46080
    v_mul_f32 v49, v49, v89
    v_cvt_pk_bf16_f32 v126, v48, v49
    v_add_f32 v100, v100, v102
    v_mfma_f32_16x16x32_bf16 v[76:79], a[168:171], v[36:39], v[76:79]
    v_rcp_f32 v90, v90
    v_add_f32 v101, v101, v103
    v_mfma_f32_16x16x32_bf16 v[80:83], a[232:235], v[36:39], v[80:83]
    s_barrier
    v_mul_f32 v50, v50, v90
    v_add_f32 v96, v96, v100
    v_rcp_f32 v91, v91
    s_waitcnt lgkmcnt(2)
    v_mfma_f32_16x16x32_bf16 v[72:75], a[108:111], v[56:59], v[72:75]
    ds_read_b128 v[36:39], v2 offset:47104
    global_load_dwordx4 v[112:115], v5, s[64:65] offset:-3072
    v_mul_f32 v51, v51, v91
    v_cvt_pk_bf16_f32 v127, v50, v51
    v_add_f32 v97, v97, v101
    v_mfma_f32_16x16x32_bf16 v[76:79], a[172:175], v[56:59], v[76:79]
    global_store_dwordx4 v2, v[124:127], s[48:49] offset:1024 sc0 sc1
    v_exp_f32 v92, v52
    v_exp_f32 v93, v53
    v_permlane32_swap_b32 v96, v97
    v_mfma_f32_16x16x32_bf16 v[80:83], a[236:239], v[56:59], v[80:83]
    v_fma_f32 v92, v92, s32, s32
    v_fma_f32 v93, v93, s32, s32
    v_add_f32 v96, v96, v97
    s_waitcnt lgkmcnt(2)
    v_mfma_f32_16x16x32_bf16 v[72:75], a[112:115], v[28:31], v[72:75]
    ds_read_b128 v[56:59], v2 offset:48128
    v_mov_b32 v97, v96
    v_exp_f32 v94, v54
    v_exp_f32 v95, v55
    v_permlane32_swap_b32 v96, v97
    v_mfma_f32_16x16x32_bf16 v[76:79], a[176:179], v[28:31], v[76:79]
    global_load_dwordx4 v[116:119], v5, s[64:65] offset:-2048
    v_fma_f32 v94, v94, s32, s32
    v_mul_f32 v96, 0xbb000000, v96
    v_mfma_f32_16x16x32_bf16 v[80:83], a[240:243], v[28:31], v[80:83]
    v_fma_f32 v95, v95, s32, s32
    v_mul_f32 v97, 0x3b000000, v97
    v_rcp_f32 v92, v92
    s_waitcnt lgkmcnt(2)
    v_mfma_f32_16x16x32_bf16 v[72:75], a[116:119], v[32:35], v[72:75]
    ds_read_b128 v[28:31], v2 offset:49152
    v_mul_f32 v52, v52, v92
    v_fma_f32 v97, -v96, v96, v97
    v_rcp_f32 v93, v93
    v_mfma_f32_16x16x32_bf16 v[76:79], a[180:183], v[32:35], v[76:79]
    v_rcp_f32 v94, v94
    v_mul_f32 v53, v53, v93
    v_max_f32 v97, 0, v97
    v_mfma_f32_16x16x32_bf16 v[80:83], a[244:247], v[32:35], v[80:83]
    global_load_dwordx4 v[120:123], v5, s[64:65] offset:-1024
    v_mul_f32 v54, v54, v94
    v_cvt_pk_bf16_f32 v22, v52, v53
    v_add_f32 v97, 0x3727c5ac, v97
    s_waitcnt lgkmcnt(2)
    v_mfma_f32_16x16x32_bf16 v[72:75], a[120:123], v[36:39], v[72:75]
    ds_read_b128 v[32:35], v2 offset:50176
    v_rcp_f32 v95, v95
    v_rsq_f32 v97, v97
    v_mfma_f32_16x16x32_bf16 v[76:79], a[184:187], v[36:39], v[76:79]
    v_mul_f32 v55, v55, v95
    v_cvt_pk_bf16_f32 v23, v54, v55
    v_mul_f32 v106, s32, v97
    v_mfma_f32_16x16x32_bf16 v[80:83], a[248:251], v[36:39], v[80:83]
    v_mov_b32 v107, v106
    global_store_dwordx2 v14, v[22:23], s[50:51] offset:1024 sc0 sc1
    s_waitcnt lgkmcnt(2)
    v_mfma_f32_16x16x32_bf16 v[72:75], a[124:127], v[56:59], v[72:75]
    ds_read_b128 v[36:39], v2 offset:51200
    v_mul_f32 v110, v96, v106
    v_mfma_f32_16x16x32_bf16 v[76:79], a[188:191], v[56:59], v[76:79]
    v_mov_b32 v111, v110
    v_mfma_f32_16x16x32_bf16 v[80:83], a[252:255], v[56:59], v[80:83]
    v_permlane16_swap_b32 v106, v107
    s_waitcnt lgkmcnt(2)
    v_mfma_f32_16x16x32_bf16 v[60:63], a[64:67], v[28:31], 0
    ds_read_b128 v[56:59], v2 offset:52224
    v_permlane16_swap_b32 v110, v111
    v_mfma_f32_16x16x32_bf16 v[64:67], a[128:131], v[28:31], 0
    v_cmp_u_f32_e64 s[18:19], v72, v72
    v_mfma_f32_16x16x32_bf16 v[68:71], a[192:195], v[28:31], 0
    s_cmp_lg_u64 s[18:19], 0
    s_waitcnt lgkmcnt(2)
    v_mfma_f32_16x16x32_bf16 v[60:63], a[68:71], v[32:35], v[60:63]
    s_cbranch_scc1 k2_L_81S
k2_L_81B:
    ds_read_b128 v[28:31], v2 offset:53248
    v_mul_f32 v72, v72, v106
    v_mul_f32 v73, v73, v106
    v_mul_f32 v74, v74, v106
    v_mul_f32 v75, v75, v106
    v_fmac_f32 v72, v244, v110
    v_mfma_f32_16x16x32_bf16 v[64:67], a[132:135], v[32:35], v[64:67]
    v_exp_f32 v84, v72
    v_fmac_f32 v73, v245, v110
    v_mfma_f32_16x16x32_bf16 v[68:71], a[196:199], v[32:35], v[68:71]
    v_fmac_f32 v74, v246, v110
    v_fmac_f32 v75, v247, v110
    s_waitcnt lgkmcnt(2)
    v_mfma_f32_16x16x32_bf16 v[60:63], a[72:75], v[36:39], v[60:63]
    ds_read_b128 v[32:35], v2 offset:54272
    v_fma_f32 v84, v84, s32, s32
    v_mul_f32 v76, v76, v106
    v_bfe_u32 v0, v2, 8, 2
    v_lshlrev_b32 v0, 4, v0
    v_xor_b32 v12, v0, v2
    v_mfma_f32_16x16x32_bf16 v[64:67], a[136:139], v[36:39], v[64:67]
    v_exp_f32 v85, v73
    v_mfma_f32_16x16x32_bf16 v[68:71], a[200:203], v[36:39], v[68:71]
    v_fma_f32 v85, v85, s32, s32
    v_mul_f32 v77, v77, v106
    s_waitcnt lgkmcnt(2)
    v_mfma_f32_16x16x32_bf16 v[60:63], a[76:79], v[56:59], v[60:63]
    ds_read_b128 v[36:39], v2 offset:55296
    v_mul_f32 v78, v78, v106
    v_mul_f32 v79, v79, v106
    v_mfma_f32_16x16x32_bf16 v[64:67], a[140:143], v[56:59], v[64:67]
    v_exp_f32 v86, v74
    v_fmac_f32 v76, v248, v110
    v_mfma_f32_16x16x32_bf16 v[68:71], a[204:207], v[56:59], v[68:71]
    v_fma_f32 v86, v86, s32, s32
    v_fmac_f32 v77, v249, v110
    s_waitcnt lgkmcnt(2)
    v_mfma_f32_16x16x32_bf16 v[60:63], a[80:83], v[28:31], v[60:63]
    ds_read_b128 v[56:59], v2 offset:56320
    v_fmac_f32 v78, v250, v110
    v_fmac_f32 v79, v251, v110
    v_mfma_f32_16x16x32_bf16 v[64:67], a[144:147], v[28:31], v[64:67]
    v_exp_f32 v87, v75
    v_mfma_f32_16x16x32_bf16 v[68:71], a[208:211], v[28:31], v[68:71]
    global_load_dword v18, v16, s[52:53] offset:-3600 sc1
    v_fma_f32 v87, v87, s32, s32
    v_mul_f32 v80, v80, v106
    s_waitcnt lgkmcnt(2)
    v_mfma_f32_16x16x32_bf16 v[60:63], a[84:87], v[32:35], v[60:63]
    ds_read_b128 v[28:31], v2 offset:57344
    global_load_dwordx4 a[64:67], v2, s[52:53] offset:-4096 sc1
    v_mul_f32 v81, v81, v106
    v_mul_f32 v82, v82, v106
    v_mfma_f32_16x16x32_bf16 v[64:67], a[148:151], v[32:35], v[64:67]
    v_rcp_f32 v84, v84
    v_mul_f32 v83, v83, v106
    v_mfma_f32_16x16x32_bf16 v[68:71], a[212:215], v[32:35], v[68:71]
    global_load_dwordx4 a[128:131], v2, s[52:53] offset:0 sc1
    v_mul_f32 v72, v72, v84
    v_fmac_f32 v80, v252, v110
    v_and_b32 v15, 0x70, v12
    s_waitcnt lgkmcnt(2)
    v_mfma_f32_16x16x32_bf16 v[60:63], a[88:91], v[36:39], v[60:63]
    ds_read_b128 v[32:35], v2 offset:58368
    v_fmac_f32 v81, v253, v110
    v_fmac_f32 v82, v254, v110
    v_mfma_f32_16x16x32_bf16 v[64:67], a[152:155], v[36:39], v[64:67]
    global_load_dwordx4 a[192:195], v3, s[52:53] offset:-4096 sc1
    v_fmac_f32 v83, v255, v110
    v_mfma_f32_16x16x32_bf16 v[68:71], a[216:219], v[36:39], v[68:71]
    v_rcp_f32 v85, v85
    v_rcp_f32 v86, v86
    s_waitcnt lgkmcnt(2)
    v_mfma_f32_16x16x32_bf16 v[60:63], a[92:95], v[56:59], v[60:63]
    ds_read_b128 v[36:39], v2 offset:59392
    global_load_dwordx4 a[68:71], v3, s[52:53] offset:0 sc1
    v_mul_f32 v73, v73, v85
    v_mul_f32 v74, v74, v86
    v_mfma_f32_16x16x32_bf16 v[64:67], a[156:159], v[56:59], v[64:67]
    v_rcp_f32 v87, v87
    v_cvt_pk_bf16_f32 v124, v72, v73
    v_mfma_f32_16x16x32_bf16 v[68:71], a[220:223], v[56:59], v[68:71]
    global_load_dwordx4 a[132:135], v4, s[52:53] offset:-4096 sc1
    v_mul_f32 v75, v75, v87
    v_cvt_pk_bf16_f32 v125, v74, v75
    s_waitcnt lgkmcnt(2)
    v_mfma_f32_16x16x32_bf16 v[60:63], a[96:99], v[28:31], v[60:63]
    ds_read_b128 v[56:59], v2 offset:60416
    v_exp_f32 v88, v76
    v_exp_f32 v89, v77
    v_mfma_f32_16x16x32_bf16 v[64:67], a[160:163], v[28:31], v[64:67]
    global_load_dwordx4 a[196:199], v4, s[52:53] offset:0 sc1
    v_fma_f32 v88, v88, s32, s32
    v_mfma_f32_16x16x32_bf16 v[68:71], a[224:227], v[28:31], v[68:71]
    v_fma_f32 v89, v89, s32, s32
    v_exp_f32 v90, v78
    s_waitcnt lgkmcnt(2)
    v_mfma_f32_16x16x32_bf16 v[60:63], a[100:103], v[32:35], v[60:63]
    ds_read_b128 v[28:31], v2 offset:61440
    global_load_dwordx4 a[72:75], v5, s[52:53] offset:-4096 sc1
    v_fma_f32 v90, v90, s32, s32
    v_exp_f32 v91, v79
    v_mfma_f32_16x16x32_bf16 v[64:67], a[164:167], v[32:35], v[64:67]
    v_rcp_f32 v88, v88
    v_fma_f32 v91, v91, s32, s32
    v_mfma_f32_16x16x32_bf16 v[68:71], a[228:231], v[32:35], v[68:71]
    global_load_dwordx4 a[136:139], v5, s[52:53] offset:0 sc1
    v_mul_f32 v76, v76, v88
    v_and_b32 v0, 0x30, v2
    v_lshl_add_u32 v15, v0, 4, v15
    v_rcp_f32 v89, v89
    s_waitcnt lgkmcnt(2)
    v_mfma_f32_16x16x32_bf16 v[60:63], a[104:107], v[36:39], v[60:63]
    ds_read_b128 v[32:35], v2 offset:62464
    v_mul_f32 v77, v77, v89
    v_cvt_pk_bf16_f32 v126, v76, v77
    v_mfma_f32_16x16x32_bf16 v[64:67], a[168:171], v[36:39], v[64:67]
    global_load_dwordx4 a[200:203], v6, s[52:53] offset:-4096 sc1
    v_rcp_f32 v90, v90
    v_mfma_f32_16x16x32_bf16 v[68:71], a[232:235], v[36:39], v[68:71]
    v_mul_f32 v78, v78, v90
    v_rcp_f32 v91, v91
    s_waitcnt lgkmcnt(2)
    v_mfma_f32_16x16x32_bf16 v[60:63], a[108:111], v[56:59], v[60:63]
    ds_read_b128 v[36:39], v2 offset:63488
    global_load_dwordx4 a[76:79], v6, s[52:53] offset:0 sc1
    v_mul_f32 v79, v79, v91
    v_cvt_pk_bf16_f32 v127, v78, v79
    v_mfma_f32_16x16x32_bf16 v[64:67], a[172:175], v[56:59], v[64:67]
    global_store_dwordx4 v2, v[124:127], s[48:49] offset:2048 sc0 sc1
    v_exp_f32 v92, v80
    v_exp_f32 v93, v81
    v_mfma_f32_16x16x32_bf16 v[68:71], a[236:239], v[56:59], v[68:71]
    global_load_dwordx4 a[140:143], v7, s[94:95] offset:-4096 sc1
    v_fma_f32 v92, v92, s32, s32
    v_fma_f32 v93, v93, s32, s32
    s_waitcnt lgkmcnt(2)
    v_mfma_f32_16x16x32_bf16 v[60:63], a[112:115], v[28:31], v[60:63]
    ds_read_b128 v[56:59], v2 offset:64512
    v_exp_f32 v94, v82
    v_exp_f32 v95, v83
    v_mfma_f32_16x16x32_bf16 v[64:67], a[176:179], v[28:31], v[64:67]
    v_rcp_f32 v92, v92
    v_mfma_f32_16x16x32_bf16 v[68:71], a[240:243], v[28:31], v[68:71]
    v_fma_f32 v94, v94, s32, s32
    v_fma_f32 v95, v95, s32, s32
    s_waitcnt lgkmcnt(2)
    v_mfma_f32_16x16x32_bf16 v[60:63], a[116:119], v[32:35], v[60:63]
    v_rcp_f32 v93, v93
    v_mul_f32 v80, v80, v92
    v_mfma_f32_16x16x32_bf16 v[64:67], a[180:183], v[32:35], v[64:67]
    v_rcp_f32 v94, v94
    v_mul_f32 v81, v81, v93
    v_mfma_f32_16x16x32_bf16 v[68:71], a[244:247], v[32:35], v[68:71]
    v_mul_f32 v82, v82, v94
    v_cvt_pk_bf16_f32 v22, v80, v81
    v_and_b32 v0, 0xc0, v2
    v_lshl_add_u32 v15, v0, 6, v15
    s_waitcnt lgkmcnt(1)
    v_mfma_f32_16x16x32_bf16 v[60:63], a[120:123], v[36:39], v[60:63]
    v_rcp_f32 v95, v95
    v_mfma_f32_16x16x32_bf16 v[64:67], a[184:187], v[36:39], v[64:67]
    v_mul_f32 v83, v83, v95
    v_cvt_pk_bf16_f32 v23, v82, v83
    s_mul_i32 s17, s3, 1088
    v_xor_b32 v15, s17, v15
    v_mfma_f32_16x16x32_bf16 v[68:71], a[248:251], v[36:39], v[68:71]
    global_store_dwordx2 v14, v[22:23], s[50:51] offset:2048 sc0 sc1
    s_waitcnt lgkmcnt(0)
    v_mfma_f32_16x16x32_bf16 v[60:63], a[124:127], v[56:59], v[60:63]
    s_add_u32 s17, s3, 1
    s_and_b32 s17, s17, 3
    s_xor_b32 s17, s17, s3
    s_lshl_b32 s17, s17, 6
    v_xor_b32 v9, s17, v15
    v_mfma_f32_16x16x32_bf16 v[64:67], a[188:191], v[56:59], v[64:67]
    s_add_u32 s17, s3, 2
    s_and_b32 s17, s17, 3
    s_xor_b32 s17, s17, s3
    s_lshl_b32 s17, s17, 6
    v_xor_b32 v10, s17, v15
    v_mfma_f32_16x16x32_bf16 v[68:71], a[252:255], v[56:59], v[68:71]
    s_waitcnt vmcnt(13)
    v_cmp_eq_u32_e64 s[20:21], -1, v18
    s_cmp_lg_u64 s[20:21], 0
    s_cbranch_scc1 k2_L_85S
k2_L_85B:
    s_waitcnt vmcnt(12)
    v_mfma_f32_16x16x32_bf16 v[28:31], v[144:147], a[64:67], v[128:131]
    s_add_u32 s17, s3, 3
    s_and_b32 s17, s17, 3
    s_xor_b32 s17, s17, s3
    s_lshl_b32 s17, s17, 6
    v_xor_b32 v11, s17, v15
    v_mfma_f32_16x16x32_bf16 v[32:35], v[148:151], a[64:67], 0
    v_cmp_u_f32_e64 s[18:19], v60, v60
    v_mfma_f32_16x16x32_bf16 v[36:39], v[152:155], a[64:67], 0
    s_mul_i32 s17, s3, 4160
    s_andn2_b32 s17, s17, 128
    v_xor_b32 v12, s17, v12
    s_cmp_lg_u64 s[18:19], 0
    v_mfma_f32_16x16x32_bf16 v[40:43], v[156:159], a[64:67], 0
    s_cbranch_scc1 k2_L_83S
k2_L_83B:
    v_mul_f32 v60, v60, v107
    v_mul_f32 v61, v61, v107
    v_mul_f32 v62, v62, v107
    v_mul_f32 v63, v63, v107
    v_fmac_f32 v60, v244, v111
    s_waitcnt vmcnt(11)
    v_mfma_f32_16x16x32_bf16 v[28:31], v[160:163], a[128:131], v[28:31]
    v_exp_f32 v84, v60
    v_fmac_f32 v61, v245, v111
    v_mfma_f32_16x16x32_bf16 v[32:35], v[164:167], a[128:131], v[32:35]
    v_exp_f32 v85, v61
    v_and_b32 v0, 0x300, v2
    v_lshlrev_b32 v17, 2, v0
    v_fmac_f32 v62, v246, v111
    v_mfma_f32_16x16x32_bf16 v[36:39], v[168:171], a[128:131], v[36:39]
    v_exp_f32 v86, v62
    v_fmac_f32 v63, v247, v111
    v_mfma_f32_16x16x32_bf16 v[40:43], v[172:175], a[128:131], v[40:43]
    v_fma_f32 v84, v84, s32, s32
    s_waitcnt vmcnt(10)
    v_mfma_f32_16x16x32_bf16 v[28:31], v[176:179], a[192:195], v[28:31]
    v_exp_f32 v87, v63
    v_fma_f32 v85, v85, s32, s32
    v_mfma_f32_16x16x32_bf16 v[32:35], v[180:183], a[192:195], v[32:35]
    v_rcp_f32 v84, v84
    v_fma_f32 v86, v86, s32, s32
    v_mfma_f32_16x16x32_bf16 v[36:39], v[184:187], a[192:195], v[36:39]
    v_rcp_f32 v85, v85
    v_fma_f32 v87, v87, s32, s32
    v_mfma_f32_16x16x32_bf16 v[40:43], v[188:191], a[192:195], v[40:43]
    v_mul_f32 v60, v60, v84
    v_mul_f32 v61, v61, v85
    s_waitcnt vmcnt(9)
    v_mfma_f32_16x16x32_bf16 v[28:31], v[192:195], a[68:71], v[28:31]
    global_load_dword v19, v16, s[52:53] offset:-2576 sc1
    v_cvt_pk_bf16_f32 v124, v60, v61
    v_mul_f32 v64, v64, v107
    v_mfma_f32_16x16x32_bf16 v[32:35], v[196:199], a[68:71], v[32:35]
    global_load_dwordx4 a[204:207], v2, s[52:53] offset:-3072 sc1
    v_mul_f32 v65, v65, v107
    v_mfma_f32_16x16x32_bf16 v[36:39], v[200:203], a[68:71], v[36:39]
    v_rcp_f32 v86, v86
    v_mul_f32 v66, v66, v107
    v_mfma_f32_16x16x32_bf16 v[40:43], v[204:207], a[68:71], v[40:43]
    v_mul_f32 v62, v62, v86
    v_mul_f32 v67, v67, v107
    s_waitcnt vmcnt(10)
    v_mfma_f32_16x16x32_bf16 v[28:31], v[208:211], a[132:135], v[28:31]
    global_load_dwordx4 a[80:83], v2, s[52:53] offset:1024 sc1
    v_fmac_f32 v64, v248, v111
    v_fmac_f32 v65, v249, v111
    v_mfma_f32_16x16x32_bf16 v[32:35], v[212:215], a[132:135], v[32:35]
    v_rcp_f32 v87, v87
    v_bfe_u32 v0, v2, 4, 4
    v_lshl_add_u32 v17, v0, 3, v17
    v_fmac_f32 v66, v250, v111
    v_mfma_f32_16x16x32_bf16 v[36:39], v[216:219], a[132:135], v[36:39]
    v_exp_f32 v88, v64
    v_mul_f32 v63, v63, v87
    v_mfma_f32_16x16x32_bf16 v[40:43], v[220:223], a[132:135], v[40:43]
    global_load_dwordx4 a[144:147], v3, s[52:53] offset:-3072 sc1
    s_mul_i32 s17, s3, 4064
    v_add_u32 v17, s17, v17
    v_cvt_pk_bf16_f32 v125, v62, v63
    s_waitcnt vmcnt(11)
    v_mfma_f32_16x16x32_bf16 v[28:31], v[224:227], a[196:199], v[28:31]
    v_exp_f32 v89, v65
    v_fmac_f32 v67, v251, v111
    v_mfma_f32_16x16x32_bf16 v[32:35], v[228:231], a[196:199], v[32:35]
    v_exp_f32 v90, v66
    v_fma_f32 v88, v88, s32, s32
    v_mfma_f32_16x16x32_bf16 v[36:39], v[232:235], a[196:199], v[36:39]
    global_load_dwordx4 a[208:211], v3, s[52:53] offset:1024 sc1
    v_fma_f32 v89, v89, s32, s32
    v_fma_f32 v90, v90, s32, s32
    v_mfma_f32_16x16x32_bf16 v[40:43], v[236:239], a[196:199], v[40:43]
    v_mul_f32 v68, v68, v107
    v_mul_f32 v69, v69, v107
    s_waitcnt vmcnt(11)
    v_mfma_f32_16x16x32_bf16 v[28:31], v[240:243], a[72:75], v[28:31]
    v_exp_f32 v91, v67
    v_mul_f32 v70, v70, v107
    v_mfma_f32_16x16x32_bf16 v[32:35], v[112:115], a[72:75], v[32:35]
    global_load_dwordx4 a[84:87], v4, s[52:53] offset:-3072 sc1
    v_fma_f32 v91, v91, s32, s32
    v_mfma_f32_16x16x32_bf16 v[36:39], v[116:119], a[72:75], v[36:39]
    v_rcp_f32 v88, v88
    v_mul_f32 v71, v71, v107
    v_mfma_f32_16x16x32_bf16 v[40:43], v[120:123], a[72:75], v[40:43]
    v_mul_f32 v64, v64, v88
    v_fmac_f32 v68, v252, v111
    s_waitcnt vmcnt(11)
    v_mfma_f32_16x16x32_bf16 v[28:31], a[0:3], a[136:139], v[28:31]
    global_load_dwordx4 a[148:151], v4, s[52:53] offset:1024 sc1
    v_fmac_f32 v69, v253, v111
    v_fmac_f32 v70, v254, v111
    v_mfma_f32_16x16x32_bf16 v[32:35], a[4:7], a[136:139], v[32:35]
    v_rcp_f32 v89, v89
    v_fmac_f32 v71, v255, v111
    v_mfma_f32_16x16x32_bf16 v[36:39], a[8:11], a[136:139], v[36:39]
    v_rcp_f32 v90, v90
    v_mul_f32 v65, v65, v89
    v_mfma_f32_16x16x32_bf16 v[40:43], a[12:15], a[136:139], v[40:43]
    global_load_dwordx4 a[212:215], v5, s[52:53] offset:-3072 sc1
    v_mul_f32 v66, v66, v90
    s_waitcnt vmcnt(12)
    v_mfma_f32_16x16x32_bf16 v[28:31], a[16:19], a[200:203], v[28:31]
    v_rcp_f32 v91, v91
    v_cvt_pk_bf16_f32 v126, v64, v65
    v_mfma_f32_16x16x32_bf16 v[32:35], a[20:23], a[200:203], v[32:35]
    v_exp_f32 v92, v68
    v_mul_f32 v67, v67, v91
    v_mfma_f32_16x16x32_bf16 v[36:39], a[24:27], a[200:203], v[36:39]
    global_load_dwordx4 a[88:91], v5, s[52:53] offset:1024 sc1
    v_cvt_pk_bf16_f32 v127, v66, v67
    v_fma_f32 v92, v92, s32, s32
    v_mfma_f32_16x16x32_bf16 v[40:43], a[28:31], a[200:203], v[40:43]
    v_exp_f32 v93, v69
    v_exp_f32 v94, v70
    s_waitcnt vmcnt(12)
    v_mfma_f32_16x16x32_bf16 v[28:31], a[32:35], a[76:79], v[28:31]
    global_store_dwordx4 v2, v[124:127], s[48:49] offset:3072 sc0 sc1
    v_fma_f32 v93, v93, s32, s32
    v_fma_f32 v94, v94, s32, s32
    v_mfma_f32_16x16x32_bf16 v[32:35], a[36:39], a[76:79], v[32:35]
    global_load_dwordx4 a[152:155], v6, s[52:53] offset:-3072 sc1
    v_exp_f32 v95, v71
    v_mfma_f32_16x16x32_bf16 v[36:39], a[40:43], a[76:79], v[36:39]
    v_rcp_f32 v92, v92
    v_fma_f32 v95, v95, s32, s32
    v_mfma_f32_16x16x32_bf16 v[40:43], a[44:47], a[76:79], v[40:43]
    v_mul_f32 v68, v68, v92
    v_rcp_f32 v93, v93
    s_waitcnt vmcnt(12)
    v_mfma_f32_16x16x32_bf16 v[32:35], a[52:55], a[140:143], v[32:35]
    global_load_dwordx4 a[216:219], v6, s[52:53] offset:1024 sc1
    v_mul_f32 v69, v69, v93
    v_cvt_pk_bf16_f32 v22, v68, v69
    v_mfma_f32_16x16x32_bf16 v[36:39], a[56:59], a[140:143], v[36:39]
    v_rcp_f32 v94, v94
    v_rcp_f32 v95, v95
    v_mfma_f32_16x16x32_bf16 v[40:43], a[60:63], a[140:143], v[40:43]
    v_mul_f32 v70, v70, v94
    v_mul_f32 v71, v71, v95
    v_mfma_f32_16x16x32_bf16 v[28:31], a[48:51], a[140:143], v[28:31]
    global_load_dwordx4 a[92:95], v7, s[94:95] offset:-3072 sc1
    v_cvt_pk_bf16_f32 v23, v70, v71
    s_waitcnt vmcnt(12)
    v_cmp_eq_u32_e64 s[20:21], -1, v19
    s_cmp_lg_u64 s[20:21], 0
    s_cbranch_scc1 k2_L_87S
k2_L_87B:
    s_waitcnt vmcnt(11)
    v_mfma_f32_16x16x32_bf16 v[44:47], v[144:147], a[204:207], v[132:135]
    global_store_dwordx2 v14, v[22:23], s[50:51] offset:3072 sc0 sc1
    v_mfma_f32_16x16x32_bf16 v[48:51], v[148:151], a[204:207], 0
    v_cmp_u_f32_e64 s[18:19], v32, v32
    v_mfma_f32_16x16x32_bf16 v[52:55], v[152:155], a[204:207], 0
    ds_write_b128 v9, v[32:35] offset:0
    v_mfma_f32_16x16x32_bf16 v[56:59], v[156:159], a[204:207], 0
    s_waitcnt vmcnt(11)
    v_mfma_f32_16x16x32_bf16 v[44:47], v[160:163], a[80:83], v[44:47]
    ds_write_b128 v10, v[36:39] offset:0
    v_mfma_f32_16x16x32_bf16 v[48:51], v[164:167], a[80:83], v[48:51]
    v_mfma_f32_16x16x32_bf16 v[52:55], v[168:171], a[80:83], v[52:55]
    ds_write_b128 v11, v[40:43] offset:0
    v_mfma_f32_16x16x32_bf16 v[56:59], v[172:175], a[80:83], v[56:59]
    s_waitcnt vmcnt(10)
    v_mfma_f32_16x16x32_bf16 v[44:47], v[176:179], a[144:147], v[44:47]
    ds_write_b128 v15, v[28:31] offset:0
    v_mfma_f32_16x16x32_bf16 v[48:51], v[180:183], a[144:147], v[48:51]
    s_cmp_lg_u64 s[18:19], 0
    v_mfma_f32_16x16x32_bf16 v[52:55], v[184:187], a[144:147], v[52:55]
    s_cbranch_scc1 k2_L_93S
k2_L_93B:
    v_mfma_f32_16x16x32_bf16 v[56:59], v[188:191], a[144:147], v[56:59]
    s_waitcnt lgkmcnt(0)
    s_barrier
    s_waitcnt vmcnt(9)
    v_mfma_f32_16x16x32_bf16 v[44:47], v[192:195], a[208:211], v[44:47]
    ds_read_b128 v[72:75], v12 offset:0
    ds_read_b128 v[76:79], v12 offset:1024
    v_mfma_f32_16x16x32_bf16 v[48:51], v[196:199], a[208:211], v[48:51]
    ds_read_b128 v[80:83], v12 offset:2048
    ds_read_b128 v[84:87], v12 offset:3072
    v_mfma_f32_16x16x32_bf16 v[52:55], v[200:203], a[208:211], v[52:55]
    v_mfma_f32_16x16x32_bf16 v[56:59], v[204:207], a[208:211], v[56:59]
    s_waitcnt vmcnt(8)
    v_mfma_f32_16x16x32_bf16 v[44:47], v[208:211], a[84:87], v[44:47]
    global_load_dword v20, v16, s[52:53] offset:-1552 sc1
    v_mfma_f32_16x16x32_bf16 v[48:51], v[212:215], a[84:87], v[48:51]
    global_load_dwordx4 a[156:159], v2, s[52:53] offset:-2048 sc1
    v_mfma_f32_16x16x32_bf16 v[52:55], v[216:219], a[84:87], v[52:55]
    v_mfma_f32_16x16x32_bf16 v[56:59], v[220:223], a[84:87], v[56:59]
    s_waitcnt lgkmcnt(2)
    v_pk_add_f32 v[72:73], v[72:73], v[76:77]
    v_pk_add_f32 v[74:75], v[74:75], v[78:79]
    s_waitcnt vmcnt(9)
    v_mfma_f32_16x16x32_bf16 v[44:47], v[224:227], a[148:151], v[44:47]
    s_waitcnt lgkmcnt(0)
    global_load_dwordx4 a[220:223], v2, s[52:53] offset:2048 sc1
    v_pk_add_f32 v[80:81], v[80:81], v[84:85]
    v_pk_add_f32 v[82:83], v[82:83], v[86:87]
    v_mfma_f32_16x16x32_bf16 v[48:51], v[228:231], a[148:151], v[48:51]
    v_pk_add_f32 v[72:73], v[72:73], v[80:81]
    v_pk_add_f32 v[74:75], v[74:75], v[82:83]
    v_mfma_f32_16x16x32_bf16 v[52:55], v[232:235], a[148:151], v[52:55]
    v_cvt_pk_bf16_f32 v96, v72, v73
    v_cvt_pk_bf16_f32 v97, v74, v75
    v_mfma_f32_16x16x32_bf16 v[56:59], v[236:239], a[148:151], v[56:59]
    global_load_dwordx4 a[96:99], v3, s[52:53] offset:-2048 sc1
    s_waitcnt vmcnt(10)
    v_mfma_f32_16x16x32_bf16 v[44:47], v[240:243], a[212:215], v[44:47]
    v_mfma_f32_16x16x32_bf16 v[48:51], v[112:115], a[212:215], v[48:51]
    v_mfma_f32_16x16x32_bf16 v[52:55], v[116:119], a[212:215], v[52:55]
    global_load_dwordx4 a[160:163], v3, s[52:53] offset:2048 sc1
    v_mfma_f32_16x16x32_bf16 v[56:59], v[120:123], a[212:215], v[56:59]
    s_waitcnt vmcnt(10)
    v_mfma_f32_16x16x32_bf16 v[44:47], a[0:3], a[88:91], v[44:47]
    v_mfma_f32_16x16x32_bf16 v[48:51], a[4:7], a[88:91], v[48:51]
    global_load_dwordx4 a[224:227], v4, s[52:53] offset:-2048 sc1
    v_mfma_f32_16x16x32_bf16 v[52:55], a[8:11], a[88:91], v[52:55]
    v_mfma_f32_16x16x32_bf16 v[56:59], a[12:15], a[88:91], v[56:59]
    s_waitcnt vmcnt(9)
    v_mfma_f32_16x16x32_bf16 v[44:47], a[16:19], a[152:155], v[44:47]
    global_load_dwordx4 a[100:103], v4, s[52:53] offset:2048 sc1
    v_mfma_f32_16x16x32_bf16 v[48:51], a[20:23], a[152:155], v[48:51]
    v_mfma_f32_16x16x32_bf16 v[52:55], a[24:27], a[152:155], v[52:55]
    v_mfma_f32_16x16x32_bf16 v[56:59], a[28:31], a[152:155], v[56:59]
    global_load_dwordx4 a[164:167], v5, s[52:53] offset:-2048 sc1
    s_waitcnt vmcnt(10)
    v_mfma_f32_16x16x32_bf16 v[44:47], a[32:35], a[216:219], v[44:47]
    v_mfma_f32_16x16x32_bf16 v[48:51], a[36:39], a[216:219], v[48:51]
    v_mfma_f32_16x16x32_bf16 v[52:55], a[40:43], a[216:219], v[52:55]
    global_load_dwordx4 a[228:231], v5, s[52:53] offset:2048 sc1
    v_mfma_f32_16x16x32_bf16 v[56:59], a[44:47], a[216:219], v[56:59]
    s_waitcnt vmcnt(10)
    v_mfma_f32_16x16x32_bf16 v[48:51], a[52:55], a[92:95], v[48:51]
    v_mfma_f32_16x16x32_bf16 v[52:55], a[56:59], a[92:95], v[52:55]
    global_load_dwordx4 a[104:107], v6, s[52:53] offset:-2048 sc1
    v_mfma_f32_16x16x32_bf16 v[56:59], a[60:63], a[92:95], v[56:59]
    v_mfma_f32_16x16x32_bf16 v[44:47], a[48:51], a[92:95], v[44:47]
    s_waitcnt vmcnt(9)
    v_cmp_eq_u32_e64 s[20:21], -1, v20
    s_cmp_lg_u64 s[20:21], 0
    s_cbranch_scc1 k2_L_89S
k2_L_89B:
    s_waitcnt vmcnt(8)
    v_mfma_f32_16x16x32_bf16 v[28:31], v[144:147], a[156:159], v[136:139]
    global_load_dwordx4 a[168:171], v6, s[52:53] offset:2048 sc1
    v_mfma_f32_16x16x32_bf16 v[32:35], v[148:151], a[156:159], 0
    v_cmp_u_f32_e64 s[18:19], v48, v48
    v_mfma_f32_16x16x32_bf16 v[36:39], v[152:155], a[156:159], 0
    ds_write_b128 v9, v[48:51] offset:16384
    v_mfma_f32_16x16x32_bf16 v[40:43], v[156:159], a[156:159], 0
    global_load_dwordx4 a[232:235], v7, s[94:95] offset:-2048 sc1
    s_waitcnt vmcnt(9)
    v_mfma_f32_16x16x32_bf16 v[28:31], v[160:163], a[220:223], v[28:31]
    ds_write_b128 v10, v[52:55] offset:16384
    v_mfma_f32_16x16x32_bf16 v[32:35], v[164:167], a[220:223], v[32:35]
    v_mfma_f32_16x16x32_bf16 v[36:39], v[168:171], a[220:223], v[36:39]
    ds_write_b128 v11, v[56:59] offset:16384
    v_mfma_f32_16x16x32_bf16 v[40:43], v[172:175], a[220:223], v[40:43]
    s_waitcnt vmcnt(8)
    v_mfma_f32_16x16x32_bf16 v[28:31], v[176:179], a[96:99], v[28:31]
    ds_write_b128 v15, v[44:47] offset:16384
    v_mfma_f32_16x16x32_bf16 v[32:35], v[180:183], a[96:99], v[32:35]
    s_cmp_lg_u64 s[18:19], 0
    v_mfma_f32_16x16x32_bf16 v[36:39], v[184:187], a[96:99], v[36:39]
    s_cbranch_scc1 k2_L_95S
k2_L_95B:
    v_mfma_f32_16x16x32_bf16 v[40:43], v[188:191], a[96:99], v[40:43]
    s_waitcnt lgkmcnt(0)
    s_barrier
    s_waitcnt vmcnt(7)
    v_mfma_f32_16x16x32_bf16 v[28:31], v[192:195], a[160:163], v[28:31]
    ds_read_b128 v[72:75], v12 offset:16384
    ds_read_b128 v[76:79], v12 offset:17408
    v_mfma_f32_16x16x32_bf16 v[32:35], v[196:199], a[160:163], v[32:35]
    ds_read_b128 v[80:83], v12 offset:18432
    ds_read_b128 v[84:87], v12 offset:19456
    v_mfma_f32_16x16x32_bf16 v[36:39], v[200:203], a[160:163], v[36:39]
    global_load_dword v18, v16, s[52:53] offset:-528 sc1
    v_mfma_f32_16x16x32_bf16 v[40:43], v[204:207], a[160:163], v[40:43]
    global_load_dwordx4 a[108:111], v2, s[52:53] offset:-1024 sc1
    s_waitcnt vmcnt(8)
    v_mfma_f32_16x16x32_bf16 v[28:31], v[208:211], a[224:227], v[28:31]
    v_mfma_f32_16x16x32_bf16 v[32:35], v[212:215], a[224:227], v[32:35]
    v_mfma_f32_16x16x32_bf16 v[36:39], v[216:219], a[224:227], v[36:39]
    global_load_dwordx4 a[172:175], v2, s[52:53] offset:3072 sc1
    v_mfma_f32_16x16x32_bf16 v[40:43], v[220:223], a[224:227], v[40:43]
    s_waitcnt lgkmcnt(2)
    v_pk_add_f32 v[72:73], v[72:73], v[76:77]
    v_pk_add_f32 v[74:75], v[74:75], v[78:79]
    s_waitcnt vmcnt(8)
    v_mfma_f32_16x16x32_bf16 v[28:31], v[224:227], a[100:103], v[28:31]
    s_waitcnt lgkmcnt(0)
    v_pk_add_f32 v[80:81], v[80:81], v[84:85]
    v_pk_add_f32 v[82:83], v[82:83], v[86:87]
    v_mfma_f32_16x16x32_bf16 v[32:35], v[228:231], a[100:103], v[32:35]
    global_load_dwordx4 a[236:239], v3, s[52:53] offset:-1024 sc1
    v_pk_add_f32 v[72:73], v[72:73], v[80:81]
    v_mfma_f32_16x16x32_bf16 v[36:39], v[232:235], a[100:103], v[36:39]
    v_pk_add_f32 v[74:75], v[74:75], v[82:83]
    v_cvt_pk_bf16_f32 v98, v72, v73
    v_mfma_f32_16x16x32_bf16 v[40:43], v[236:239], a[100:103], v[40:43]
    v_cvt_pk_bf16_f32 v99, v74, v75
    s_waitcnt vmcnt(8)
    v_mfma_f32_16x16x32_bf16 v[28:31], v[240:243], a[164:167], v[28:31]
    global_load_dwordx4 a[112:115], v3, s[52:53] offset:3072 sc1
    v_mfma_f32_16x16x32_bf16 v[32:35], v[112:115], a[164:167], v[32:35]
    v_mfma_f32_16x16x32_bf16 v[36:39], v[116:119], a[164:167], v[36:39]
    v_mfma_f32_16x16x32_bf16 v[40:43], v[120:123], a[164:167], v[40:43]
    global_load_dwordx4 a[176:179], v4, s[52:53] offset:-1024 sc1
    s_waitcnt vmcnt(9)
    v_mfma_f32_16x16x32_bf16 v[28:31], a[0:3], a[228:231], v[28:31]
    v_mfma_f32_16x16x32_bf16 v[32:35], a[4:7], a[228:231], v[32:35]
    v_mfma_f32_16x16x32_bf16 v[36:39], a[8:11], a[228:231], v[36:39]
    global_load_dwordx4 a[240:243], v4, s[52:53] offset:3072 sc1
    v_mfma_f32_16x16x32_bf16 v[40:43], a[12:15], a[228:231], v[40:43]
    s_waitcnt vmcnt(9)
    v_mfma_f32_16x16x32_bf16 v[28:31], a[16:19], a[104:107], v[28:31]
    v_mfma_f32_16x16x32_bf16 v[32:35], a[20:23], a[104:107], v[32:35]
    global_load_dwordx4 a[116:119], v5, s[52:53] offset:-1024 sc1
    v_mfma_f32_16x16x32_bf16 v[36:39], a[24:27], a[104:107], v[36:39]
    v_mfma_f32_16x16x32_bf16 v[40:43], a[28:31], a[104:107], v[40:43]
    s_waitcnt vmcnt(9)
    v_mfma_f32_16x16x32_bf16 v[28:31], a[32:35], a[168:171], v[28:31]
    global_load_dwordx4 a[180:183], v5, s[52:53] offset:3072 sc1
    v_mfma_f32_16x16x32_bf16 v[32:35], a[36:39], a[168:171], v[32:35]
    v_mfma_f32_16x16x32_bf16 v[36:39], a[40:43], a[168:171], v[36:39]
    v_mfma_f32_16x16x32_bf16 v[40:43], a[44:47], a[168:171], v[40:43]
    global_load_dwordx4 a[244:247], v6, s[52:53] offset:-1024 sc1
    s_waitcnt vmcnt(10)
    v_mfma_f32_16x16x32_bf16 v[32:35], a[52:55], a[232:235], v[32:35]
    v_mfma_f32_16x16x32_bf16 v[36:39], a[56:59], a[232:235], v[36:39]
    v_mfma_f32_16x16x32_bf16 v[40:43], a[60:63], a[232:235], v[40:43]
    global_load_dwordx4 a[120:123], v6, s[52:53] offset:3072 sc1
    v_mfma_f32_16x16x32_bf16 v[28:31], a[48:51], a[232:235], v[28:31]
    s_waitcnt vmcnt(10)
    v_cmp_eq_u32_e64 s[20:21], -1, v18
    s_cmp_lg_u64 s[20:21], 0
    s_cbranch_scc1 k2_L_91S
k2_L_91B:
    s_waitcnt vmcnt(9)
    v_mfma_f32_16x16x32_bf16 v[44:47], v[144:147], a[108:111], v[140:143]
    v_mfma_f32_16x16x32_bf16 v[48:51], v[148:151], a[108:111], 0
    global_load_dwordx4 a[184:187], v7, s[94:95] offset:-1024 sc1
    v_cmp_u_f32_e64 s[18:19], v32, v32
    v_mfma_f32_16x16x32_bf16 v[52:55], v[152:155], a[108:111], 0
    ds_write_b128 v9, v[32:35] offset:32768
    v_mfma_f32_16x16x32_bf16 v[56:59], v[156:159], a[108:111], 0
    s_waitcnt vmcnt(9)
    v_mfma_f32_16x16x32_bf16 v[44:47], v[160:163], a[172:175], v[44:47]
    ds_write_b128 v10, v[36:39] offset:32768
    v_mfma_f32_16x16x32_bf16 v[48:51], v[164:167], a[172:175], v[48:51]
    v_mfma_f32_16x16x32_bf16 v[52:55], v[168:171], a[172:175], v[52:55]
    ds_write_b128 v11, v[40:43] offset:32768
    v_mfma_f32_16x16x32_bf16 v[56:59], v[172:175], a[172:175], v[56:59]
    s_waitcnt vmcnt(8)
    v_mfma_f32_16x16x32_bf16 v[44:47], v[176:179], a[236:239], v[44:47]
    ds_write_b128 v15, v[28:31] offset:32768
    v_mfma_f32_16x16x32_bf16 v[48:51], v[180:183], a[236:239], v[48:51]
    s_cmp_lg_u64 s[18:19], 0
    v_mfma_f32_16x16x32_bf16 v[52:55], v[184:187], a[236:239], v[52:55]
    s_cbranch_scc1 k2_L_97S
k2_L_97B:
    v_mfma_f32_16x16x32_bf16 v[56:59], v[188:191], a[236:239], v[56:59]
    s_waitcnt lgkmcnt(0)
    s_barrier
    s_waitcnt vmcnt(7)
    v_mfma_f32_16x16x32_bf16 v[44:47], v[192:195], a[112:115], v[44:47]
    ds_read_b128 v[72:75], v12 offset:32768
    ds_read_b128 v[76:79], v12 offset:33792
    v_mfma_f32_16x16x32_bf16 v[48:51], v[196:199], a[112:115], v[48:51]
    ds_read_b128 v[80:83], v12 offset:34816
    ds_read_b128 v[84:87], v12 offset:35840
    v_mfma_f32_16x16x32_bf16 v[52:55], v[200:203], a[112:115], v[52:55]
    v_mfma_f32_16x16x32_bf16 v[56:59], v[204:207], a[112:115], v[56:59]
    s_waitcnt vmcnt(6)
    v_mfma_f32_16x16x32_bf16 v[44:47], v[208:211], a[176:179], v[44:47]
    v_mfma_f32_16x16x32_bf16 v[48:51], v[212:215], a[176:179], v[48:51]
    v_mfma_f32_16x16x32_bf16 v[52:55], v[216:219], a[176:179], v[52:55]
    v_mfma_f32_16x16x32_bf16 v[56:59], v[220:223], a[176:179], v[56:59]
    s_waitcnt lgkmcnt(2)
    v_pk_add_f32 v[72:73], v[72:73], v[76:77]
    v_pk_add_f32 v[74:75], v[74:75], v[78:79]
    s_waitcnt vmcnt(5)
    v_mfma_f32_16x16x32_bf16 v[44:47], v[224:227], a[240:243], v[44:47]
    s_waitcnt lgkmcnt(0)
    global_store_dwordx2 v17, v[96:97], s[38:39]
    s_add_u32 s38, s38, 16384
    s_addc_u32 s39, s39, 0
    v_pk_add_f32 v[80:81], v[80:81], v[84:85]
    v_pk_add_f32 v[82:83], v[82:83], v[86:87]
    v_mfma_f32_16x16x32_bf16 v[48:51], v[228:231], a[240:243], v[48:51]
    v_pk_add_f32 v[72:73], v[72:73], v[80:81]
    v_pk_add_f32 v[74:75], v[74:75], v[82:83]
    v_mfma_f32_16x16x32_bf16 v[52:55], v[232:235], a[240:243], v[52:55]
    global_store_dwordx2 v17, v[98:99], s[38:39]
    s_add_u32 s38, s38, 16384
    s_addc_u32 s39, s39, 0
    v_mfma_f32_16x16x32_bf16 v[56:59], v[236:239], a[240:243], v[56:59]
    v_cvt_pk_bf16_f32 v100, v72, v73
    s_waitcnt vmcnt(6)
    v_mfma_f32_16x16x32_bf16 v[44:47], v[240:243], a[116:119], v[44:47]
    v_cvt_pk_bf16_f32 v101, v74, v75
    v_mfma_f32_16x16x32_bf16 v[48:51], v[112:115], a[116:119], v[48:51]
    global_store_dwordx2 v17, v[100:101], s[38:39]
    s_add_u32 s38, s38, 16384
    s_addc_u32 s39, s39, 0
    v_mfma_f32_16x16x32_bf16 v[52:55], v[116:119], a[116:119], v[52:55]
    v_mfma_f32_16x16x32_bf16 v[56:59], v[120:123], a[116:119], v[56:59]
    s_waitcnt vmcnt(6)
    v_mfma_f32_16x16x32_bf16 v[44:47], a[0:3], a[180:183], v[44:47]
    v_mfma_f32_16x16x32_bf16 v[48:51], a[4:7], a[180:183], v[48:51]
    v_mfma_f32_16x16x32_bf16 v[52:55], a[8:11], a[180:183], v[52:55]
    v_mfma_f32_16x16x32_bf16 v[56:59], a[12:15], a[180:183], v[56:59]
    s_waitcnt vmcnt(5)
    v_mfma_f32_16x16x32_bf16 v[44:47], a[16:19], a[244:247], v[44:47]
    v_mfma_f32_16x16x32_bf16 v[48:51], a[20:23], a[244:247], v[48:51]
    v_mfma_f32_16x16x32_bf16 v[52:55], a[24:27], a[244:247], v[52:55]
    v_mfma_f32_16x16x32_bf16 v[56:59], a[28:31], a[244:247], v[56:59]
    s_waitcnt vmcnt(4)
    v_mfma_f32_16x16x32_bf16 v[44:47], a[32:35], a[120:123], v[44:47]
    v_mfma_f32_16x16x32_bf16 v[48:51], a[36:39], a[120:123], v[48:51]
    v_mfma_f32_16x16x32_bf16 v[52:55], a[40:43], a[120:123], v[52:55]
    v_mfma_f32_16x16x32_bf16 v[56:59], a[44:47], a[120:123], v[56:59]
    s_waitcnt vmcnt(3)
    v_mfma_f32_16x16x32_bf16 v[48:51], a[52:55], a[184:187], v[48:51]
    v_mfma_f32_16x16x32_bf16 v[52:55], a[56:59], a[184:187], v[52:55]
    v_mfma_f32_16x16x32_bf16 v[56:59], a[60:63], a[184:187], v[56:59]
    v_mfma_f32_16x16x32_bf16 v[44:47], a[48:51], a[184:187], v[44:47]
    s_nop 4
    v_cmp_u_f32_e64 s[18:19], v48, v48
    ds_write_b128 v9, v[48:51] offset:49152
    ds_write_b128 v10, v[52:55] offset:49152
    ds_write_b128 v11, v[56:59] offset:49152
    ds_write_b128 v15, v[44:47] offset:49152
    s_cmp_lg_u64 s[18:19], 0
    s_cbranch_scc1 k2_L_99S
k2_L_99B:
    s_waitcnt lgkmcnt(0)
    s_barrier
    ds_read_b128 v[72:75], v12 offset:49152
    ds_read_b128 v[76:79], v12 offset:50176
    ds_read_b128 v[80:83], v12 offset:51200
    ds_read_b128 v[84:87], v12 offset:52224
    s_waitcnt lgkmcnt(2)
    v_pk_add_f32 v[72:73], v[72:73], v[76:77]
    v_pk_add_f32 v[74:75], v[74:75], v[78:79]
    s_waitcnt lgkmcnt(0)
    v_pk_add_f32 v[80:81], v[80:81], v[84:85]
    v_pk_add_f32 v[82:83], v[82:83], v[86:87]
    v_pk_add_f32 v[72:73], v[72:73], v[80:81]
    v_pk_add_f32 v[74:75], v[74:75], v[82:83]
    v_cvt_pk_bf16_f32 v102, v72, v73
    v_cvt_pk_bf16_f32 v103, v74, v75
    global_store_dwordx2 v17, v[102:103], s[38:39]
    s_endpgm
k2_L_54S:
    s_mov_b64 s[28:29], -1
    s_branch k2_L_54B
k2_L_57S:
k2_L_56L:
    global_load_dwordx4 v[96:99], v2, s[34:35] offset:0 sc1
    global_load_dwordx4 v[100:103], v2, s[34:35] offset:1024 sc1
    global_load_dwordx4 v[104:107], v2, s[34:35] offset:2048 sc1
    global_load_dwordx4 v[108:111], v2, s[34:35] offset:3072 sc1
    s_sub_u32 s67, s67, 1
    s_cbranch_scc1 k2_L_56X
    s_waitcnt vmcnt(0)
    v_max3_u32 v36, v96, v100, v104
    v_max_u32 v36, v36, v108
    v_cmp_eq_u32_e64 vcc, -1, v36
    s_cbranch_vccnz k2_L_56L
    s_branch k2_L_56Y
k2_L_56X:
    s_mov_b32 s67, 0
k2_L_56Y:
    s_waitcnt vmcnt(0)
    s_branch k2_L_57B
k2_L_55:
    s_waitcnt vmcnt(0)
    s_cmp_eq_u64 s[26:27], 0
    s_cbranch_scc1 k2_L_55_KB
    v_mov_b32 v32, 0xff800000
    v_mov_b32 v56, v12
    s_mov_b32 s26, 64
k2_L_55_1B:
    ds_read_b128 v[40:43], v56
    v_add_u32 v56, 2304, v56
    s_waitcnt lgkmcnt(0)
    v_mfma_f32_32x32x16_bf16 v[64:79], v[40:43], v[28:31], 0
    s_nop 11
    v_max3_f32 v32, v64, v65, v32
    v_max3_f32 v32, v66, v67, v32
    v_max3_f32 v32, v68, v69, v32
    v_max3_f32 v32, v70, v71, v32
    v_max3_f32 v32, v72, v73, v32
    v_max3_f32 v32, v74, v75, v32
    v_max3_f32 v32, v76, v77, v32
    v_max3_f32 v32, v78, v79, v32
    s_sub_u32 s26, s26, 1
    s_cmp_lg_u32 s26, 0
    s_cbranch_scc1 k2_L_55_1B
    v_mov_b32 v33, v32
    s_nop 1
    v_permlane32_swap_b32 v32, v33
    v_max_f32 v32, v32, v33
    v_sub_f32 v80, 0, v32
    v_mov_b32 v112, 0
    v_sub_f32 v81, 0, v32
    v_mov_b32 v113, 0
    v_sub_f32 v82, 0, v32
    v_mov_b32 v114, 0
    v_sub_f32 v83, 0, v32
    v_mov_b32 v115, 0
    v_sub_f32 v84, 0, v32
    v_mov_b32 v116, 0
    v_sub_f32 v85, 0, v32
    v_mov_b32 v117, 0
    v_sub_f32 v86, 0, v32
    v_mov_b32 v118, 0
    v_sub_f32 v87, 0, v32
    v_mov_b32 v119, 0
    v_sub_f32 v88, 0, v32
    v_mov_b32 v120, 0
    v_sub_f32 v89, 0, v32
    v_mov_b32 v121, 0
    v_sub_f32 v90, 0, v32
    v_mov_b32 v122, 0
    v_sub_f32 v91, 0, v32
    v_mov_b32 v123, 0
    v_sub_f32 v92, 0, v32
    v_mov_b32 v124, 0
    v_sub_f32 v93, 0, v32
    v_mov_b32 v125, 0
    v_sub_f32 v94, 0, v32
    v_mov_b32 v126, 0
    v_sub_f32 v95, 0, v32
    v_mov_b32 v127, 0
    v_mov_b32 v56, v12
    v_mov_b32 v57, v15
    v_mov_b32 v58, v18
    s_mov_b32 s26, 64
k2_L_55_2B:
    ds_read_b128 v[40:43], v56
    ds_read_b128 v[48:51], v57
    ds_read_b128 v[52:55], v58
    v_add_u32 v56, 2304, v56
    v_add_u32 v57, 2304, v57
    v_add_u32 v58, 2304, v58
    s_waitcnt lgkmcnt(0)
    v_mfma_f32_32x32x16_bf16 v[64:79], v[40:43], v[28:31], v[80:95]
    s_nop 11
    v_exp_f32 v64, v64
    v_exp_f32 v65, v65
    v_exp_f32 v66, v66
    v_exp_f32 v67, v67
    v_exp_f32 v68, v68
    v_exp_f32 v69, v69
    v_exp_f32 v70, v70
    v_exp_f32 v71, v71
    v_exp_f32 v72, v72
    v_exp_f32 v73, v73
    v_exp_f32 v74, v74
    v_exp_f32 v75, v75
    v_exp_f32 v76, v76
    v_exp_f32 v77, v77
    v_exp_f32 v78, v78
    v_exp_f32 v79, v79
    v_smfmac_f32_32x32x32_bf16 v[112:127], v[48:51], v[64:71], v39
    s_nop 0
    v_smfmac_f32_32x32x32_bf16 v[112:127], v[52:55], v[72:79], v39
    s_sub_u32 s26, s26, 1
    s_cmp_lg_u32 s26, 0
    s_cbranch_scc1 k2_L_55_2B
    s_nop 8
    v_rcp_f32 v121, v120
    s_nop 0
    v_pk_mul_f32 v[112:113], v[112:113], v[120:121] op_sel:[0,1] op_sel_hi:[1,1]
    v_pk_mul_f32 v[114:115], v[114:115], v[120:121] op_sel:[0,1] op_sel_hi:[1,1]
    v_pk_mul_f32 v[116:117], v[116:117], v[120:121] op_sel:[0,1] op_sel_hi:[1,1]
    v_pk_mul_f32 v[118:119], v[118:119], v[120:121] op_sel:[0,1] op_sel_hi:[1,1]
    v_cvt_pk_bf16_f32 v124, v112, v113
    v_cvt_pk_bf16_f32 v125, v114, v115
    v_cvt_pk_bf16_f32 v126, v116, v117
    v_cvt_pk_bf16_f32 v127, v118, v119
k2_L_55_KB:
    global_store_dwordx4 v21, v[124:127], s[92:93] sc0 sc1
    s_cmp_eq_u64 s[28:29], 0
    s_cbranch_scc1 k2_L_55_KA
    v_mov_b32 v32, 0xff800000
    v_mov_b32 v56, v12
    s_mov_b32 s26, 64
k2_L_55_1A:
    ds_read_b128 v[40:43], v56
    v_add_u32 v56, 2304, v56
    s_waitcnt lgkmcnt(0)
    v_mfma_f32_32x32x16_bf16 v[64:79], v[40:43], v[24:27], 0
    s_nop 11
    v_max3_f32 v32, v64, v65, v32
    v_max3_f32 v32, v66, v67, v32
    v_max3_f32 v32, v68, v69, v32
    v_max3_f32 v32, v70, v71, v32
    v_max3_f32 v32, v72, v73, v32
    v_max3_f32 v32, v74, v75, v32
    v_max3_f32 v32, v76, v77, v32
    v_max3_f32 v32, v78, v79, v32
    s_sub_u32 s26, s26, 1
    s_cmp_lg_u32 s26, 0
    s_cbranch_scc1 k2_L_55_1A
    v_mov_b32 v33, v32
    s_nop 1
    v_permlane32_swap_b32 v32, v33
    v_max_f32 v32, v32, v33
    v_sub_f32 v80, 0, v32
    v_mov_b32 v96, 0
    v_sub_f32 v81, 0, v32
    v_mov_b32 v97, 0
    v_sub_f32 v82, 0, v32
    v_mov_b32 v98, 0
    v_sub_f32 v83, 0, v32
    v_mov_b32 v99, 0
    v_sub_f32 v84, 0, v32
    v_mov_b32 v100, 0
    v_sub_f32 v85, 0, v32
    v_mov_b32 v101, 0
    v_sub_f32 v86, 0, v32
    v_mov_b32 v102, 0
    v_sub_f32 v87, 0, v32
    v_mov_b32 v103, 0
    v_sub_f32 v88, 0, v32
    v_mov_b32 v104, 0
    v_sub_f32 v89, 0, v32
    v_mov_b32 v105, 0
    v_sub_f32 v90, 0, v32
    v_mov_b32 v106, 0
    v_sub_f32 v91, 0, v32
    v_mov_b32 v107, 0
    v_sub_f32 v92, 0, v32
    v_mov_b32 v108, 0
    v_sub_f32 v93, 0, v32
    v_mov_b32 v109, 0
    v_sub_f32 v94, 0, v32
    v_mov_b32 v110, 0
    v_sub_f32 v95, 0, v32
    v_mov_b32 v111, 0
    v_mov_b32 v56, v12
    v_mov_b32 v57, v15
    v_mov_b32 v58, v18
    s_mov_b32 s26, 64
k2_L_55_2A:
    ds_read_b128 v[40:43], v56
    ds_read_b128 v[48:51], v57
    ds_read_b128 v[52:55], v58
    v_add_u32 v56, 2304, v56
    v_add_u32 v57, 2304, v57
    v_add_u32 v58, 2304, v58
    s_waitcnt lgkmcnt(0)
    v_mfma_f32_32x32x16_bf16 v[64:79], v[40:43], v[24:27], v[80:95]
    s_nop 11
    v_exp_f32 v64, v64
    v_exp_f32 v65, v65
    v_exp_f32 v66, v66
    v_exp_f32 v67, v67
    v_exp_f32 v68, v68
    v_exp_f32 v69, v69
    v_exp_f32 v70, v70
    v_exp_f32 v71, v71
    v_exp_f32 v72, v72
    v_exp_f32 v73, v73
    v_exp_f32 v74, v74
    v_exp_f32 v75, v75
    v_exp_f32 v76, v76
    v_exp_f32 v77, v77
    v_exp_f32 v78, v78
    v_exp_f32 v79, v79
    v_smfmac_f32_32x32x32_bf16 v[96:111], v[48:51], v[64:71], v39
    s_nop 0
    v_smfmac_f32_32x32x32_bf16 v[96:111], v[52:55], v[72:79], v39
    s_sub_u32 s26, s26, 1
    s_cmp_lg_u32 s26, 0
    s_cbranch_scc1 k2_L_55_2A
    s_nop 8
    v_rcp_f32 v105, v104
    s_nop 0
    v_pk_mul_f32 v[96:97], v[96:97], v[104:105] op_sel:[0,1] op_sel_hi:[1,1]
    v_pk_mul_f32 v[98:99], v[98:99], v[104:105] op_sel:[0,1] op_sel_hi:[1,1]
    v_pk_mul_f32 v[100:101], v[100:101], v[104:105] op_sel:[0,1] op_sel_hi:[1,1]
    v_pk_mul_f32 v[102:103], v[102:103], v[104:105] op_sel:[0,1] op_sel_hi:[1,1]
    v_cvt_pk_bf16_f32 v108, v96, v97
    v_cvt_pk_bf16_f32 v109, v98, v99
    v_cvt_pk_bf16_f32 v110, v100, v101
    v_cvt_pk_bf16_f32 v111, v102, v103
    global_store_dwordx4 v21, v[108:111], s[22:23] sc0 sc1
k2_L_55_KA:
    global_load_dwordx4 v[64:67], v4, s[34:35] offset:0 sc1
    global_load_dwordx4 v[68:71], v4, s[34:35] offset:1024 sc1
    global_load_dwordx4 v[72:75], v4, s[34:35] offset:2048 sc1
    global_load_dwordx4 v[76:79], v4, s[34:35] offset:3072 sc1
    v_lshlrev_b32 v136, 16, v138
    v_and_b32 v137, 0xffff0000, v138
    v_lshlrev_b32 v138, 16, v139
    v_and_b32 v139, 0xffff0000, v139
    s_waitcnt vmcnt(0)
    s_branch k2_L_57S
k2_L_59S:
k2_L_58L:
    global_load_dwordx4 v[64:67], v4, s[34:35] offset:0 sc1
    global_load_dwordx4 v[68:71], v4, s[34:35] offset:1024 sc1
    global_load_dwordx4 v[72:75], v4, s[34:35] offset:2048 sc1
    global_load_dwordx4 v[76:79], v4, s[34:35] offset:3072 sc1
    s_sub_u32 s67, s67, 1
    s_cbranch_scc1 k2_L_58X
    s_waitcnt vmcnt(0)
    v_max3_u32 v36, v64, v68, v72
    v_max_u32 v36, v36, v76
    v_cmp_eq_u32_e64 vcc, -1, v36
    s_cbranch_vccnz k2_L_58L
    s_branch k2_L_58Y
k2_L_58X:
    s_mov_b32 s67, 0
k2_L_58Y:
    s_waitcnt vmcnt(0)
    s_branch k2_L_59B
k2_L_61S:
    s_mov_b32 s96, m0
k2_L_60L:
    v_lshlrev_b32 v0, 2, v2
    v_add_u32 v0, 0, v0
    global_load_dwordx3 v[24:26], v0, s[44:45] sc1
    s_sub_u32 s67, s67, 1
    s_cbranch_scc1 k2_L_60X
    s_waitcnt vmcnt(0)
    v_max_u32 v24, v24, v26
    v_cmp_eq_u32 vcc, -1, v24
    s_cbranch_vccnz k2_L_60L
    s_branch k2_L_60Y
k2_L_60X:
    s_mov_b32 s67, 0
k2_L_60Y:
    s_add_u32 m0, s30, 0
    s_nop 0
    global_load_lds_dwordx4 v2, s[44:45] offset:0 sc1
    global_load_lds_dwordx4 v2, s[44:45] offset:1024 sc1
    global_load_lds_dwordx4 v2, s[44:45] offset:2048 sc1
    global_load_lds_dwordx4 v2, s[44:45] offset:3072 sc1
    s_waitcnt vmcnt(0)
    s_mov_b32 m0, s96
    s_branch k2_L_61B
k2_L_63S:
    s_mov_b32 s96, m0
k2_L_62L:
    v_lshlrev_b32 v0, 2, v2
    v_add_u32 v0, 16384, v0
    global_load_dwordx3 v[24:26], v0, s[44:45] sc1
    s_sub_u32 s67, s67, 1
    s_cbranch_scc1 k2_L_62X
    s_waitcnt vmcnt(0)
    v_max_u32 v24, v24, v26
    v_cmp_eq_u32 vcc, -1, v24
    s_cbranch_vccnz k2_L_62L
    s_branch k2_L_62Y
k2_L_62X:
    s_mov_b32 s67, 0
k2_L_62Y:
    s_add_u32 m0, s30, 16384
    s_nop 0
    global_load_lds_dwordx4 v4, s[44:45] offset:0 sc1
    global_load_lds_dwordx4 v4, s[44:45] offset:1024 sc1
    global_load_lds_dwordx4 v4, s[44:45] offset:2048 sc1
    global_load_lds_dwordx4 v4, s[44:45] offset:3072 sc1
    s_waitcnt vmcnt(0)
    s_mov_b32 m0, s96
    s_branch k2_L_63B
k2_L_65S:
k2_L_64L:
    global_load_dwordx4 v[112:115], v6, s[34:35] offset:0 sc1
    global_load_dwordx4 v[116:119], v6, s[34:35] offset:1024 sc1
    global_load_dwordx4 v[120:123], v6, s[34:35] offset:2048 sc1
    global_load_dwordx4 v[124:127], v6, s[34:35] offset:3072 sc1
    s_sub_u32 s67, s67, 1
    s_cbranch_scc1 k2_L_64X
    s_waitcnt vmcnt(0)
    v_max3_u32 v36, v112, v116, v120
    v_max_u32 v36, v36, v124
    v_cmp_eq_u32_e64 vcc, -1, v36
    s_cbranch_vccnz k2_L_64L
    s_branch k2_L_64Y
k2_L_64X:
    s_mov_b32 s67, 0
k2_L_64Y:
    s_waitcnt vmcnt(0)
    s_branch k2_L_65B
k2_L_67S:
k2_L_66L:
    global_load_dwordx4 v[96:99], v8, s[34:35] offset:0 sc1
    global_load_dwordx4 v[100:103], v8, s[34:35] offset:1024 sc1
    global_load_dwordx4 v[104:107], v8, s[34:35] offset:2048 sc1
    global_load_dwordx4 v[108:111], v8, s[34:35] offset:3072 sc1
    s_sub_u32 s67, s67, 1
    s_cbranch_scc1 k2_L_66X
    s_waitcnt vmcnt(0)
    v_max3_u32 v36, v96, v100, v104
    v_max_u32 v36, v36, v108
    v_cmp_eq_u32_e64 vcc, -1, v36
    s_cbranch_vccnz k2_L_66L
    s_branch k2_L_66Y
k2_L_66X:
    s_mov_b32 s67, 0
k2_L_66Y:
    s_waitcnt vmcnt(0)
    s_branch k2_L_67B
k2_L_69S:
    s_mov_b32 s96, m0
k2_L_68L:
    v_lshlrev_b32 v0, 2, v2
    v_add_u32 v0, 32768, v0
    global_load_dwordx3 v[24:26], v0, s[44:45] sc1
    s_sub_u32 s67, s67, 1
    s_cbranch_scc1 k2_L_68X
    s_waitcnt vmcnt(0)
    v_max_u32 v24, v24, v26
    v_cmp_eq_u32 vcc, -1, v24
    s_cbranch_vccnz k2_L_68L
    s_branch k2_L_68Y
k2_L_68X:
    s_mov_b32 s67, 0
k2_L_68Y:
    s_add_u32 m0, s30, 32768
    s_nop 0
    global_load_lds_dwordx4 v6, s[44:45] offset:0 sc1
    global_load_lds_dwordx4 v6, s[44:45] offset:1024 sc1
    global_load_lds_dwordx4 v6, s[44:45] offset:2048 sc1
    global_load_lds_dwordx4 v6, s[44:45] offset:3072 sc1
    s_waitcnt vmcnt(0)
    s_mov_b32 m0, s96
    s_branch k2_L_69B
k2_L_71S:
    s_mov_b32 s96, m0
k2_L_70L:
    v_lshlrev_b32 v0, 2, v2
    v_add_u32 v0, 49152, v0
    global_load_dwordx3 v[24:26], v0, s[44:45] sc1
    s_sub_u32 s67, s67, 1
    s_cbranch_scc1 k2_L_70X
    s_waitcnt vmcnt(0)
    v_max_u32 v24, v24, v26
    v_cmp_eq_u32 vcc, -1, v24
    s_cbranch_vccnz k2_L_70L
    s_branch k2_L_70Y
k2_L_70X:
    s_mov_b32 s67, 0
k2_L_70Y:
    s_add_u32 m0, s30, 49152
    s_nop 0
    global_load_lds_dwordx4 v8, s[44:45] offset:0 sc1
    global_load_lds_dwordx4 v8, s[44:45] offset:1024 sc1
    global_load_lds_dwordx4 v8, s[44:45] offset:2048 sc1
    global_load_lds_dwordx4 v8, s[44:45] offset:3072 sc1
    s_waitcnt vmcnt(0)
    s_mov_b32 m0, s96
    s_branch k2_L_71B
k2_L_73S:
k2_L_72L:
    global_load_dwordx4 v[72:75], v1, s[46:47] offset:0 sc1
    global_load_dwordx4 v[76:79], v1, s[46:47] offset:1024 sc1
    s_sub_u32 s67, s67, 1
    s_cbranch_scc1 k2_L_72X
    s_waitcnt vmcnt(0)
    v_max3_u32 v104, v72, v73, v74
    v_max3_u32 v108, v75, v76, v77
    v_max3_u32 v104, v104, v78, v79
    v_max_u32 v104, v104, v108
    v_cmp_eq_u32 vcc, -1, v104
    s_cbranch_vccnz k2_L_72L
    s_branch k2_L_72Y
k2_L_72X:
    s_mov_b32 s67, 0
k2_L_72Y:
    s_waitcnt vmcnt(0)
    s_branch k2_L_73B
k2_L_75S:
k2_L_74L:
    global_load_dwordx4 v[96:99], v1, s[46:47] offset:512 sc1
    global_load_dwordx4 v[100:103], v1, s[46:47] offset:1536 sc1
    s_sub_u32 s67, s67, 1
    s_cbranch_scc1 k2_L_74X
    s_waitcnt vmcnt(0)
    v_max3_u32 v106, v96, v97, v98
    v_max3_u32 v110, v99, v100, v101
    v_max3_u32 v106, v106, v102, v103
    v_max_u32 v106, v106, v110
    v_cmp_eq_u32 vcc, -1, v106
    s_cbranch_vccnz k2_L_74L
    s_branch k2_L_74Y
k2_L_74X:
    s_mov_b32 s67, 0
k2_L_74Y:
    s_waitcnt vmcnt(0)
    s_branch k2_L_75B
k2_L_77S:
    v_mov_b32 v0, v2
    s_mov_b32 s17, 16
k2_L_76L:
    global_load_dwordx4 v[24:27], v0, s[54:55] offset:0 sc1
    s_waitcnt vmcnt(0)
    v_max_u32 v24, v24, v26
    v_cmp_eq_u32 vcc, -1, v24
    s_cbranch_vccz k2_L_76N
    s_sub_u32 s67, s67, 1
    s_cbranch_scc0 k2_L_76L
    s_mov_b32 s67, 0
k2_L_76N:
    v_add_u32 v0, 1024, v0
    s_sub_u32 s17, s17, 1
    s_cmp_lg_u32 s17, 0
    s_cbranch_scc1 k2_L_76L
    v_mov_b32 v0, v2
    global_load_dwordx4 v[24:27], v0, s[54:55] sc1
    v_add_u32 v0, 1024, v0
    s_waitcnt vmcnt(0)
    v_mfma_f32_16x16x32_bf16 v[60:63], a[64:67], v[24:27], 0
    v_mfma_f32_16x16x32_bf16 v[64:67], a[128:131], v[24:27], 0
    v_mfma_f32_16x16x32_bf16 v[68:71], a[192:195], v[24:27], 0
    global_load_dwordx4 v[24:27], v0, s[54:55] sc1
    v_add_u32 v0, 1024, v0
    s_waitcnt vmcnt(0)
    v_mfma_f32_16x16x32_bf16 v[60:63], a[68:71], v[24:27], v[60:63]
    v_mfma_f32_16x16x32_bf16 v[64:67], a[132:135], v[24:27], v[64:67]
    v_mfma_f32_16x16x32_bf16 v[68:71], a[196:199], v[24:27], v[68:71]
    global_load_dwordx4 v[24:27], v0, s[54:55] sc1
    v_add_u32 v0, 1024, v0
    s_waitcnt vmcnt(0)
    v_mfma_f32_16x16x32_bf16 v[60:63], a[72:75], v[24:27], v[60:63]
    v_mfma_f32_16x16x32_bf16 v[64:67], a[136:139], v[24:27], v[64:67]
    v_mfma_f32_16x16x32_bf16 v[68:71], a[200:203], v[24:27], v[68:71]
    global_load_dwordx4 v[24:27], v0, s[54:55] sc1
    v_add_u32 v0, 1024, v0
    s_waitcnt vmcnt(0)
    v_mfma_f32_16x16x32_bf16 v[60:63], a[76:79], v[24:27], v[60:63]
    v_mfma_f32_16x16x32_bf16 v[64:67], a[140:143], v[24:27], v[64:67]
    v_mfma_f32_16x16x32_bf16 v[68:71], a[204:207], v[24:27], v[68:71]
    global_load_dwordx4 v[24:27], v0, s[54:55] sc1
    v_add_u32 v0, 1024, v0
    s_waitcnt vmcnt(0)
    v_mfma_f32_16x16x32_bf16 v[60:63], a[80:83], v[24:27], v[60:63]
    v_mfma_f32_16x16x32_bf16 v[64:67], a[144:147], v[24:27], v[64:67]
    v_mfma_f32_16x16x32_bf16 v[68:71], a[208:211], v[24:27], v[68:71]
    global_load_dwordx4 v[24:27], v0, s[54:55] sc1
    v_add_u32 v0, 1024, v0
    s_waitcnt vmcnt(0)
    v_mfma_f32_16x16x32_bf16 v[60:63], a[84:87], v[24:27], v[60:63]
    v_mfma_f32_16x16x32_bf16 v[64:67], a[148:151], v[24:27], v[64:67]
    v_mfma_f32_16x16x32_bf16 v[68:71], a[212:215], v[24:27], v[68:71]
    global_load_dwordx4 v[24:27], v0, s[54:55] sc1
    v_add_u32 v0, 1024, v0
    s_waitcnt vmcnt(0)
    v_mfma_f32_16x16x32_bf16 v[60:63], a[88:91], v[24:27], v[60:63]
    v_mfma_f32_16x16x32_bf16 v[64:67], a[152:155], v[24:27], v[64:67]
    v_mfma_f32_16x16x32_bf16 v[68:71], a[216:219], v[24:27], v[68:71]
    global_load_dwordx4 v[24:27], v0, s[54:55] sc1
    v_add_u32 v0, 1024, v0
    s_waitcnt vmcnt(0)
    v_mfma_f32_16x16x32_bf16 v[60:63], a[92:95], v[24:27], v[60:63]
    v_mfma_f32_16x16x32_bf16 v[64:67], a[156:159], v[24:27], v[64:67]
    v_mfma_f32_16x16x32_bf16 v[68:71], a[220:223], v[24:27], v[68:71]
    global_load_dwordx4 v[24:27], v0, s[54:55] sc1
    v_add_u32 v0, 1024, v0
    s_waitcnt vmcnt(0)
    v_mfma_f32_16x16x32_bf16 v[60:63], a[96:99], v[24:27], v[60:63]
    v_mfma_f32_16x16x32_bf16 v[64:67], a[160:163], v[24:27], v[64:67]
    v_mfma_f32_16x16x32_bf16 v[68:71], a[224:227], v[24:27], v[68:71]
    global_load_dwordx4 v[24:27], v0, s[54:55] sc1
    v_add_u32 v0, 1024, v0
    s_waitcnt vmcnt(0)
    v_mfma_f32_16x16x32_bf16 v[60:63], a[100:103], v[24:27], v[60:63]
    v_mfma_f32_16x16x32_bf16 v[64:67], a[164:167], v[24:27], v[64:67]
    v_mfma_f32_16x16x32_bf16 v[68:71], a[228:231], v[24:27], v[68:71]
    global_load_dwordx4 v[24:27], v0, s[54:55] sc1
    v_add_u32 v0, 1024, v0
    s_waitcnt vmcnt(0)
    v_mfma_f32_16x16x32_bf16 v[60:63], a[104:107], v[24:27], v[60:63]
    v_mfma_f32_16x16x32_bf16 v[64:67], a[168:171], v[24:27], v[64:67]
    v_mfma_f32_16x16x32_bf16 v[68:71], a[232:235], v[24:27], v[68:71]
    global_load_dwordx4 v[24:27], v0, s[54:55] sc1
    v_add_u32 v0, 1024, v0
    s_waitcnt vmcnt(0)
    v_mfma_f32_16x16x32_bf16 v[60:63], a[108:111], v[24:27], v[60:63]
    v_mfma_f32_16x16x32_bf16 v[64:67], a[172:175], v[24:27], v[64:67]
    v_mfma_f32_16x16x32_bf16 v[68:71], a[236:239], v[24:27], v[68:71]
    global_load_dwordx4 v[24:27], v0, s[54:55] sc1
    v_add_u32 v0, 1024, v0
    s_waitcnt vmcnt(0)
    v_mfma_f32_16x16x32_bf16 v[60:63], a[112:115], v[24:27], v[60:63]
    v_mfma_f32_16x16x32_bf16 v[64:67], a[176:179], v[24:27], v[64:67]
    v_mfma_f32_16x16x32_bf16 v[68:71], a[240:243], v[24:27], v[68:71]
    global_load_dwordx4 v[24:27], v0, s[54:55] sc1
    v_add_u32 v0, 1024, v0
    s_waitcnt vmcnt(0)
    v_mfma_f32_16x16x32_bf16 v[60:63], a[116:119], v[24:27], v[60:63]
    v_mfma_f32_16x16x32_bf16 v[64:67], a[180:183], v[24:27], v[64:67]
    v_mfma_f32_16x16x32_bf16 v[68:71], a[244:247], v[24:27], v[68:71]
    global_load_dwordx4 v[24:27], v0, s[54:55] sc1
    v_add_u32 v0, 1024, v0
    s_waitcnt vmcnt(0)
    v_mfma_f32_16x16x32_bf16 v[60:63], a[120:123], v[24:27], v[60:63]
    v_mfma_f32_16x16x32_bf16 v[64:67], a[184:187], v[24:27], v[64:67]
    v_mfma_f32_16x16x32_bf16 v[68:71], a[248:251], v[24:27], v[68:71]
    global_load_dwordx4 v[24:27], v0, s[54:55] sc1
    v_add_u32 v0, 1024, v0
    s_waitcnt vmcnt(0)
    v_mfma_f32_16x16x32_bf16 v[60:63], a[124:127], v[24:27], v[60:63]
    v_mfma_f32_16x16x32_bf16 v[64:67], a[188:191], v[24:27], v[64:67]
    v_mfma_f32_16x16x32_bf16 v[68:71], a[252:255], v[24:27], v[68:71]
    s_nop 7
    s_branch k2_L_77B
k2_L_79S:
    v_mov_b32 v0, v4
    s_mov_b32 s17, 16
k2_L_78L:
    global_load_dwordx4 v[24:27], v0, s[54:55] offset:0 sc1
    s_waitcnt vmcnt(0)
    v_max_u32 v24, v24, v26
    v_cmp_eq_u32 vcc, -1, v24
    s_cbranch_vccz k2_L_78N
    s_sub_u32 s67, s67, 1
    s_cbranch_scc0 k2_L_78L
    s_mov_b32 s67, 0
k2_L_78N:
    v_add_u32 v0, 1024, v0
    s_sub_u32 s17, s17, 1
    s_cmp_lg_u32 s17, 0
    s_cbranch_scc1 k2_L_78L
    v_mov_b32 v0, v4
    global_load_dwordx4 v[24:27], v0, s[54:55] sc1
    v_add_u32 v0, 1024, v0
    s_waitcnt vmcnt(0)
    v_mfma_f32_16x16x32_bf16 v[44:47], a[64:67], v[24:27], 0
    v_mfma_f32_16x16x32_bf16 v[48:51], a[128:131], v[24:27], 0
    v_mfma_f32_16x16x32_bf16 v[52:55], a[192:195], v[24:27], 0
    global_load_dwordx4 v[24:27], v0, s[54:55] sc1
    v_add_u32 v0, 1024, v0
    s_waitcnt vmcnt(0)
    v_mfma_f32_16x16x32_bf16 v[44:47], a[68:71], v[24:27], v[44:47]
    v_mfma_f32_16x16x32_bf16 v[48:51], a[132:135], v[24:27], v[48:51]
    v_mfma_f32_16x16x32_bf16 v[52:55], a[196:199], v[24:27], v[52:55]
    global_load_dwordx4 v[24:27], v0, s[54:55] sc1
    v_add_u32 v0, 1024, v0
    s_waitcnt vmcnt(0)
    v_mfma_f32_16x16x32_bf16 v[44:47], a[72:75], v[24:27], v[44:47]
    v_mfma_f32_16x16x32_bf16 v[48:51], a[136:139], v[24:27], v[48:51]
    v_mfma_f32_16x16x32_bf16 v[52:55], a[200:203], v[24:27], v[52:55]
    global_load_dwordx4 v[24:27], v0, s[54:55] sc1
    v_add_u32 v0, 1024, v0
    s_waitcnt vmcnt(0)
    v_mfma_f32_16x16x32_bf16 v[44:47], a[76:79], v[24:27], v[44:47]
    v_mfma_f32_16x16x32_bf16 v[48:51], a[140:143], v[24:27], v[48:51]
    v_mfma_f32_16x16x32_bf16 v[52:55], a[204:207], v[24:27], v[52:55]
    global_load_dwordx4 v[24:27], v0, s[54:55] sc1
    v_add_u32 v0, 1024, v0
    s_waitcnt vmcnt(0)
    v_mfma_f32_16x16x32_bf16 v[44:47], a[80:83], v[24:27], v[44:47]
    v_mfma_f32_16x16x32_bf16 v[48:51], a[144:147], v[24:27], v[48:51]
    v_mfma_f32_16x16x32_bf16 v[52:55], a[208:211], v[24:27], v[52:55]
    global_load_dwordx4 v[24:27], v0, s[54:55] sc1
    v_add_u32 v0, 1024, v0
    s_waitcnt vmcnt(0)
    v_mfma_f32_16x16x32_bf16 v[44:47], a[84:87], v[24:27], v[44:47]
    v_mfma_f32_16x16x32_bf16 v[48:51], a[148:151], v[24:27], v[48:51]
    v_mfma_f32_16x16x32_bf16 v[52:55], a[212:215], v[24:27], v[52:55]
    global_load_dwordx4 v[24:27], v0, s[54:55] sc1
    v_add_u32 v0, 1024, v0
    s_waitcnt vmcnt(0)
    v_mfma_f32_16x16x32_bf16 v[44:47], a[88:91], v[24:27], v[44:47]
    v_mfma_f32_16x16x32_bf16 v[48:51], a[152:155], v[24:27], v[48:51]
    v_mfma_f32_16x16x32_bf16 v[52:55], a[216:219], v[24:27], v[52:55]
    global_load_dwordx4 v[24:27], v0, s[54:55] sc1
    v_add_u32 v0, 1024, v0
    s_waitcnt vmcnt(0)
    v_mfma_f32_16x16x32_bf16 v[44:47], a[92:95], v[24:27], v[44:47]
    v_mfma_f32_16x16x32_bf16 v[48:51], a[156:159], v[24:27], v[48:51]
    v_mfma_f32_16x16x32_bf16 v[52:55], a[220:223], v[24:27], v[52:55]
    global_load_dwordx4 v[24:27], v0, s[54:55] sc1
    v_add_u32 v0, 1024, v0
    s_waitcnt vmcnt(0)
    v_mfma_f32_16x16x32_bf16 v[44:47], a[96:99], v[24:27], v[44:47]
    v_mfma_f32_16x16x32_bf16 v[48:51], a[160:163], v[24:27], v[48:51]
    v_mfma_f32_16x16x32_bf16 v[52:55], a[224:227], v[24:27], v[52:55]
    global_load_dwordx4 v[24:27], v0, s[54:55] sc1
    v_add_u32 v0, 1024, v0
    s_waitcnt vmcnt(0)
    v_mfma_f32_16x16x32_bf16 v[44:47], a[100:103], v[24:27], v[44:47]
    v_mfma_f32_16x16x32_bf16 v[48:51], a[164:167], v[24:27], v[48:51]
    v_mfma_f32_16x16x32_bf16 v[52:55], a[228:231], v[24:27], v[52:55]
    global_load_dwordx4 v[24:27], v0, s[54:55] sc1
    v_add_u32 v0, 1024, v0
    s_waitcnt vmcnt(0)
    v_mfma_f32_16x16x32_bf16 v[44:47], a[104:107], v[24:27], v[44:47]
    v_mfma_f32_16x16x32_bf16 v[48:51], a[168:171], v[24:27], v[48:51]
    v_mfma_f32_16x16x32_bf16 v[52:55], a[232:235], v[24:27], v[52:55]
    global_load_dwordx4 v[24:27], v0, s[54:55] sc1
    v_add_u32 v0, 1024, v0
    s_waitcnt vmcnt(0)
    v_mfma_f32_16x16x32_bf16 v[44:47], a[108:111], v[24:27], v[44:47]
    v_mfma_f32_16x16x32_bf16 v[48:51], a[172:175], v[24:27], v[48:51]
    v_mfma_f32_16x16x32_bf16 v[52:55], a[236:239], v[24:27], v[52:55]
    global_load_dwordx4 v[24:27], v0, s[54:55] sc1
    v_add_u32 v0, 1024, v0
    s_waitcnt vmcnt(0)
    v_mfma_f32_16x16x32_bf16 v[44:47], a[112:115], v[24:27], v[44:47]
    v_mfma_f32_16x16x32_bf16 v[48:51], a[176:179], v[24:27], v[48:51]
    v_mfma_f32_16x16x32_bf16 v[52:55], a[240:243], v[24:27], v[52:55]
    global_load_dwordx4 v[24:27], v0, s[54:55] sc1
    v_add_u32 v0, 1024, v0
    s_waitcnt vmcnt(0)
    v_mfma_f32_16x16x32_bf16 v[44:47], a[116:119], v[24:27], v[44:47]
    v_mfma_f32_16x16x32_bf16 v[48:51], a[180:183], v[24:27], v[48:51]
    v_mfma_f32_16x16x32_bf16 v[52:55], a[244:247], v[24:27], v[52:55]
    global_load_dwordx4 v[24:27], v0, s[54:55] sc1
    v_add_u32 v0, 1024, v0
    s_waitcnt vmcnt(0)
    v_mfma_f32_16x16x32_bf16 v[44:47], a[120:123], v[24:27], v[44:47]
    v_mfma_f32_16x16x32_bf16 v[48:51], a[184:187], v[24:27], v[48:51]
    v_mfma_f32_16x16x32_bf16 v[52:55], a[248:251], v[24:27], v[52:55]
    global_load_dwordx4 v[24:27], v0, s[54:55] sc1
    v_add_u32 v0, 1024, v0
    s_waitcnt vmcnt(0)
    v_mfma_f32_16x16x32_bf16 v[44:47], a[124:127], v[24:27], v[44:47]
    v_mfma_f32_16x16x32_bf16 v[48:51], a[188:191], v[24:27], v[48:51]
    v_mfma_f32_16x16x32_bf16 v[52:55], a[252:255], v[24:27], v[52:55]
    s_nop 7
    s_branch k2_L_79B
k2_L_81S:
    v_mov_b32 v0, v6
    s_mov_b32 s17, 16
k2_L_80L:
    global_load_dwordx4 v[24:27], v0, s[54:55] offset:0 sc1
    s_waitcnt vmcnt(0)
    v_max_u32 v24, v24, v26
    v_cmp_eq_u32 vcc, -1, v24
    s_cbranch_vccz k2_L_80N
    s_sub_u32 s67, s67, 1
    s_cbranch_scc0 k2_L_80L
    s_mov_b32 s67, 0
k2_L_80N:
    v_add_u32 v0, 1024, v0
    s_sub_u32 s17, s17, 1
    s_cmp_lg_u32 s17, 0
    s_cbranch_scc1 k2_L_80L
    v_mov_b32 v0, v6
    global_load_dwordx4 v[24:27], v0, s[54:55] sc1
    v_add_u32 v0, 1024, v0
    global_load_dwordx4 v[84:87], v2, s[58:59] offset:-4096
    global_load_dwordx4 v[88:91], v2, s[60:61] offset:-4096
    global_load_dwordx4 v[92:95], v2, s[62:63] offset:-4096
    s_waitcnt vmcnt(0)
    v_mfma_f32_16x16x32_bf16 v[72:75], v[84:87], v[24:27], 0
    v_mfma_f32_16x16x32_bf16 v[76:79], v[88:91], v[24:27], 0
    v_mfma_f32_16x16x32_bf16 v[80:83], v[92:95], v[24:27], 0
    global_load_dwordx4 v[24:27], v0, s[54:55] sc1
    v_add_u32 v0, 1024, v0
    global_load_dwordx4 v[84:87], v2, s[58:59] offset:-3072
    global_load_dwordx4 v[88:91], v2, s[60:61] offset:-3072
    global_load_dwordx4 v[92:95], v2, s[62:63] offset:-3072
    s_waitcnt vmcnt(0)
    v_mfma_f32_16x16x32_bf16 v[72:75], v[84:87], v[24:27], v[72:75]
    v_mfma_f32_16x16x32_bf16 v[76:79], v[88:91], v[24:27], v[76:79]
    v_mfma_f32_16x16x32_bf16 v[80:83], v[92:95], v[24:27], v[80:83]
    global_load_dwordx4 v[24:27], v0, s[54:55] sc1
    v_add_u32 v0, 1024, v0
    global_load_dwordx4 v[84:87], v2, s[58:59] offset:-2048
    global_load_dwordx4 v[88:91], v2, s[60:61] offset:-2048
    global_load_dwordx4 v[92:95], v2, s[62:63] offset:-2048
    s_waitcnt vmcnt(0)
    v_mfma_f32_16x16x32_bf16 v[72:75], v[84:87], v[24:27], v[72:75]
    v_mfma_f32_16x16x32_bf16 v[76:79], v[88:91], v[24:27], v[76:79]
    v_mfma_f32_16x16x32_bf16 v[80:83], v[92:95], v[24:27], v[80:83]
    global_load_dwordx4 v[24:27], v0, s[54:55] sc1
    v_add_u32 v0, 1024, v0
    global_load_dwordx4 v[84:87], v2, s[58:59] offset:-1024
    global_load_dwordx4 v[88:91], v2, s[60:61] offset:-1024
    global_load_dwordx4 v[92:95], v2, s[62:63] offset:-1024
    s_waitcnt vmcnt(0)
    v_mfma_f32_16x16x32_bf16 v[72:75], v[84:87], v[24:27], v[72:75]
    v_mfma_f32_16x16x32_bf16 v[76:79], v[88:91], v[24:27], v[76:79]
    v_mfma_f32_16x16x32_bf16 v[80:83], v[92:95], v[24:27], v[80:83]
    global_load_dwordx4 v[24:27], v0, s[54:55] sc1
    v_add_u32 v0, 1024, v0
    global_load_dwordx4 v[84:87], v2, s[58:59] offset:0
    global_load_dwordx4 v[88:91], v2, s[60:61] offset:0
    global_load_dwordx4 v[92:95], v2, s[62:63] offset:0
    s_waitcnt vmcnt(0)
    v_mfma_f32_16x16x32_bf16 v[72:75], v[84:87], v[24:27], v[72:75]
    v_mfma_f32_16x16x32_bf16 v[76:79], v[88:91], v[24:27], v[76:79]
    v_mfma_f32_16x16x32_bf16 v[80:83], v[92:95], v[24:27], v[80:83]
    global_load_dwordx4 v[24:27], v0, s[54:55] sc1
    v_add_u32 v0, 1024, v0
    global_load_dwordx4 v[84:87], v2, s[58:59] offset:1024
    global_load_dwordx4 v[88:91], v2, s[60:61] offset:1024
    global_load_dwordx4 v[92:95], v2, s[62:63] offset:1024
    s_waitcnt vmcnt(0)
    v_mfma_f32_16x16x32_bf16 v[72:75], v[84:87], v[24:27], v[72:75]
    v_mfma_f32_16x16x32_bf16 v[76:79], v[88:91], v[24:27], v[76:79]
    v_mfma_f32_16x16x32_bf16 v[80:83], v[92:95], v[24:27], v[80:83]
    global_load_dwordx4 v[24:27], v0, s[54:55] sc1
    v_add_u32 v0, 1024, v0
    global_load_dwordx4 v[84:87], v2, s[58:59] offset:2048
    global_load_dwordx4 v[88:91], v2, s[60:61] offset:2048
    global_load_dwordx4 v[92:95], v2, s[62:63] offset:2048
    s_waitcnt vmcnt(0)
    v_mfma_f32_16x16x32_bf16 v[72:75], v[84:87], v[24:27], v[72:75]
    v_mfma_f32_16x16x32_bf16 v[76:79], v[88:91], v[24:27], v[76:79]
    v_mfma_f32_16x16x32_bf16 v[80:83], v[92:95], v[24:27], v[80:83]
    global_load_dwordx4 v[24:27], v0, s[54:55] sc1
    v_add_u32 v0, 1024, v0
    global_load_dwordx4 v[84:87], v2, s[58:59] offset:3072
    global_load_dwordx4 v[88:91], v2, s[60:61] offset:3072
    global_load_dwordx4 v[92:95], v2, s[62:63] offset:3072
    s_waitcnt vmcnt(0)
    v_mfma_f32_16x16x32_bf16 v[72:75], v[84:87], v[24:27], v[72:75]
    v_mfma_f32_16x16x32_bf16 v[76:79], v[88:91], v[24:27], v[76:79]
    v_mfma_f32_16x16x32_bf16 v[80:83], v[92:95], v[24:27], v[80:83]
    global_load_dwordx4 v[24:27], v0, s[54:55] sc1
    v_add_u32 v0, 1024, v0
    global_load_dwordx4 v[84:87], v3, s[58:59] offset:-4096
    global_load_dwordx4 v[88:91], v3, s[60:61] offset:-4096
    global_load_dwordx4 v[92:95], v3, s[62:63] offset:-4096
    s_waitcnt vmcnt(0)
    v_mfma_f32_16x16x32_bf16 v[72:75], v[84:87], v[24:27], v[72:75]
    v_mfma_f32_16x16x32_bf16 v[76:79], v[88:91], v[24:27], v[76:79]
    v_mfma_f32_16x16x32_bf16 v[80:83], v[92:95], v[24:27], v[80:83]
    global_load_dwordx4 v[24:27], v0, s[54:55] sc1
    v_add_u32 v0, 1024, v0
    global_load_dwordx4 v[84:87], v3, s[58:59] offset:-3072
    global_load_dwordx4 v[88:91], v3, s[60:61] offset:-3072
    global_load_dwordx4 v[92:95], v3, s[62:63] offset:-3072
    s_waitcnt vmcnt(0)
    v_mfma_f32_16x16x32_bf16 v[72:75], v[84:87], v[24:27], v[72:75]
    v_mfma_f32_16x16x32_bf16 v[76:79], v[88:91], v[24:27], v[76:79]
    v_mfma_f32_16x16x32_bf16 v[80:83], v[92:95], v[24:27], v[80:83]
    global_load_dwordx4 v[24:27], v0, s[54:55] sc1
    v_add_u32 v0, 1024, v0
    global_load_dwordx4 v[84:87], v3, s[58:59] offset:-2048
    global_load_dwordx4 v[88:91], v3, s[60:61] offset:-2048
    global_load_dwordx4 v[92:95], v3, s[62:63] offset:-2048
    s_waitcnt vmcnt(0)
    v_mfma_f32_16x16x32_bf16 v[72:75], v[84:87], v[24:27], v[72:75]
    v_mfma_f32_16x16x32_bf16 v[76:79], v[88:91], v[24:27], v[76:79]
    v_mfma_f32_16x16x32_bf16 v[80:83], v[92:95], v[24:27], v[80:83]
    global_load_dwordx4 v[24:27], v0, s[54:55] sc1
    v_add_u32 v0, 1024, v0
    global_load_dwordx4 v[84:87], v3, s[58:59] offset:-1024
    global_load_dwordx4 v[88:91], v3, s[60:61] offset:-1024
    global_load_dwordx4 v[92:95], v3, s[62:63] offset:-1024
    s_waitcnt vmcnt(0)
    v_mfma_f32_16x16x32_bf16 v[72:75], v[84:87], v[24:27], v[72:75]
    v_mfma_f32_16x16x32_bf16 v[76:79], v[88:91], v[24:27], v[76:79]
    v_mfma_f32_16x16x32_bf16 v[80:83], v[92:95], v[24:27], v[80:83]
    global_load_dwordx4 v[24:27], v0, s[54:55] sc1
    v_add_u32 v0, 1024, v0
    global_load_dwordx4 v[84:87], v3, s[58:59] offset:0
    global_load_dwordx4 v[88:91], v3, s[60:61] offset:0
    global_load_dwordx4 v[92:95], v3, s[62:63] offset:0
    s_waitcnt vmcnt(0)
    v_mfma_f32_16x16x32_bf16 v[72:75], v[84:87], v[24:27], v[72:75]
    v_mfma_f32_16x16x32_bf16 v[76:79], v[88:91], v[24:27], v[76:79]
    v_mfma_f32_16x16x32_bf16 v[80:83], v[92:95], v[24:27], v[80:83]
    global_load_dwordx4 v[24:27], v0, s[54:55] sc1
    v_add_u32 v0, 1024, v0
    global_load_dwordx4 v[84:87], v3, s[58:59] offset:1024
    global_load_dwordx4 v[88:91], v3, s[60:61] offset:1024
    global_load_dwordx4 v[92:95], v3, s[62:63] offset:1024
    s_waitcnt vmcnt(0)
    v_mfma_f32_16x16x32_bf16 v[72:75], v[84:87], v[24:27], v[72:75]
    v_mfma_f32_16x16x32_bf16 v[76:79], v[88:91], v[24:27], v[76:79]
    v_mfma_f32_16x16x32_bf16 v[80:83], v[92:95], v[24:27], v[80:83]
    global_load_dwordx4 v[24:27], v0, s[54:55] sc1
    v_add_u32 v0, 1024, v0
    global_load_dwordx4 v[84:87], v3, s[58:59] offset:2048
    global_load_dwordx4 v[88:91], v3, s[60:61] offset:2048
    global_load_dwordx4 v[92:95], v3, s[62:63] offset:2048
    s_waitcnt vmcnt(0)
    v_mfma_f32_16x16x32_bf16 v[72:75], v[84:87], v[24:27], v[72:75]
    v_mfma_f32_16x16x32_bf16 v[76:79], v[88:91], v[24:27], v[76:79]
    v_mfma_f32_16x16x32_bf16 v[80:83], v[92:95], v[24:27], v[80:83]
    global_load_dwordx4 v[24:27], v0, s[54:55] sc1
    v_add_u32 v0, 1024, v0
    global_load_dwordx4 v[84:87], v3, s[58:59] offset:3072
    global_load_dwordx4 v[88:91], v3, s[60:61] offset:3072
    global_load_dwordx4 v[92:95], v3, s[62:63] offset:3072
    s_waitcnt vmcnt(0)
    v_mfma_f32_16x16x32_bf16 v[72:75], v[84:87], v[24:27], v[72:75]
    v_mfma_f32_16x16x32_bf16 v[76:79], v[88:91], v[24:27], v[76:79]
    v_mfma_f32_16x16x32_bf16 v[80:83], v[92:95], v[24:27], v[80:83]
    s_nop 7
    s_branch k2_L_81B
k2_L_83S:
    v_mov_b32 v0, v8
    s_mov_b32 s17, 16
k2_L_82L:
    global_load_dwordx4 v[24:27], v0, s[54:55] offset:0 sc1
    s_waitcnt vmcnt(0)
    v_max_u32 v24, v24, v26
    v_cmp_eq_u32 vcc, -1, v24
    s_cbranch_vccz k2_L_82N
    s_sub_u32 s67, s67, 1
    s_cbranch_scc0 k2_L_82L
    s_mov_b32 s67, 0
k2_L_82N:
    v_add_u32 v0, 1024, v0
    s_sub_u32 s17, s17, 1
    s_cmp_lg_u32 s17, 0
    s_cbranch_scc1 k2_L_82L
    v_mov_b32 v0, v8
    global_load_dwordx4 v[24:27], v0, s[54:55] sc1
    v_add_u32 v0, 1024, v0
    global_load_dwordx4 v[84:87], v2, s[58:59] offset:-4096
    global_load_dwordx4 v[88:91], v2, s[60:61] offset:-4096
    global_load_dwordx4 v[92:95], v2, s[62:63] offset:-4096
    s_waitcnt vmcnt(0)
    v_mfma_f32_16x16x32_bf16 v[60:63], v[84:87], v[24:27], 0
    v_mfma_f32_16x16x32_bf16 v[64:67], v[88:91], v[24:27], 0
    v_mfma_f32_16x16x32_bf16 v[68:71], v[92:95], v[24:27], 0
    global_load_dwordx4 v[24:27], v0, s[54:55] sc1
    v_add_u32 v0, 1024, v0
    global_load_dwordx4 v[84:87], v2, s[58:59] offset:-3072
    global_load_dwordx4 v[88:91], v2, s[60:61] offset:-3072
    global_load_dwordx4 v[92:95], v2, s[62:63] offset:-3072
    s_waitcnt vmcnt(0)
    v_mfma_f32_16x16x32_bf16 v[60:63], v[84:87], v[24:27], v[60:63]
    v_mfma_f32_16x16x32_bf16 v[64:67], v[88:91], v[24:27], v[64:67]
    v_mfma_f32_16x16x32_bf16 v[68:71], v[92:95], v[24:27], v[68:71]
    global_load_dwordx4 v[24:27], v0, s[54:55] sc1
    v_add_u32 v0, 1024, v0
    global_load_dwordx4 v[84:87], v2, s[58:59] offset:-2048
    global_load_dwordx4 v[88:91], v2, s[60:61] offset:-2048
    global_load_dwordx4 v[92:95], v2, s[62:63] offset:-2048
    s_waitcnt vmcnt(0)
    v_mfma_f32_16x16x32_bf16 v[60:63], v[84:87], v[24:27], v[60:63]
    v_mfma_f32_16x16x32_bf16 v[64:67], v[88:91], v[24:27], v[64:67]
    v_mfma_f32_16x16x32_bf16 v[68:71], v[92:95], v[24:27], v[68:71]
    global_load_dwordx4 v[24:27], v0, s[54:55] sc1
    v_add_u32 v0, 1024, v0
    global_load_dwordx4 v[84:87], v2, s[58:59] offset:-1024
    global_load_dwordx4 v[88:91], v2, s[60:61] offset:-1024
    global_load_dwordx4 v[92:95], v2, s[62:63] offset:-1024
    s_waitcnt vmcnt(0)
    v_mfma_f32_16x16x32_bf16 v[60:63], v[84:87], v[24:27], v[60:63]
    v_mfma_f32_16x16x32_bf16 v[64:67], v[88:91], v[24:27], v[64:67]
    v_mfma_f32_16x16x32_bf16 v[68:71], v[92:95], v[24:27], v[68:71]
    global_load_dwordx4 v[24:27], v0, s[54:55] sc1
    v_add_u32 v0, 1024, v0
    global_load_dwordx4 v[84:87], v2, s[58:59] offset:0
    global_load_dwordx4 v[88:91], v2, s[60:61] offset:0
    global_load_dwordx4 v[92:95], v2, s[62:63] offset:0
    s_waitcnt vmcnt(0)
    v_mfma_f32_16x16x32_bf16 v[60:63], v[84:87], v[24:27], v[60:63]
    v_mfma_f32_16x16x32_bf16 v[64:67], v[88:91], v[24:27], v[64:67]
    v_mfma_f32_16x16x32_bf16 v[68:71], v[92:95], v[24:27], v[68:71]
    global_load_dwordx4 v[24:27], v0, s[54:55] sc1
    v_add_u32 v0, 1024, v0
    global_load_dwordx4 v[84:87], v2, s[58:59] offset:1024
    global_load_dwordx4 v[88:91], v2, s[60:61] offset:1024
    global_load_dwordx4 v[92:95], v2, s[62:63] offset:1024
    s_waitcnt vmcnt(0)
    v_mfma_f32_16x16x32_bf16 v[60:63], v[84:87], v[24:27], v[60:63]
    v_mfma_f32_16x16x32_bf16 v[64:67], v[88:91], v[24:27], v[64:67]
    v_mfma_f32_16x16x32_bf16 v[68:71], v[92:95], v[24:27], v[68:71]
    global_load_dwordx4 v[24:27], v0, s[54:55] sc1
    v_add_u32 v0, 1024, v0
    global_load_dwordx4 v[84:87], v2, s[58:59] offset:2048
    global_load_dwordx4 v[88:91], v2, s[60:61] offset:2048
    global_load_dwordx4 v[92:95], v2, s[62:63] offset:2048
    s_waitcnt vmcnt(0)
    v_mfma_f32_16x16x32_bf16 v[60:63], v[84:87], v[24:27], v[60:63]
    v_mfma_f32_16x16x32_bf16 v[64:67], v[88:91], v[24:27], v[64:67]
    v_mfma_f32_16x16x32_bf16 v[68:71], v[92:95], v[24:27], v[68:71]
    global_load_dwordx4 v[24:27], v0, s[54:55] sc1
    v_add_u32 v0, 1024, v0
    global_load_dwordx4 v[84:87], v2, s[58:59] offset:3072
    global_load_dwordx4 v[88:91], v2, s[60:61] offset:3072
    global_load_dwordx4 v[92:95], v2, s[62:63] offset:3072
    s_waitcnt vmcnt(0)
    v_mfma_f32_16x16x32_bf16 v[60:63], v[84:87], v[24:27], v[60:63]
    v_mfma_f32_16x16x32_bf16 v[64:67], v[88:91], v[24:27], v[64:67]
    v_mfma_f32_16x16x32_bf16 v[68:71], v[92:95], v[24:27], v[68:71]
    global_load_dwordx4 v[24:27], v0, s[54:55] sc1
    v_add_u32 v0, 1024, v0
    global_load_dwordx4 v[84:87], v3, s[58:59] offset:-4096
    global_load_dwordx4 v[88:91], v3, s[60:61] offset:-4096
    global_load_dwordx4 v[92:95], v3, s[62:63] offset:-4096
    s_waitcnt vmcnt(0)
    v_mfma_f32_16x16x32_bf16 v[60:63], v[84:87], v[24:27], v[60:63]
    v_mfma_f32_16x16x32_bf16 v[64:67], v[88:91], v[24:27], v[64:67]
    v_mfma_f32_16x16x32_bf16 v[68:71], v[92:95], v[24:27], v[68:71]
    global_load_dwordx4 v[24:27], v0, s[54:55] sc1
    v_add_u32 v0, 1024, v0
    global_load_dwordx4 v[84:87], v3, s[58:59] offset:-3072
    global_load_dwordx4 v[88:91], v3, s[60:61] offset:-3072
    global_load_dwordx4 v[92:95], v3, s[62:63] offset:-3072
    s_waitcnt vmcnt(0)
    v_mfma_f32_16x16x32_bf16 v[60:63], v[84:87], v[24:27], v[60:63]
    v_mfma_f32_16x16x32_bf16 v[64:67], v[88:91], v[24:27], v[64:67]
    v_mfma_f32_16x16x32_bf16 v[68:71], v[92:95], v[24:27], v[68:71]
    global_load_dwordx4 v[24:27], v0, s[54:55] sc1
    v_add_u32 v0, 1024, v0
    global_load_dwordx4 v[84:87], v3, s[58:59] offset:-2048
    global_load_dwordx4 v[88:91], v3, s[60:61] offset:-2048
    global_load_dwordx4 v[92:95], v3, s[62:63] offset:-2048
    s_waitcnt vmcnt(0)
    v_mfma_f32_16x16x32_bf16 v[60:63], v[84:87], v[24:27], v[60:63]
    v_mfma_f32_16x16x32_bf16 v[64:67], v[88:91], v[24:27], v[64:67]
    v_mfma_f32_16x16x32_bf16 v[68:71], v[92:95], v[24:27], v[68:71]
    global_load_dwordx4 v[24:27], v0, s[54:55] sc1
    v_add_u32 v0, 1024, v0
    global_load_dwordx4 v[84:87], v3, s[58:59] offset:-1024
    global_load_dwordx4 v[88:91], v3, s[60:61] offset:-1024
    global_load_dwordx4 v[92:95], v3, s[62:63] offset:-1024
    s_waitcnt vmcnt(0)
    v_mfma_f32_16x16x32_bf16 v[60:63], v[84:87], v[24:27], v[60:63]
    v_mfma_f32_16x16x32_bf16 v[64:67], v[88:91], v[24:27], v[64:67]
    v_mfma_f32_16x16x32_bf16 v[68:71], v[92:95], v[24:27], v[68:71]
    global_load_dwordx4 v[24:27], v0, s[54:55] sc1
    v_add_u32 v0, 1024, v0
    global_load_dwordx4 v[84:87], v3, s[58:59] offset:0
    global_load_dwordx4 v[88:91], v3, s[60:61] offset:0
    global_load_dwordx4 v[92:95], v3, s[62:63] offset:0
    s_waitcnt vmcnt(0)
    v_mfma_f32_16x16x32_bf16 v[60:63], v[84:87], v[24:27], v[60:63]
    v_mfma_f32_16x16x32_bf16 v[64:67], v[88:91], v[24:27], v[64:67]
    v_mfma_f32_16x16x32_bf16 v[68:71], v[92:95], v[24:27], v[68:71]
    global_load_dwordx4 v[24:27], v0, s[54:55] sc1
    v_add_u32 v0, 1024, v0
    global_load_dwordx4 v[84:87], v3, s[58:59] offset:1024
    global_load_dwordx4 v[88:91], v3, s[60:61] offset:1024
    global_load_dwordx4 v[92:95], v3, s[62:63] offset:1024
    s_waitcnt vmcnt(0)
    v_mfma_f32_16x16x32_bf16 v[60:63], v[84:87], v[24:27], v[60:63]
    v_mfma_f32_16x16x32_bf16 v[64:67], v[88:91], v[24:27], v[64:67]
    v_mfma_f32_16x16x32_bf16 v[68:71], v[92:95], v[24:27], v[68:71]
    global_load_dwordx4 v[24:27], v0, s[54:55] sc1
    v_add_u32 v0, 1024, v0
    global_load_dwordx4 v[84:87], v3, s[58:59] offset:2048
    global_load_dwordx4 v[88:91], v3, s[60:61] offset:2048
    global_load_dwordx4 v[92:95], v3, s[62:63] offset:2048
    s_waitcnt vmcnt(0)
    v_mfma_f32_16x16x32_bf16 v[60:63], v[84:87], v[24:27], v[60:63]
    v_mfma_f32_16x16x32_bf16 v[64:67], v[88:91], v[24:27], v[64:67]
    v_mfma_f32_16x16x32_bf16 v[68:71], v[92:95], v[24:27], v[68:71]
    global_load_dwordx4 v[24:27], v0, s[54:55] sc1
    v_add_u32 v0, 1024, v0
    global_load_dwordx4 v[84:87], v3, s[58:59] offset:3072
    global_load_dwordx4 v[88:91], v3, s[60:61] offset:3072
    global_load_dwordx4 v[92:95], v3, s[62:63] offset:3072
    s_waitcnt vmcnt(0)
    v_mfma_f32_16x16x32_bf16 v[60:63], v[84:87], v[24:27], v[60:63]
    v_mfma_f32_16x16x32_bf16 v[64:67], v[88:91], v[24:27], v[64:67]
    v_mfma_f32_16x16x32_bf16 v[68:71], v[92:95], v[24:27], v[68:71]
    s_nop 7
    s_branch k2_L_83B
k2_L_85S:
k2_L_84L:
    v_bfe_u32 v0, v2, 4, 4
    v_min_u32 v0, s31, v0
    v_lshlrev_b32 v0, 12, v0
    v_and_b32 v24, 0x300, v2
    v_add_u32 v0, v0, v24
    global_load_dwordx3 v[24:26], v0, s[52:53] offset:-3968 sc1
    s_sub_u32 s67, s67, 1
    s_cbranch_scc1 k2_L_84X
    s_waitcnt vmcnt(0)
    v_max_u32 v24, v24, v26
    v_cmp_eq_u32 vcc, -1, v24
    s_cbranch_vccnz k2_L_84L
    s_branch k2_L_84Y
k2_L_84X:
    s_mov_b32 s67, 0
k2_L_84Y:
    global_load_dwordx4 a[64:67], v2, s[52:53] offset:-4096 sc1
    global_load_dwordx4 a[128:131], v2, s[52:53] offset:0 sc1
    global_load_dwordx4 a[192:195], v3, s[52:53] offset:-4096 sc1
    global_load_dwordx4 a[68:71], v3, s[52:53] offset:0 sc1
    global_load_dwordx4 a[132:135], v4, s[52:53] offset:-4096 sc1
    global_load_dwordx4 a[196:199], v4, s[52:53] offset:0 sc1
    global_load_dwordx4 a[72:75], v5, s[52:53] offset:-4096 sc1
    global_load_dwordx4 a[136:139], v5, s[52:53] offset:0 sc1
    global_load_dwordx4 a[200:203], v6, s[52:53] offset:-4096 sc1
    global_load_dwordx4 a[76:79], v6, s[52:53] offset:0 sc1
    global_load_dwordx4 a[140:143], v7, s[94:95] offset:-4096 sc1
    s_waitcnt vmcnt(0)
    s_branch k2_L_85B
k2_L_87S:
k2_L_86L:
    v_bfe_u32 v0, v2, 4, 4
    v_min_u32 v0, s31, v0
    v_lshlrev_b32 v0, 12, v0
    v_and_b32 v24, 0x300, v2
    v_add_u32 v0, v0, v24
    global_load_dwordx3 v[24:26], v0, s[52:53] offset:-2944 sc1
    s_sub_u32 s67, s67, 1
    s_cbranch_scc1 k2_L_86X
    s_waitcnt vmcnt(0)
    v_max_u32 v24, v24, v26
    v_cmp_eq_u32 vcc, -1, v24
    s_cbranch_vccnz k2_L_86L
    s_branch k2_L_86Y
k2_L_86X:
    s_mov_b32 s67, 0
k2_L_86Y:
    global_load_dwordx4 a[204:207], v2, s[52:53] offset:-3072 sc1
    global_load_dwordx4 a[80:83], v2, s[52:53] offset:1024 sc1
    global_load_dwordx4 a[144:147], v3, s[52:53] offset:-3072 sc1
    global_load_dwordx4 a[208:211], v3, s[52:53] offset:1024 sc1
    global_load_dwordx4 a[84:87], v4, s[52:53] offset:-3072 sc1
    global_load_dwordx4 a[148:151], v4, s[52:53] offset:1024 sc1
    global_load_dwordx4 a[212:215], v5, s[52:53] offset:-3072 sc1
    global_load_dwordx4 a[88:91], v5, s[52:53] offset:1024 sc1
    global_load_dwordx4 a[152:155], v6, s[52:53] offset:-3072 sc1
    global_load_dwordx4 a[216:219], v6, s[52:53] offset:1024 sc1
    global_load_dwordx4 a[92:95], v7, s[94:95] offset:-3072 sc1
    s_waitcnt vmcnt(0)
    s_branch k2_L_87B
k2_L_89S:
k2_L_88L:
    v_bfe_u32 v0, v2, 4, 4
    v_min_u32 v0, s31, v0
    v_lshlrev_b32 v0, 12, v0
    v_and_b32 v24, 0x300, v2
    v_add_u32 v0, v0, v24
    global_load_dwordx3 v[24:26], v0, s[52:53] offset:-1920 sc1
    s_sub_u32 s67, s67, 1
    s_cbranch_scc1 k2_L_88X
    s_waitcnt vmcnt(0)
    v_max_u32 v24, v24, v26
    v_cmp_eq_u32 vcc, -1, v24
    s_cbranch_vccnz k2_L_88L
    s_branch k2_L_88Y
k2_L_88X:
    s_mov_b32 s67, 0
k2_L_88Y:
    global_load_dwordx4 a[156:159], v2, s[52:53] offset:-2048 sc1
    global_load_dwordx4 a[220:223], v2, s[52:53] offset:2048 sc1
    global_load_dwordx4 a[96:99], v3, s[52:53] offset:-2048 sc1
    global_load_dwordx4 a[160:163], v3, s[52:53] offset:2048 sc1
    global_load_dwordx4 a[224:227], v4, s[52:53] offset:-2048 sc1
    global_load_dwordx4 a[100:103], v4, s[52:53] offset:2048 sc1
    global_load_dwordx4 a[164:167], v5, s[52:53] offset:-2048 sc1
    global_load_dwordx4 a[228:231], v5, s[52:53] offset:2048 sc1
    global_load_dwordx4 a[104:107], v6, s[52:53] offset:-2048 sc1
    global_load_dwordx4 a[168:171], v6, s[52:53] offset:2048 sc1
    global_load_dwordx4 a[232:235], v7, s[94:95] offset:-2048 sc1
    s_waitcnt vmcnt(0)
    s_branch k2_L_89B
k2_L_91S:
k2_L_90L:
    v_bfe_u32 v0, v2, 4, 4
    v_min_u32 v0, s31, v0
    v_lshlrev_b32 v0, 12, v0
    v_and_b32 v24, 0x300, v2
    v_add_u32 v0, v0, v24
    global_load_dwordx3 v[24:26], v0, s[52:53] offset:-896 sc1
    s_sub_u32 s67, s67, 1
    s_cbranch_scc1 k2_L_90X
    s_waitcnt vmcnt(0)
    v_max_u32 v24, v24, v26
    v_cmp_eq_u32 vcc, -1, v24
    s_cbranch_vccnz k2_L_90L
    s_branch k2_L_90Y
k2_L_90X:
    s_mov_b32 s67, 0
k2_L_90Y:
    global_load_dwordx4 a[108:111], v2, s[52:53] offset:-1024 sc1
    global_load_dwordx4 a[172:175], v2, s[52:53] offset:3072 sc1
    global_load_dwordx4 a[236:239], v3, s[52:53] offset:-1024 sc1
    global_load_dwordx4 a[112:115], v3, s[52:53] offset:3072 sc1
    global_load_dwordx4 a[176:179], v4, s[52:53] offset:-1024 sc1
    global_load_dwordx4 a[240:243], v4, s[52:53] offset:3072 sc1
    global_load_dwordx4 a[116:119], v5, s[52:53] offset:-1024 sc1
    global_load_dwordx4 a[180:183], v5, s[52:53] offset:3072 sc1
    global_load_dwordx4 a[244:247], v6, s[52:53] offset:-1024 sc1
    global_load_dwordx4 a[120:123], v6, s[52:53] offset:3072 sc1
    global_load_dwordx4 a[184:187], v7, s[94:95] offset:-1024 sc1
    s_waitcnt vmcnt(0)
    s_branch k2_L_91B
k2_L_93S:
k2_L_92L:
    global_load_dwordx4 v[60:63], v2, s[52:53] offset:-4096 sc1
    global_load_dwordx4 v[64:67], v2, s[52:53] offset:0 sc1
    global_load_dwordx4 v[68:71], v3, s[52:53] offset:-4096 sc1
    global_load_dwordx4 v[72:75], v3, s[52:53] offset:0 sc1
    global_load_dwordx4 v[76:79], v4, s[52:53] offset:-4096 sc1
    global_load_dwordx4 v[80:83], v4, s[52:53] offset:0 sc1
    global_load_dwordx4 v[84:87], v5, s[52:53] offset:-4096 sc1
    global_load_dwordx4 v[88:91], v5, s[52:53] offset:0 sc1
    global_load_dwordx4 v[92:95], v6, s[52:53] offset:-4096 sc1
    global_load_dwordx4 v[104:107], v6, s[52:53] offset:0 sc1
    global_load_dwordx4 v[108:111], v7, s[94:95] offset:-4096 sc1
    s_sub_u32 s67, s67, 1
    s_cbranch_scc1 k2_L_92X
    s_waitcnt vmcnt(0)
    v_max3_u32 v0, v60, v62, v64
    v_max3_u32 v0, v0, v66, v68
    v_max3_u32 v0, v0, v70, v72
    v_max3_u32 v0, v0, v74, v76
    v_max3_u32 v0, v0, v78, v80
    v_max3_u32 v0, v0, v82, v84
    v_max3_u32 v0, v0, v86, v88
    v_max3_u32 v0, v0, v90, v92
    v_max3_u32 v0, v0, v94, v104
    v_max3_u32 v0, v0, v106, v108
    v_max_u32 v0, v0, v110
    v_cmp_eq_u32 vcc, -1, v0
    s_cbranch_vccnz k2_L_92L
    s_branch k2_L_92Y
k2_L_92X:
    s_mov_b32 s67, 0
k2_L_92Y:
    s_waitcnt vmcnt(0)
    s_waitcnt lgkmcnt(0)
    v_mfma_f32_16x16x32_bf16 v[28:31], v[144:147], v[60:63], v[128:131]
    v_mfma_f32_16x16x32_bf16 v[32:35], v[148:151], v[60:63], 0
    v_mfma_f32_16x16x32_bf16 v[36:39], v[152:155], v[60:63], 0
    v_mfma_f32_16x16x32_bf16 v[40:43], v[156:159], v[60:63], 0
    v_mfma_f32_16x16x32_bf16 v[28:31], v[160:163], v[64:67], v[28:31]
    v_mfma_f32_16x16x32_bf16 v[32:35], v[164:167], v[64:67], v[32:35]
    v_mfma_f32_16x16x32_bf16 v[36:39], v[168:171], v[64:67], v[36:39]
    v_mfma_f32_16x16x32_bf16 v[40:43], v[172:175], v[64:67], v[40:43]
    v_mfma_f32_16x16x32_bf16 v[28:31], v[176:179], v[68:71], v[28:31]
    v_mfma_f32_16x16x32_bf16 v[32:35], v[180:183], v[68:71], v[32:35]
    v_mfma_f32_16x16x32_bf16 v[36:39], v[184:187], v[68:71], v[36:39]
    v_mfma_f32_16x16x32_bf16 v[40:43], v[188:191], v[68:71], v[40:43]
    v_mfma_f32_16x16x32_bf16 v[28:31], v[192:195], v[72:75], v[28:31]
    v_mfma_f32_16x16x32_bf16 v[32:35], v[196:199], v[72:75], v[32:35]
    v_mfma_f32_16x16x32_bf16 v[36:39], v[200:203], v[72:75], v[36:39]
    v_mfma_f32_16x16x32_bf16 v[40:43], v[204:207], v[72:75], v[40:43]
    v_mfma_f32_16x16x32_bf16 v[28:31], v[208:211], v[76:79], v[28:31]
    v_mfma_f32_16x16x32_bf16 v[32:35], v[212:215], v[76:79], v[32:35]
    v_mfma_f32_16x16x32_bf16 v[36:39], v[216:219], v[76:79], v[36:39]
    v_mfma_f32_16x16x32_bf16 v[40:43], v[220:223], v[76:79], v[40:43]
    v_mfma_f32_16x16x32_bf16 v[28:31], v[224:227], v[80:83], v[28:31]
    v_mfma_f32_16x16x32_bf16 v[32:35], v[228:231], v[80:83], v[32:35]
    v_mfma_f32_16x16x32_bf16 v[36:39], v[232:235], v[80:83], v[36:39]
    v_mfma_f32_16x16x32_bf16 v[40:43], v[236:239], v[80:83], v[40:43]
    v_mfma_f32_16x16x32_bf16 v[28:31], v[240:243], v[84:87], v[28:31]
    v_mfma_f32_16x16x32_bf16 v[32:35], v[112:115], v[84:87], v[32:35]
    v_mfma_f32_16x16x32_bf16 v[36:39], v[116:119], v[84:87], v[36:39]
    v_mfma_f32_16x16x32_bf16 v[40:43], v[120:123], v[84:87], v[40:43]
    v_mfma_f32_16x16x32_bf16 v[28:31], a[0:3], v[88:91], v[28:31]
    v_mfma_f32_16x16x32_bf16 v[32:35], a[4:7], v[88:91], v[32:35]
    v_mfma_f32_16x16x32_bf16 v[36:39], a[8:11], v[88:91], v[36:39]
    v_mfma_f32_16x16x32_bf16 v[40:43], a[12:15], v[88:91], v[40:43]
    v_mfma_f32_16x16x32_bf16 v[28:31], a[16:19], v[92:95], v[28:31]
    v_mfma_f32_16x16x32_bf16 v[32:35], a[20:23], v[92:95], v[32:35]
    v_mfma_f32_16x16x32_bf16 v[36:39], a[24:27], v[92:95], v[36:39]
    v_mfma_f32_16x16x32_bf16 v[40:43], a[28:31], v[92:95], v[40:43]
    v_mfma_f32_16x16x32_bf16 v[28:31], a[32:35], v[104:107], v[28:31]
    v_mfma_f32_16x16x32_bf16 v[32:35], a[36:39], v[104:107], v[32:35]
    v_mfma_f32_16x16x32_bf16 v[36:39], a[40:43], v[104:107], v[36:39]
    v_mfma_f32_16x16x32_bf16 v[40:43], a[44:47], v[104:107], v[40:43]
    v_mfma_f32_16x16x32_bf16 v[28:31], a[48:51], v[108:111], v[28:31]
    v_mfma_f32_16x16x32_bf16 v[32:35], a[52:55], v[108:111], v[32:35]
    v_mfma_f32_16x16x32_bf16 v[36:39], a[56:59], v[108:111], v[36:39]
    v_mfma_f32_16x16x32_bf16 v[40:43], a[60:63], v[108:111], v[40:43]
    s_nop 7
    ds_write_b128 v9, v[32:35] offset:0
    ds_write_b128 v10, v[36:39] offset:0
    ds_write_b128 v11, v[40:43] offset:0
    ds_write_b128 v15, v[28:31] offset:0
    s_waitcnt lgkmcnt(0)
    s_branch k2_L_93B
k2_L_95S:
k2_L_94L:
    global_load_dwordx4 v[60:63], v2, s[52:53] offset:-3072 sc1
    global_load_dwordx4 v[64:67], v2, s[52:53] offset:1024 sc1
    global_load_dwordx4 v[68:71], v3, s[52:53] offset:-3072 sc1
    global_load_dwordx4 v[72:75], v3, s[52:53] offset:1024 sc1
    global_load_dwordx4 v[76:79], v4, s[52:53] offset:-3072 sc1
    global_load_dwordx4 v[80:83], v4, s[52:53] offset:1024 sc1
    global_load_dwordx4 v[84:87], v5, s[52:53] offset:-3072 sc1
    global_load_dwordx4 v[88:91], v5, s[52:53] offset:1024 sc1
    global_load_dwordx4 v[92:95], v6, s[52:53] offset:-3072 sc1
    global_load_dwordx4 v[104:107], v6, s[52:53] offset:1024 sc1
    global_load_dwordx4 v[108:111], v7, s[94:95] offset:-3072 sc1
    s_sub_u32 s67, s67, 1
    s_cbranch_scc1 k2_L_94X
    s_waitcnt vmcnt(0)
    v_max3_u32 v0, v60, v62, v64
    v_max3_u32 v0, v0, v66, v68
    v_max3_u32 v0, v0, v70, v72
    v_max3_u32 v0, v0, v74, v76
    v_max3_u32 v0, v0, v78, v80
    v_max3_u32 v0, v0, v82, v84
    v_max3_u32 v0, v0, v86, v88
    v_max3_u32 v0, v0, v90, v92
    v_max3_u32 v0, v0, v94, v104
    v_max3_u32 v0, v0, v106, v108
    v_max_u32 v0, v0, v110
    v_cmp_eq_u32 vcc, -1, v0
    s_cbranch_vccnz k2_L_94L
    s_branch k2_L_94Y
k2_L_94X:
    s_mov_b32 s67, 0
k2_L_94Y:
    s_waitcnt vmcnt(0)
    s_waitcnt lgkmcnt(0)
    v_mfma_f32_16x16x32_bf16 v[44:47], v[144:147], v[60:63], v[132:135]
    v_mfma_f32_16x16x32_bf16 v[48:51], v[148:151], v[60:63], 0
    v_mfma_f32_16x16x32_bf16 v[52:55], v[152:155], v[60:63], 0
    v_mfma_f32_16x16x32_bf16 v[56:59], v[156:159], v[60:63], 0
    v_mfma_f32_16x16x32_bf16 v[44:47], v[160:163], v[64:67], v[44:47]
    v_mfma_f32_16x16x32_bf16 v[48:51], v[164:167], v[64:67], v[48:51]
    v_mfma_f32_16x16x32_bf16 v[52:55], v[168:171], v[64:67], v[52:55]
    v_mfma_f32_16x16x32_bf16 v[56:59], v[172:175], v[64:67], v[56:59]
    v_mfma_f32_16x16x32_bf16 v[44:47], v[176:179], v[68:71], v[44:47]
    v_mfma_f32_16x16x32_bf16 v[48:51], v[180:183], v[68:71], v[48:51]
    v_mfma_f32_16x16x32_bf16 v[52:55], v[184:187], v[68:71], v[52:55]
    v_mfma_f32_16x16x32_bf16 v[56:59], v[188:191], v[68:71], v[56:59]
    v_mfma_f32_16x16x32_bf16 v[44:47], v[192:195], v[72:75], v[44:47]
    v_mfma_f32_16x16x32_bf16 v[48:51], v[196:199], v[72:75], v[48:51]
    v_mfma_f32_16x16x32_bf16 v[52:55], v[200:203], v[72:75], v[52:55]
    v_mfma_f32_16x16x32_bf16 v[56:59], v[204:207], v[72:75], v[56:59]
    v_mfma_f32_16x16x32_bf16 v[44:47], v[208:211], v[76:79], v[44:47]
    v_mfma_f32_16x16x32_bf16 v[48:51], v[212:215], v[76:79], v[48:51]
    v_mfma_f32_16x16x32_bf16 v[52:55], v[216:219], v[76:79], v[52:55]
    v_mfma_f32_16x16x32_bf16 v[56:59], v[220:223], v[76:79], v[56:59]
    v_mfma_f32_16x16x32_bf16 v[44:47], v[224:227], v[80:83], v[44:47]
    v_mfma_f32_16x16x32_bf16 v[48:51], v[228:231], v[80:83], v[48:51]
    v_mfma_f32_16x16x32_bf16 v[52:55], v[232:235], v[80:83], v[52:55]
    v_mfma_f32_16x16x32_bf16 v[56:59], v[236:239], v[80:83], v[56:59]
    v_mfma_f32_16x16x32_bf16 v[44:47], v[240:243], v[84:87], v[44:47]
    v_mfma_f32_16x16x32_bf16 v[48:51], v[112:115], v[84:87], v[48:51]
    v_mfma_f32_16x16x32_bf16 v[52:55], v[116:119], v[84:87], v[52:55]
    v_mfma_f32_16x16x32_bf16 v[56:59], v[120:123], v[84:87], v[56:59]
    v_mfma_f32_16x16x32_bf16 v[44:47], a[0:3], v[88:91], v[44:47]
    v_mfma_f32_16x16x32_bf16 v[48:51], a[4:7], v[88:91], v[48:51]
    v_mfma_f32_16x16x32_bf16 v[52:55], a[8:11], v[88:91], v[52:55]
    v_mfma_f32_16x16x32_bf16 v[56:59], a[12:15], v[88:91], v[56:59]
    v_mfma_f32_16x16x32_bf16 v[44:47], a[16:19], v[92:95], v[44:47]
    v_mfma_f32_16x16x32_bf16 v[48:51], a[20:23], v[92:95], v[48:51]
    v_mfma_f32_16x16x32_bf16 v[52:55], a[24:27], v[92:95], v[52:55]
    v_mfma_f32_16x16x32_bf16 v[56:59], a[28:31], v[92:95], v[56:59]
    v_mfma_f32_16x16x32_bf16 v[44:47], a[32:35], v[104:107], v[44:47]
    v_mfma_f32_16x16x32_bf16 v[48:51], a[36:39], v[104:107], v[48:51]
    v_mfma_f32_16x16x32_bf16 v[52:55], a[40:43], v[104:107], v[52:55]
    v_mfma_f32_16x16x32_bf16 v[56:59], a[44:47], v[104:107], v[56:59]
    v_mfma_f32_16x16x32_bf16 v[44:47], a[48:51], v[108:111], v[44:47]
    v_mfma_f32_16x16x32_bf16 v[48:51], a[52:55], v[108:111], v[48:51]
    v_mfma_f32_16x16x32_bf16 v[52:55], a[56:59], v[108:111], v[52:55]
    v_mfma_f32_16x16x32_bf16 v[56:59], a[60:63], v[108:111], v[56:59]
    s_nop 7
    ds_write_b128 v9, v[48:51] offset:16384
    ds_write_b128 v10, v[52:55] offset:16384
    ds_write_b128 v11, v[56:59] offset:16384
    ds_write_b128 v15, v[44:47] offset:16384
    s_waitcnt lgkmcnt(0)
    s_branch k2_L_95B
k2_L_97S:
k2_L_96L:
    global_load_dwordx4 v[60:63], v2, s[52:53] offset:-2048 sc1
    global_load_dwordx4 v[64:67], v2, s[52:53] offset:2048 sc1
    global_load_dwordx4 v[68:71], v3, s[52:53] offset:-2048 sc1
    global_load_dwordx4 v[72:75], v3, s[52:53] offset:2048 sc1
    global_load_dwordx4 v[76:79], v4, s[52:53] offset:-2048 sc1
    global_load_dwordx4 v[80:83], v4, s[52:53] offset:2048 sc1
    global_load_dwordx4 v[84:87], v5, s[52:53] offset:-2048 sc1
    global_load_dwordx4 v[88:91], v5, s[52:53] offset:2048 sc1
    global_load_dwordx4 v[92:95], v6, s[52:53] offset:-2048 sc1
    global_load_dwordx4 v[104:107], v6, s[52:53] offset:2048 sc1
    global_load_dwordx4 v[108:111], v7, s[94:95] offset:-2048 sc1
    s_sub_u32 s67, s67, 1
    s_cbranch_scc1 k2_L_96X
    s_waitcnt vmcnt(0)
    v_max3_u32 v0, v60, v62, v64
    v_max3_u32 v0, v0, v66, v68
    v_max3_u32 v0, v0, v70, v72
    v_max3_u32 v0, v0, v74, v76
    v_max3_u32 v0, v0, v78, v80
    v_max3_u32 v0, v0, v82, v84
    v_max3_u32 v0, v0, v86, v88
    v_max3_u32 v0, v0, v90, v92
    v_max3_u32 v0, v0, v94, v104
    v_max3_u32 v0, v0, v106, v108
    v_max_u32 v0, v0, v110
    v_cmp_eq_u32 vcc, -1, v0
    s_cbranch_vccnz k2_L_96L
    s_branch k2_L_96Y
k2_L_96X:
    s_mov_b32 s67, 0
k2_L_96Y:
    s_waitcnt vmcnt(0)
    s_waitcnt lgkmcnt(0)
    v_mfma_f32_16x16x32_bf16 v[28:31], v[144:147], v[60:63], v[136:139]
    v_mfma_f32_16x16x32_bf16 v[32:35], v[148:151], v[60:63], 0
    v_mfma_f32_16x16x32_bf16 v[36:39], v[152:155], v[60:63], 0
    v_mfma_f32_16x16x32_bf16 v[40:43], v[156:159], v[60:63], 0
    v_mfma_f32_16x16x32_bf16 v[28:31], v[160:163], v[64:67], v[28:31]
    v_mfma_f32_16x16x32_bf16 v[32:35], v[164:167], v[64:67], v[32:35]
    v_mfma_f32_16x16x32_bf16 v[36:39], v[168:171], v[64:67], v[36:39]
    v_mfma_f32_16x16x32_bf16 v[40:43], v[172:175], v[64:67], v[40:43]
    v_mfma_f32_16x16x32_bf16 v[28:31], v[176:179], v[68:71], v[28:31]
    v_mfma_f32_16x16x32_bf16 v[32:35], v[180:183], v[68:71], v[32:35]
    v_mfma_f32_16x16x32_bf16 v[36:39], v[184:187], v[68:71], v[36:39]
    v_mfma_f32_16x16x32_bf16 v[40:43], v[188:191], v[68:71], v[40:43]
    v_mfma_f32_16x16x32_bf16 v[28:31], v[192:195], v[72:75], v[28:31]
    v_mfma_f32_16x16x32_bf16 v[32:35], v[196:199], v[72:75], v[32:35]
    v_mfma_f32_16x16x32_bf16 v[36:39], v[200:203], v[72:75], v[36:39]
    v_mfma_f32_16x16x32_bf16 v[40:43], v[204:207], v[72:75], v[40:43]
    v_mfma_f32_16x16x32_bf16 v[28:31], v[208:211], v[76:79], v[28:31]
    v_mfma_f32_16x16x32_bf16 v[32:35], v[212:215], v[76:79], v[32:35]
    v_mfma_f32_16x16x32_bf16 v[36:39], v[216:219], v[76:79], v[36:39]
    v_mfma_f32_16x16x32_bf16 v[40:43], v[220:223], v[76:79], v[40:43]
    v_mfma_f32_16x16x32_bf16 v[28:31], v[224:227], v[80:83], v[28:31]
    v_mfma_f32_16x16x32_bf16 v[32:35], v[228:231], v[80:83], v[32:35]
    v_mfma_f32_16x16x32_bf16 v[36:39], v[232:235], v[80:83], v[36:39]
    v_mfma_f32_16x16x32_bf16 v[40:43], v[236:239], v[80:83], v[40:43]
    v_mfma_f32_16x16x32_bf16 v[28:31], v[240:243], v[84:87], v[28:31]
    v_mfma_f32_16x16x32_bf16 v[32:35], v[112:115], v[84:87], v[32:35]
    v_mfma_f32_16x16x32_bf16 v[36:39], v[116:119], v[84:87], v[36:39]
    v_mfma_f32_16x16x32_bf16 v[40:43], v[120:123], v[84:87], v[40:43]
    v_mfma_f32_16x16x32_bf16 v[28:31], a[0:3], v[88:91], v[28:31]
    v_mfma_f32_16x16x32_bf16 v[32:35], a[4:7], v[88:91], v[32:35]
    v_mfma_f32_16x16x32_bf16 v[36:39], a[8:11], v[88:91], v[36:39]
    v_mfma_f32_16x16x32_bf16 v[40:43], a[12:15], v[88:91], v[40:43]
    v_mfma_f32_16x16x32_bf16 v[28:31], a[16:19], v[92:95], v[28:31]
    v_mfma_f32_16x16x32_bf16 v[32:35], a[20:23], v[92:95], v[32:35]
    v_mfma_f32_16x16x32_bf16 v[36:39], a[24:27], v[92:95], v[36:39]
    v_mfma_f32_16x16x32_bf16 v[40:43], a[28:31], v[92:95], v[40:43]
    v_mfma_f32_16x16x32_bf16 v[28:31], a[32:35], v[104:107], v[28:31]
    v_mfma_f32_16x16x32_bf16 v[32:35], a[36:39], v[104:107], v[32:35]
    v_mfma_f32_16x16x32_bf16 v[36:39], a[40:43], v[104:107], v[36:39]
    v_mfma_f32_16x16x32_bf16 v[40:43], a[44:47], v[104:107], v[40:43]
    v_mfma_f32_16x16x32_bf16 v[28:31], a[48:51], v[108:111], v[28:31]
    v_mfma_f32_16x16x32_bf16 v[32:35], a[52:55], v[108:111], v[32:35]
    v_mfma_f32_16x16x32_bf16 v[36:39], a[56:59], v[108:111], v[36:39]
    v_mfma_f32_16x16x32_bf16 v[40:43], a[60:63], v[108:111], v[40:43]
    s_nop 7
    ds_write_b128 v9, v[32:35] offset:32768
    ds_write_b128 v10, v[36:39] offset:32768
    ds_write_b128 v11, v[40:43] offset:32768
    ds_write_b128 v15, v[28:31] offset:32768
    s_waitcnt lgkmcnt(0)
    s_branch k2_L_97B
k2_L_99S:
k2_L_98L:
    global_load_dwordx4 v[60:63], v2, s[52:53] offset:-1024 sc1
    global_load_dwordx4 v[64:67], v2, s[52:53] offset:3072 sc1
    global_load_dwordx4 v[68:71], v3, s[52:53] offset:-1024 sc1
    global_load_dwordx4 v[72:75], v3, s[52:53] offset:3072 sc1
    global_load_dwordx4 v[76:79], v4, s[52:53] offset:-1024 sc1
    global_load_dwordx4 v[80:83], v4, s[52:53] offset:3072 sc1
    global_load_dwordx4 v[84:87], v5, s[52:53] offset:-1024 sc1
    global_load_dwordx4 v[88:91], v5, s[52:53] offset:3072 sc1
    global_load_dwordx4 v[92:95], v6, s[52:53] offset:-1024 sc1
    global_load_dwordx4 v[104:107], v6, s[52:53] offset:3072 sc1
    global_load_dwordx4 v[108:111], v7, s[94:95] offset:-1024 sc1
    s_sub_u32 s67, s67, 1
    s_cbranch_scc1 k2_L_98X
    s_waitcnt vmcnt(0)
    v_max3_u32 v0, v60, v62, v64
    v_max3_u32 v0, v0, v66, v68
    v_max3_u32 v0, v0, v70, v72
    v_max3_u32 v0, v0, v74, v76
    v_max3_u32 v0, v0, v78, v80
    v_max3_u32 v0, v0, v82, v84
    v_max3_u32 v0, v0, v86, v88
    v_max3_u32 v0, v0, v90, v92
    v_max3_u32 v0, v0, v94, v104
    v_max3_u32 v0, v0, v106, v108
    v_max_u32 v0, v0, v110
    v_cmp_eq_u32 vcc, -1, v0
    s_cbranch_vccnz k2_L_98L
    s_branch k2_L_98Y
k2_L_98X:
    s_mov_b32 s67, 0
k2_L_98Y:
    s_waitcnt vmcnt(0)
    s_waitcnt lgkmcnt(0)
    v_mfma_f32_16x16x32_bf16 v[44:47], v[144:147], v[60:63], v[140:143]
    v_mfma_f32_16x16x32_bf16 v[48:51], v[148:151], v[60:63], 0
    v_mfma_f32_16x16x32_bf16 v[52:55], v[152:155], v[60:63], 0
    v_mfma_f32_16x16x32_bf16 v[56:59], v[156:159], v[60:63], 0
    v_mfma_f32_16x16x32_bf16 v[44:47], v[160:163], v[64:67], v[44:47]
    v_mfma_f32_16x16x32_bf16 v[48:51], v[164:167], v[64:67], v[48:51]
    v_mfma_f32_16x16x32_bf16 v[52:55], v[168:171], v[64:67], v[52:55]
    v_mfma_f32_16x16x32_bf16 v[56:59], v[172:175], v[64:67], v[56:59]
    v_mfma_f32_16x16x32_bf16 v[44:47], v[176:179], v[68:71], v[44:47]
    v_mfma_f32_16x16x32_bf16 v[48:51], v[180:183], v[68:71], v[48:51]
    v_mfma_f32_16x16x32_bf16 v[52:55], v[184:187], v[68:71], v[52:55]
    v_mfma_f32_16x16x32_bf16 v[56:59], v[188:191], v[68:71], v[56:59]
    v_mfma_f32_16x16x32_bf16 v[44:47], v[192:195], v[72:75], v[44:47]
    v_mfma_f32_16x16x32_bf16 v[48:51], v[196:199], v[72:75], v[48:51]
    v_mfma_f32_16x16x32_bf16 v[52:55], v[200:203], v[72:75], v[52:55]
    v_mfma_f32_16x16x32_bf16 v[56:59], v[204:207], v[72:75], v[56:59]
    v_mfma_f32_16x16x32_bf16 v[44:47], v[208:211], v[76:79], v[44:47]
    v_mfma_f32_16x16x32_bf16 v[48:51], v[212:215], v[76:79], v[48:51]
    v_mfma_f32_16x16x32_bf16 v[52:55], v[216:219], v[76:79], v[52:55]
    v_mfma_f32_16x16x32_bf16 v[56:59], v[220:223], v[76:79], v[56:59]
    v_mfma_f32_16x16x32_bf16 v[44:47], v[224:227], v[80:83], v[44:47]
    v_mfma_f32_16x16x32_bf16 v[48:51], v[228:231], v[80:83], v[48:51]
    v_mfma_f32_16x16x32_bf16 v[52:55], v[232:235], v[80:83], v[52:55]
    v_mfma_f32_16x16x32_bf16 v[56:59], v[236:239], v[80:83], v[56:59]
    v_mfma_f32_16x16x32_bf16 v[44:47], v[240:243], v[84:87], v[44:47]
    v_mfma_f32_16x16x32_bf16 v[48:51], v[112:115], v[84:87], v[48:51]
    v_mfma_f32_16x16x32_bf16 v[52:55], v[116:119], v[84:87], v[52:55]
    v_mfma_f32_16x16x32_bf16 v[56:59], v[120:123], v[84:87], v[56:59]
    v_mfma_f32_16x16x32_bf16 v[44:47], a[0:3], v[88:91], v[44:47]
    v_mfma_f32_16x16x32_bf16 v[48:51], a[4:7], v[88:91], v[48:51]
    v_mfma_f32_16x16x32_bf16 v[52:55], a[8:11], v[88:91], v[52:55]
    v_mfma_f32_16x16x32_bf16 v[56:59], a[12:15], v[88:91], v[56:59]
    v_mfma_f32_16x16x32_bf16 v[44:47], a[16:19], v[92:95], v[44:47]
    v_mfma_f32_16x16x32_bf16 v[48:51], a[20:23], v[92:95], v[48:51]
    v_mfma_f32_16x16x32_bf16 v[52:55], a[24:27], v[92:95], v[52:55]
    v_mfma_f32_16x16x32_bf16 v[56:59], a[28:31], v[92:95], v[56:59]
    v_mfma_f32_16x16x32_bf16 v[44:47], a[32:35], v[104:107], v[44:47]
    v_mfma_f32_16x16x32_bf16 v[48:51], a[36:39], v[104:107], v[48:51]
    v_mfma_f32_16x16x32_bf16 v[52:55], a[40:43], v[104:107], v[52:55]
    v_mfma_f32_16x16x32_bf16 v[56:59], a[44:47], v[104:107], v[56:59]
    v_mfma_f32_16x16x32_bf16 v[44:47], a[48:51], v[108:111], v[44:47]
    v_mfma_f32_16x16x32_bf16 v[48:51], a[52:55], v[108:111], v[48:51]
    v_mfma_f32_16x16x32_bf16 v[52:55], a[56:59], v[108:111], v[52:55]
    v_mfma_f32_16x16x32_bf16 v[56:59], a[60:63], v[108:111], v[56:59]
    s_nop 7
    ds_write_b128 v9, v[48:51] offset:49152
    ds_write_b128 v10, v[52:55] offset:49152
    ds_write_b128 v11, v[56:59] offset:49152
    ds_write_b128 v15, v[44:47] offset:49152
    s_waitcnt lgkmcnt(0)
    s_branch k2_L_99B
k2_LAST:
.section .rodata,"a"
.p2align 6
.amdhsa_kernel sequential_preLN__mha_block__dense_activation_silu__prompt_kernel
  .amdhsa_next_free_vgpr 512
  .amdhsa_next_free_sgpr 98
  .amdhsa_accum_offset 256
  .amdhsa_group_segment_fixed_size 0
  .amdhsa_kernarg_size 72
  .amdhsa_user_sgpr_count 2
  .amdhsa_user_sgpr_kernarg_segment_ptr 1
  .amdhsa_system_sgpr_workgroup_id_x 1
.end_amdhsa_kernel
```
